```python
import torch

def _softmax(x, axis=-1):
    return torch.softmax(x, dim=axis)
def _gelu(x):
    return torch.nn.functional.gelu(x, approximate="tanh")
def _silu(x):
    return torch.nn.functional.silu(x)
def _sigmoid(x):
    return torch.sigmoid(x)
def _layernorm(x, axis=-1, eps=1e-5):
    m = x.mean(dim=axis, keepdim=True)
    v = x.var(dim=axis, keepdim=True, unbiased=False)
    return (x - m) / torch.sqrt(v + eps)
def _scatter_add(tgt, idx, src, axis=0):
    return tgt.clone().index_add_(axis, idx, src)
def _segment_sum(src, seg, n):
    out = torch.zeros((n,) + src.shape[1:], dtype=src.dtype)
    return out.index_add_(0, seg, src)
def _pad(x, pw):
    flat = tuple(v for pair in reversed(pw) for v in pair)
    return torch.nn.functional.pad(x, flat)

kernel_name = 'interleave_layers__sliding_local_dilated__sliding_local_dilated__prompt'

def setup_inputs():

    _w = (lambda a: (lambda t: t.to(torch.bfloat16) if t.is_floating_point() else t)(torch.as_tensor(a)))
    def _A_setup():
        B, S, D = 1, 2048, 576
        return {
            "x": _w((lambda *s: torch.randn(*s, dtype=torch.bfloat16) * 0.05)(B, S, D)),
            "wqkv": _w((lambda *s: torch.randn(*s, dtype=torch.bfloat16) * 0.05)(D, 3 * D)),
            "wo": _w((lambda *s: torch.randn(*s, dtype=torch.bfloat16) * 0.05)(D, D)),
        }
    _A_in = _A_setup()

    def _B_setup():
        B, S, D = 1, 2048, 576
        return {
            "x": _w((lambda *s: torch.randn(*s, dtype=torch.bfloat16) * 0.05)(B, S, D)),
            "wqkv": _w((lambda *s: torch.randn(*s, dtype=torch.bfloat16) * 0.05)(D, 3 * D)),
            "wo": _w((lambda *s: torch.randn(*s, dtype=torch.bfloat16) * 0.05)(D, D)),
        }
    _B_in = _B_setup()

    return {
        "A_x": _A_in["x"],
        "A_wqkv": _A_in["wqkv"],
        "A_wo": _A_in["wo"],
        "B_x": _B_in["x"],
        "B_wqkv": _B_in["wqkv"],
        "B_wo": _B_in["wo"],
    }

def reference(A_x, A_wqkv, A_wo, B_x, B_wqkv, B_wo):
    def _A_ref(x, wqkv, wo):
        B, S, D = x.shape
        H = 32; Dh = D // H
        W, dil = 8, 2
        qkv = (lambda x, *d: x.permute(*d))((x @ wqkv).reshape(B, S, 3, H, Dh), 2, 0, 3, 1, 4)
        q, k, v = qkv[0], qkv[1], qkv[2]
        scale = Dh ** -0.5
        pos = torch.arange(S)
        off = torch.arange(W) * dil
        idx = pos[:, None] - off[None, :]
        mask = idx >= 0
        idx_c = torch.where(mask, idx, 0).reshape(-1)
        kg = k[:, :, idx_c, :].reshape(B, H, S, W, Dh)
        vg = v[:, :, idx_c, :].reshape(B, H, S, W, Dh)
        logits = torch.einsum("bhsd,bhswd->bhsw", q, kg) * scale
        logits = torch.where(mask[None, None, :, :], logits, -1e9)
        attn = _softmax(logits, axis=-1)
        o = torch.einsum("bhsw,bhswd->bhsd", attn, vg)
        return (lambda x, *d: x.permute(*d))(o, 0, 2, 1, 3).reshape(B, S, D) @ wo

    def _B_ref(x, wqkv, wo):
        B, S, D = x.shape
        H = 32; Dh = D // H
        W, dil = 8, 2
        qkv = (lambda x, *d: x.permute(*d))((x @ wqkv).reshape(B, S, 3, H, Dh), 2, 0, 3, 1, 4)
        q, k, v = qkv[0], qkv[1], qkv[2]
        scale = Dh ** -0.5
        pos = torch.arange(S)
        off = torch.arange(W) * dil
        idx = pos[:, None] - off[None, :]
        mask = idx >= 0
        idx_c = torch.where(mask, idx, 0).reshape(-1)
        kg = k[:, :, idx_c, :].reshape(B, H, S, W, Dh)
        vg = v[:, :, idx_c, :].reshape(B, H, S, W, Dh)
        logits = torch.einsum("bhsd,bhswd->bhsw", q, kg) * scale
        logits = torch.where(mask[None, None, :, :], logits, -1e9)
        attn = _softmax(logits, axis=-1)
        o = torch.einsum("bhsw,bhswd->bhsd", attn, vg)
        return (lambda x, *d: x.permute(*d))(o, 0, 2, 1, 3).reshape(B, S, D) @ wo

    x = A_x
    x = x + _A_ref(_layernorm(x, axis=-1), A_wqkv, A_wo)
    x = x + _B_ref(_layernorm(x, axis=-1), B_wqkv, B_wo)
    x = x + _A_ref(_layernorm(x, axis=-1), A_wqkv, A_wo)
    x = x + _B_ref(_layernorm(x, axis=-1), B_wqkv, B_wo)
    return x
```

```asm
; @launch kernel=p_kernel grid=(527,1,1) block=(256,1,1) lds=16384
; @launch kernel=m_kernel grid=(256,1,1) block=(512,1,1) lds=163840
.amdgcn_target "amdgcn-amd-amdhsa--gfx950"
.text
.globl p_kernel
.p2align 8
.type p_kernel,@function
p_kernel:
P_body:
    s_cmp_ge_u32 s2, 527
    s_cbranch_scc1 P_exit
    s_load_dwordx16 s[32:47], s[0:1], 0
    s_load_dwordx2 s[48:49], s[0:1], 64
    v_lshrrev_b32 v1, 6, v0
    v_and_b32 v0, 63, v0
    v_readfirstlane_b32 s4, v1
    s_waitcnt lgkmcnt(0)
    s_mov_b32 s16, s48
    s_mov_b32 s17, s49
    s_mov_b32 s18, 33554432
    s_mov_b32 s19, 0x20000
    s_mov_b32 s11, 0x20000
    v_lshrrev_b32 v3, 4, v0
    v_bfe_u32 v4, v0, 2, 2
    v_lshlrev_b32 v4, 1, v4
    v_lshl_add_u32 v12, v3, 3, v4
    v_and_b32 v13, 3, v0
    v_lshlrev_b32 v13, 3, v13
    v_lshlrev_b32 v14, 4, v0
    v_and_b32 v4, 7, v0
    v_lshl_add_u32 v15, v3, 3, v4
    v_lshlrev_b32 v15, 4, v15
    v_and_b32 v4, 8, v0
    v_cmp_eq_u32 s[50:51], 0, v4
    v_bfrev_b32 v16, 1
    s_cmp_ge_u32 s2, 511
    s_cbranch_scc1 P_warm
    s_cmp_gt_u32 s2, 438
    s_cbranch_scc1 P_x
    s_cmp_eq_u32 s2, 438
    s_cbranch_scc1 P_flg
    s_cmp_ge_u32 s2, 384
    s_cbranch_scc1 P_cs
    s_cmp_ge_u32 s2, 288
    s_cbranch_scc1 P_o
    s_cmp_ge_u32 s2, 144
    s_cselect_b32 s5, 144, 0
    s_cselect_b64 s[8:9], s[40:41], s[34:35]
    s_mov_b32 s22, 20971520
    s_cselect_b32 s22, 23068672, s22
    s_mov_b32 s10, 1990656
    s_sub_u32 s5, s2, s5
    s_mul_i32 s6, s5, 3641
    s_lshr_b32 s6, s6, 16
    s_mul_i32 s7, s6, 18
    s_sub_u32 s7, s5, s7
    s_mul_i32 s23, s5, 13824
    s_add_u32 s22, s22, s23
    s_mul_i32 s24, s7, 110592
    s_mul_i32 s25, s6, 144
    s_add_u32 s24, s24, s25
    s_lshl_b32 s26, s4, 6
    s_add_u32 s26, s26, 0
    v_add_u32 v2, s26, v0
    v_cmp_gt_u32 vcc, 864, v2
    v_mul_u32_u24 v3, 2428, v2
    v_lshrrev_b32 v3, 16, v3
    v_mul_u32_u24 v4, 27, v3
    v_sub_u32 v2, v2, v4
    v_mul_u32_u24 v4, 57, v2
    v_lshrrev_b32 v4, 9, v4
    v_mul_u32_u24 v5, 9, v4
    v_sub_u32 v2, v2, v5
    v_and_b32 v5, 0x78, v3
    v_bfe_u32 v6, v3, 1, 2
    v_or_b32 v5, v5, v6
    v_and_b32 v6, 1, v3
    v_lshl_or_b32 v5, v6, 2, v5
    v_mul_u32_u24 v5, 3456, v5
    v_mul_u32_u24 v4, 1152, v4
    v_add_u32 v5, v5, v4
    v_lshl_add_u32 v5, v2, 4, v5
    v_cndmask_b32 v5, v16, v5, vcc
    s_lshl_b32 s26, s26, 4
    s_mov_b32 m0, s26
    s_nop 0
    buffer_load_dwordx4 v5, s[8:11], s24 offen lds
    s_lshl_b32 s26, s4, 6
    s_add_u32 s26, s26, 256
    v_add_u32 v2, s26, v0
    v_cmp_gt_u32 vcc, 864, v2
    v_mul_u32_u24 v3, 2428, v2
    v_lshrrev_b32 v3, 16, v3
    v_mul_u32_u24 v4, 27, v3
    v_sub_u32 v2, v2, v4
    v_mul_u32_u24 v4, 57, v2
    v_lshrrev_b32 v4, 9, v4
    v_mul_u32_u24 v5, 9, v4
    v_sub_u32 v2, v2, v5
    v_and_b32 v5, 0x78, v3
    v_bfe_u32 v6, v3, 1, 2
    v_or_b32 v5, v5, v6
    v_and_b32 v6, 1, v3
    v_lshl_or_b32 v5, v6, 2, v5
    v_mul_u32_u24 v5, 3456, v5
    v_mul_u32_u24 v4, 1152, v4
    v_add_u32 v5, v5, v4
    v_lshl_add_u32 v5, v2, 4, v5
    v_cndmask_b32 v5, v16, v5, vcc
    s_lshl_b32 s26, s26, 4
    s_mov_b32 m0, s26
    s_nop 0
    buffer_load_dwordx4 v5, s[8:11], s24 offen lds
    s_lshl_b32 s26, s4, 6
    s_add_u32 s26, s26, 512
    v_add_u32 v2, s26, v0
    v_cmp_gt_u32 vcc, 864, v2
    v_mul_u32_u24 v3, 2428, v2
    v_lshrrev_b32 v3, 16, v3
    v_mul_u32_u24 v4, 27, v3
    v_sub_u32 v2, v2, v4
    v_mul_u32_u24 v4, 57, v2
    v_lshrrev_b32 v4, 9, v4
    v_mul_u32_u24 v5, 9, v4
    v_sub_u32 v2, v2, v5
    v_and_b32 v5, 0x78, v3
    v_bfe_u32 v6, v3, 1, 2
    v_or_b32 v5, v5, v6
    v_and_b32 v6, 1, v3
    v_lshl_or_b32 v5, v6, 2, v5
    v_mul_u32_u24 v5, 3456, v5
    v_mul_u32_u24 v4, 1152, v4
    v_add_u32 v5, v5, v4
    v_lshl_add_u32 v5, v2, 4, v5
    v_cndmask_b32 v5, v16, v5, vcc
    s_lshl_b32 s26, s26, 4
    s_mov_b32 m0, s26
    s_nop 0
    buffer_load_dwordx4 v5, s[8:11], s24 offen lds
    s_lshl_b32 s26, s4, 6
    s_add_u32 s26, s26, 768
    v_add_u32 v2, s26, v0
    v_cmp_gt_u32 vcc, 864, v2
    v_mul_u32_u24 v3, 2428, v2
    v_lshrrev_b32 v3, 16, v3
    v_mul_u32_u24 v4, 27, v3
    v_sub_u32 v2, v2, v4
    v_mul_u32_u24 v4, 57, v2
    v_lshrrev_b32 v4, 9, v4
    v_mul_u32_u24 v5, 9, v4
    v_sub_u32 v2, v2, v5
    v_and_b32 v5, 0x78, v3
    v_bfe_u32 v6, v3, 1, 2
    v_or_b32 v5, v5, v6
    v_and_b32 v6, 1, v3
    v_lshl_or_b32 v5, v6, 2, v5
    v_mul_u32_u24 v5, 3456, v5
    v_mul_u32_u24 v4, 1152, v4
    v_add_u32 v5, v5, v4
    v_lshl_add_u32 v5, v2, 4, v5
    v_cndmask_b32 v5, v16, v5, vcc
    s_lshl_b32 s26, s26, 4
    s_mov_b32 m0, s26
    s_nop 0
    buffer_load_dwordx4 v5, s[8:11], s24 offen lds
    v_mul_u32_u24 v12, 432, v12
    v_add_u32 v12, v12, v13
    v_bfe_u32 v5, v0, 1, 1
    v_lshlrev_b32 v5, 7, v5
    v_add_u32 v5, 128, v5
    v_add_u32 v13, v12, v5
    s_waitcnt vmcnt(0)
    s_barrier
    s_cmp_eq_u32 s4, 1
    s_cbranch_scc1 P_q1
    s_cmp_eq_u32 s4, 2
    s_cbranch_scc1 P_q2
    s_cmp_eq_u32 s4, 3
    s_cbranch_scc1 P_q3
P_q0:
    ds_read_b64_tr_b16 v[20:21], v12 offset:0
    ds_read_b64_tr_b16 v[22:23], v12 offset:432
    ds_read_b64_tr_b16 v[24:25], v13 offset:0
    ds_read_b64_tr_b16 v[26:27], v13 offset:432
    ds_read_b64_tr_b16 v[28:29], v12 offset:240
    ds_read_b64_tr_b16 v[30:31], v12 offset:672
    ds_read_b64_tr_b16 v[32:33], v12 offset:384
    ds_read_b64_tr_b16 v[34:35], v12 offset:816
    s_waitcnt lgkmcnt(6)
    s_add_u32 s26, s22, 0
    buffer_store_dwordx4 v[20:23], v14, s[16:19], s26 offen
    s_waitcnt lgkmcnt(4)
    s_add_u32 s26, s22, 4096
    buffer_store_dwordx4 v[24:27], v14, s[16:19], s26 offen
    s_waitcnt lgkmcnt(2)
    s_add_u32 s26, s22, 8192
    buffer_store_dwordx4 v[28:31], v14, s[16:19], s26 offen
    s_waitcnt lgkmcnt(0)
    s_add_u32 s26, s22, 12288
    buffer_store_dwordx4 v[32:35], v14, s[16:19], s26 offen
    s_endpgm
P_q1:
    ds_read_b64_tr_b16 v[20:21], v12 offset:32
    ds_read_b64_tr_b16 v[22:23], v12 offset:464
    ds_read_b64_tr_b16 v[24:25], v12 offset:144
    ds_read_b64_tr_b16 v[26:27], v12 offset:576
    ds_read_b64_tr_b16 v[28:29], v12 offset:288
    ds_read_b64_tr_b16 v[30:31], v12 offset:720
    ds_read_b64_tr_b16 v[32:33], v12 offset:416
    ds_read_b64_tr_b16 v[34:35], v12 offset:848
    s_waitcnt lgkmcnt(6)
    s_add_u32 s26, s22, 1024
    buffer_store_dwordx4 v[20:23], v14, s[16:19], s26 offen
    s_waitcnt lgkmcnt(4)
    s_add_u32 s26, s22, 5120
    buffer_store_dwordx4 v[24:27], v14, s[16:19], s26 offen
    s_waitcnt lgkmcnt(2)
    s_add_u32 s26, s22, 9216
    buffer_store_dwordx4 v[28:31], v14, s[16:19], s26 offen
    s_waitcnt lgkmcnt(0)
    s_add_u32 s26, s22, 13312
    s_mov_b64 exec, s[50:51]
    buffer_store_dwordx4 v[32:35], v15, s[16:19], s26 offen
    s_endpgm
P_q2:
    ds_read_b64_tr_b16 v[20:21], v12 offset:64
    ds_read_b64_tr_b16 v[22:23], v12 offset:496
    ds_read_b64_tr_b16 v[24:25], v12 offset:176
    ds_read_b64_tr_b16 v[26:27], v12 offset:608
    ds_read_b64_tr_b16 v[28:29], v12 offset:320
    ds_read_b64_tr_b16 v[30:31], v12 offset:752
    s_waitcnt lgkmcnt(4)
    s_add_u32 s26, s22, 2048
    buffer_store_dwordx4 v[20:23], v14, s[16:19], s26 offen
    s_waitcnt lgkmcnt(2)
    s_add_u32 s26, s22, 6144
    buffer_store_dwordx4 v[24:27], v14, s[16:19], s26 offen
    s_waitcnt lgkmcnt(0)
    s_add_u32 s26, s22, 10240
    buffer_store_dwordx4 v[28:31], v14, s[16:19], s26 offen
    s_endpgm
P_q3:
    ds_read_b64_tr_b16 v[20:21], v12 offset:96
    ds_read_b64_tr_b16 v[22:23], v12 offset:528
    ds_read_b64_tr_b16 v[24:25], v12 offset:208
    ds_read_b64_tr_b16 v[26:27], v12 offset:640
    ds_read_b64_tr_b16 v[28:29], v12 offset:352
    ds_read_b64_tr_b16 v[30:31], v12 offset:784
    s_waitcnt lgkmcnt(4)
    s_add_u32 s26, s22, 3072
    buffer_store_dwordx4 v[20:23], v14, s[16:19], s26 offen
    s_waitcnt lgkmcnt(2)
    s_add_u32 s26, s22, 7168
    buffer_store_dwordx4 v[24:27], v14, s[16:19], s26 offen
    s_waitcnt lgkmcnt(0)
    s_add_u32 s26, s22, 11264
    buffer_store_dwordx4 v[28:31], v14, s[16:19], s26 offen
    s_endpgm
P_o:
    s_sub_u32 s5, s2, 288
    s_cmp_ge_u32 s5, 48
    s_cselect_b32 s6, 48, 0
    s_cselect_b64 s[8:9], s[42:43], s[36:37]
    s_mov_b32 s22, 25165824
    s_cselect_b32 s22, 27262976, s22
    s_mov_b32 s10, 663552
    s_sub_u32 s5, s5, s6
    s_mul_i32 s6, s5, 43
    s_lshr_b32 s6, s6, 8
    s_mul_i32 s7, s6, 6
    s_sub_u32 s7, s5, s7
    s_mul_i32 s23, s5, 13824
    s_add_u32 s22, s22, s23
    s_mul_i32 s24, s7, 110592
    s_mul_i32 s25, s6, 144
    s_add_u32 s24, s24, s25
    s_lshl_b32 s26, s4, 6
    s_add_u32 s26, s26, 0
    v_add_u32 v2, s26, v0
    v_cmp_gt_u32 vcc, 864, v2
    v_mul_u32_u24 v3, 7282, v2
    v_lshrrev_b32 v3, 16, v3
    v_mul_u32_u24 v4, 9, v3
    v_sub_u32 v2, v2, v4
    v_and_b32 v5, 0x78, v3
    v_bfe_u32 v6, v3, 1, 2
    v_or_b32 v5, v5, v6
    v_and_b32 v6, 1, v3
    v_lshl_or_b32 v5, v6, 2, v5
    v_mul_u32_u24 v5, 1152, v5
    v_lshl_add_u32 v5, v2, 4, v5
    v_cndmask_b32 v5, v16, v5, vcc
    s_lshl_b32 s26, s26, 4
    s_mov_b32 m0, s26
    s_nop 0
    buffer_load_dwordx4 v5, s[8:11], s24 offen lds
    s_lshl_b32 s26, s4, 6
    s_add_u32 s26, s26, 256
    v_add_u32 v2, s26, v0
    v_cmp_gt_u32 vcc, 864, v2
    v_mul_u32_u24 v3, 7282, v2
    v_lshrrev_b32 v3, 16, v3
    v_mul_u32_u24 v4, 9, v3
    v_sub_u32 v2, v2, v4
    v_and_b32 v5, 0x78, v3
    v_bfe_u32 v6, v3, 1, 2
    v_or_b32 v5, v5, v6
    v_and_b32 v6, 1, v3
    v_lshl_or_b32 v5, v6, 2, v5
    v_mul_u32_u24 v5, 1152, v5
    v_lshl_add_u32 v5, v2, 4, v5
    v_cndmask_b32 v5, v16, v5, vcc
    s_lshl_b32 s26, s26, 4
    s_mov_b32 m0, s26
    s_nop 0
    buffer_load_dwordx4 v5, s[8:11], s24 offen lds
    s_lshl_b32 s26, s4, 6
    s_add_u32 s26, s26, 512
    v_add_u32 v2, s26, v0
    v_cmp_gt_u32 vcc, 864, v2
    v_mul_u32_u24 v3, 7282, v2
    v_lshrrev_b32 v3, 16, v3
    v_mul_u32_u24 v4, 9, v3
    v_sub_u32 v2, v2, v4
    v_and_b32 v5, 0x78, v3
    v_bfe_u32 v6, v3, 1, 2
    v_or_b32 v5, v5, v6
    v_and_b32 v6, 1, v3
    v_lshl_or_b32 v5, v6, 2, v5
    v_mul_u32_u24 v5, 1152, v5
    v_lshl_add_u32 v5, v2, 4, v5
    v_cndmask_b32 v5, v16, v5, vcc
    s_lshl_b32 s26, s26, 4
    s_mov_b32 m0, s26
    s_nop 0
    buffer_load_dwordx4 v5, s[8:11], s24 offen lds
    s_lshl_b32 s26, s4, 6
    s_add_u32 s26, s26, 768
    v_add_u32 v2, s26, v0
    v_cmp_gt_u32 vcc, 864, v2
    v_mul_u32_u24 v3, 7282, v2
    v_lshrrev_b32 v3, 16, v3
    v_mul_u32_u24 v4, 9, v3
    v_sub_u32 v2, v2, v4
    v_and_b32 v5, 0x78, v3
    v_bfe_u32 v6, v3, 1, 2
    v_or_b32 v5, v5, v6
    v_and_b32 v6, 1, v3
    v_lshl_or_b32 v5, v6, 2, v5
    v_mul_u32_u24 v5, 1152, v5
    v_lshl_add_u32 v5, v2, 4, v5
    v_cndmask_b32 v5, v16, v5, vcc
    s_lshl_b32 s26, s26, 4
    s_mov_b32 m0, s26
    s_nop 0
    buffer_load_dwordx4 v5, s[8:11], s24 offen lds
    v_mul_u32_u24 v12, 144, v12
    v_add_u32 v12, v12, v13
    s_waitcnt vmcnt(0)
    s_barrier
    s_cmp_eq_u32 s4, 1
    s_cbranch_scc1 P_o1
    s_cmp_eq_u32 s4, 2
    s_cbranch_scc1 P_o2
    s_cmp_eq_u32 s4, 3
    s_cbranch_scc1 P_o3
P_o0:
    ds_read_b64_tr_b16 v[20:21], v12 offset:0
    ds_read_b64_tr_b16 v[22:23], v12 offset:144
    ds_read_b64_tr_b16 v[24:25], v12 offset:128
    ds_read_b64_tr_b16 v[26:27], v12 offset:272
    ds_read_b64_tr_b16 v[28:29], v12 offset:4704
    ds_read_b64_tr_b16 v[30:31], v12 offset:4848
    ds_read_b64_tr_b16 v[32:33], v12 offset:9280
    ds_read_b64_tr_b16 v[34:35], v12 offset:9424
    s_waitcnt lgkmcnt(6)
    s_add_u32 s26, s22, 0
    buffer_store_dwordx4 v[20:23], v14, s[16:19], s26 offen
    s_waitcnt lgkmcnt(4)
    s_add_u32 s26, s22, 4096
    s_mov_b64 exec, s[50:51]
    buffer_store_dwordx4 v[24:27], v15, s[16:19], s26 offen
    s_mov_b64 exec, -1
    s_waitcnt lgkmcnt(2)
    s_add_u32 s26, s22, 7680
    buffer_store_dwordx4 v[28:31], v14, s[16:19], s26 offen
    s_waitcnt lgkmcnt(0)
    s_add_u32 s26, s22, 11264
    buffer_store_dwordx4 v[32:35], v14, s[16:19], s26 offen
    s_endpgm
P_o1:
    ds_read_b64_tr_b16 v[20:21], v12 offset:32
    ds_read_b64_tr_b16 v[22:23], v12 offset:176
    ds_read_b64_tr_b16 v[24:25], v12 offset:4608
    ds_read_b64_tr_b16 v[26:27], v12 offset:4752
    ds_read_b64_tr_b16 v[28:29], v12 offset:4736
    ds_read_b64_tr_b16 v[30:31], v12 offset:4880
    ds_read_b64_tr_b16 v[32:33], v12 offset:9312
    ds_read_b64_tr_b16 v[34:35], v12 offset:9456
    s_waitcnt lgkmcnt(6)
    s_add_u32 s26, s22, 1024
    buffer_store_dwordx4 v[20:23], v14, s[16:19], s26 offen
    s_waitcnt lgkmcnt(4)
    s_add_u32 s26, s22, 4608
    buffer_store_dwordx4 v[24:27], v14, s[16:19], s26 offen
    s_waitcnt lgkmcnt(2)
    s_add_u32 s26, s22, 8704
    s_mov_b64 exec, s[50:51]
    buffer_store_dwordx4 v[28:31], v15, s[16:19], s26 offen
    s_mov_b64 exec, -1
    s_waitcnt lgkmcnt(0)
    s_add_u32 s26, s22, 12288
    buffer_store_dwordx4 v[32:35], v14, s[16:19], s26 offen
    s_endpgm
P_o2:
    ds_read_b64_tr_b16 v[20:21], v12 offset:64
    ds_read_b64_tr_b16 v[22:23], v12 offset:208
    ds_read_b64_tr_b16 v[24:25], v12 offset:4640
    ds_read_b64_tr_b16 v[26:27], v12 offset:4784
    ds_read_b64_tr_b16 v[28:29], v12 offset:9216
    ds_read_b64_tr_b16 v[30:31], v12 offset:9360
    ds_read_b64_tr_b16 v[32:33], v12 offset:9344
    ds_read_b64_tr_b16 v[34:35], v12 offset:9488
    s_waitcnt lgkmcnt(6)
    s_add_u32 s26, s22, 2048
    buffer_store_dwordx4 v[20:23], v14, s[16:19], s26 offen
    s_waitcnt lgkmcnt(4)
    s_add_u32 s26, s22, 5632
    buffer_store_dwordx4 v[24:27], v14, s[16:19], s26 offen
    s_waitcnt lgkmcnt(2)
    s_add_u32 s26, s22, 9216
    buffer_store_dwordx4 v[28:31], v14, s[16:19], s26 offen
    s_waitcnt lgkmcnt(0)
    s_add_u32 s26, s22, 13312
    s_mov_b64 exec, s[50:51]
    buffer_store_dwordx4 v[32:35], v15, s[16:19], s26 offen
    s_mov_b64 exec, -1
    s_endpgm
P_o3:
    ds_read_b64_tr_b16 v[20:21], v12 offset:96
    ds_read_b64_tr_b16 v[22:23], v12 offset:240
    ds_read_b64_tr_b16 v[24:25], v12 offset:4672
    ds_read_b64_tr_b16 v[26:27], v12 offset:4816
    ds_read_b64_tr_b16 v[28:29], v12 offset:9248
    ds_read_b64_tr_b16 v[30:31], v12 offset:9392
    s_waitcnt lgkmcnt(4)
    s_add_u32 s26, s22, 3072
    buffer_store_dwordx4 v[20:23], v14, s[16:19], s26 offen
    s_waitcnt lgkmcnt(2)
    s_add_u32 s26, s22, 6656
    buffer_store_dwordx4 v[24:27], v14, s[16:19], s26 offen
    s_waitcnt lgkmcnt(0)
    s_add_u32 s26, s22, 10240
    buffer_store_dwordx4 v[28:31], v14, s[16:19], s26 offen
    s_endpgm
P_cs:
    s_sub_u32 s5, s2, 384
    s_cmp_ge_u32 s5, 27
    s_cselect_b32 s6, 27, 0
    s_cselect_b64 s[8:9], s[40:41], s[34:35]
    s_mov_b32 s22, 28311552
    s_cselect_b32 s22, 28377088, s22
    s_mov_b32 s10, 1990656
    s_sub_u32 s5, s5, s6
    s_lshl_b32 s24, s5, 7
    s_lshl_b32 s23, s5, 8
    s_add_u32 s22, s22, s23
    s_lshl_b32 s6, s4, 3
    v_lshrrev_b32 v2, 3, v0
    v_add_u32 v2, s6, v2
    v_and_b32 v3, 7, v0
    v_mul_u32_u24 v4, 3456, v2
    v_lshl_add_u32 v4, v3, 4, v4
    buffer_load_dwordx4 v[24:27], v4, s[8:11], s24 offen
    s_add_u32 s24, s24, 110592
    buffer_load_dwordx4 v[28:31], v4, s[8:11], s24 offen
    s_add_u32 s24, s24, 110592
    buffer_load_dwordx4 v[32:35], v4, s[8:11], s24 offen
    s_add_u32 s24, s24, 110592
    buffer_load_dwordx4 v[36:39], v4, s[8:11], s24 offen
    s_add_u32 s24, s24, 110592
    buffer_load_dwordx4 v[40:43], v4, s[8:11], s24 offen
    s_add_u32 s24, s24, 110592
    buffer_load_dwordx4 v[44:47], v4, s[8:11], s24 offen
    s_add_u32 s24, s24, 110592
    buffer_load_dwordx4 v[48:51], v4, s[8:11], s24 offen
    s_add_u32 s24, s24, 110592
    buffer_load_dwordx4 v[52:55], v4, s[8:11], s24 offen
    s_add_u32 s24, s24, 110592
    buffer_load_dwordx4 v[56:59], v4, s[8:11], s24 offen
    s_add_u32 s24, s24, 110592
    buffer_load_dwordx4 v[60:63], v4, s[8:11], s24 offen
    s_add_u32 s24, s24, 110592
    buffer_load_dwordx4 v[64:67], v4, s[8:11], s24 offen
    s_add_u32 s24, s24, 110592
    buffer_load_dwordx4 v[68:71], v4, s[8:11], s24 offen
    s_add_u32 s24, s24, 110592
    buffer_load_dwordx4 v[72:75], v4, s[8:11], s24 offen
    s_add_u32 s24, s24, 110592
    buffer_load_dwordx4 v[76:79], v4, s[8:11], s24 offen
    s_add_u32 s24, s24, 110592
    buffer_load_dwordx4 v[80:83], v4, s[8:11], s24 offen
    s_add_u32 s24, s24, 110592
    buffer_load_dwordx4 v[84:87], v4, s[8:11], s24 offen
    s_add_u32 s24, s24, 110592
    buffer_load_dwordx4 v[88:91], v4, s[8:11], s24 offen
    s_add_u32 s24, s24, 110592
    buffer_load_dwordx4 v[92:95], v4, s[8:11], s24 offen
    s_add_u32 s24, s24, 110592
    v_mov_b32 v8, 0
    v_mov_b32 v9, 0
    v_mov_b32 v10, 0
    v_mov_b32 v11, 0
    v_mov_b32 v12, 0
    v_mov_b32 v13, 0
    v_mov_b32 v14, 0
    v_mov_b32 v15, 0
    s_waitcnt vmcnt(17)
    v_lshlrev_b32 v5, 16, v24
    v_and_b32 v6, 0xffff0000, v24
    v_add_f32 v8, v8, v5
    v_add_f32 v9, v9, v6
    v_lshlrev_b32 v5, 16, v25
    v_and_b32 v6, 0xffff0000, v25
    v_add_f32 v10, v10, v5
    v_add_f32 v11, v11, v6
    v_lshlrev_b32 v5, 16, v26
    v_and_b32 v6, 0xffff0000, v26
    v_add_f32 v12, v12, v5
    v_add_f32 v13, v13, v6
    v_lshlrev_b32 v5, 16, v27
    v_and_b32 v6, 0xffff0000, v27
    v_add_f32 v14, v14, v5
    v_add_f32 v15, v15, v6
    s_waitcnt vmcnt(16)
    v_lshlrev_b32 v5, 16, v28
    v_and_b32 v6, 0xffff0000, v28
    v_add_f32 v8, v8, v5
    v_add_f32 v9, v9, v6
    v_lshlrev_b32 v5, 16, v29
    v_and_b32 v6, 0xffff0000, v29
    v_add_f32 v10, v10, v5
    v_add_f32 v11, v11, v6
    v_lshlrev_b32 v5, 16, v30
    v_and_b32 v6, 0xffff0000, v30
    v_add_f32 v12, v12, v5
    v_add_f32 v13, v13, v6
    v_lshlrev_b32 v5, 16, v31
    v_and_b32 v6, 0xffff0000, v31
    v_add_f32 v14, v14, v5
    v_add_f32 v15, v15, v6
    s_waitcnt vmcnt(15)
    v_lshlrev_b32 v5, 16, v32
    v_and_b32 v6, 0xffff0000, v32
    v_add_f32 v8, v8, v5
    v_add_f32 v9, v9, v6
    v_lshlrev_b32 v5, 16, v33
    v_and_b32 v6, 0xffff0000, v33
    v_add_f32 v10, v10, v5
    v_add_f32 v11, v11, v6
    v_lshlrev_b32 v5, 16, v34
    v_and_b32 v6, 0xffff0000, v34
    v_add_f32 v12, v12, v5
    v_add_f32 v13, v13, v6
    v_lshlrev_b32 v5, 16, v35
    v_and_b32 v6, 0xffff0000, v35
    v_add_f32 v14, v14, v5
    v_add_f32 v15, v15, v6
    s_waitcnt vmcnt(14)
    v_lshlrev_b32 v5, 16, v36
    v_and_b32 v6, 0xffff0000, v36
    v_add_f32 v8, v8, v5
    v_add_f32 v9, v9, v6
    v_lshlrev_b32 v5, 16, v37
    v_and_b32 v6, 0xffff0000, v37
    v_add_f32 v10, v10, v5
    v_add_f32 v11, v11, v6
    v_lshlrev_b32 v5, 16, v38
    v_and_b32 v6, 0xffff0000, v38
    v_add_f32 v12, v12, v5
    v_add_f32 v13, v13, v6
    v_lshlrev_b32 v5, 16, v39
    v_and_b32 v6, 0xffff0000, v39
    v_add_f32 v14, v14, v5
    v_add_f32 v15, v15, v6
    s_waitcnt vmcnt(13)
    v_lshlrev_b32 v5, 16, v40
    v_and_b32 v6, 0xffff0000, v40
    v_add_f32 v8, v8, v5
    v_add_f32 v9, v9, v6
    v_lshlrev_b32 v5, 16, v41
    v_and_b32 v6, 0xffff0000, v41
    v_add_f32 v10, v10, v5
    v_add_f32 v11, v11, v6
    v_lshlrev_b32 v5, 16, v42
    v_and_b32 v6, 0xffff0000, v42
    v_add_f32 v12, v12, v5
    v_add_f32 v13, v13, v6
    v_lshlrev_b32 v5, 16, v43
    v_and_b32 v6, 0xffff0000, v43
    v_add_f32 v14, v14, v5
    v_add_f32 v15, v15, v6
    s_waitcnt vmcnt(12)
    v_lshlrev_b32 v5, 16, v44
    v_and_b32 v6, 0xffff0000, v44
    v_add_f32 v8, v8, v5
    v_add_f32 v9, v9, v6
    v_lshlrev_b32 v5, 16, v45
    v_and_b32 v6, 0xffff0000, v45
    v_add_f32 v10, v10, v5
    v_add_f32 v11, v11, v6
    v_lshlrev_b32 v5, 16, v46
    v_and_b32 v6, 0xffff0000, v46
    v_add_f32 v12, v12, v5
    v_add_f32 v13, v13, v6
    v_lshlrev_b32 v5, 16, v47
    v_and_b32 v6, 0xffff0000, v47
    v_add_f32 v14, v14, v5
    v_add_f32 v15, v15, v6
    s_waitcnt vmcnt(11)
    v_lshlrev_b32 v5, 16, v48
    v_and_b32 v6, 0xffff0000, v48
    v_add_f32 v8, v8, v5
    v_add_f32 v9, v9, v6
    v_lshlrev_b32 v5, 16, v49
    v_and_b32 v6, 0xffff0000, v49
    v_add_f32 v10, v10, v5
    v_add_f32 v11, v11, v6
    v_lshlrev_b32 v5, 16, v50
    v_and_b32 v6, 0xffff0000, v50
    v_add_f32 v12, v12, v5
    v_add_f32 v13, v13, v6
    v_lshlrev_b32 v5, 16, v51
    v_and_b32 v6, 0xffff0000, v51
    v_add_f32 v14, v14, v5
    v_add_f32 v15, v15, v6
    s_waitcnt vmcnt(10)
    v_lshlrev_b32 v5, 16, v52
    v_and_b32 v6, 0xffff0000, v52
    v_add_f32 v8, v8, v5
    v_add_f32 v9, v9, v6
    v_lshlrev_b32 v5, 16, v53
    v_and_b32 v6, 0xffff0000, v53
    v_add_f32 v10, v10, v5
    v_add_f32 v11, v11, v6
    v_lshlrev_b32 v5, 16, v54
    v_and_b32 v6, 0xffff0000, v54
    v_add_f32 v12, v12, v5
    v_add_f32 v13, v13, v6
    v_lshlrev_b32 v5, 16, v55
    v_and_b32 v6, 0xffff0000, v55
    v_add_f32 v14, v14, v5
    v_add_f32 v15, v15, v6
    s_waitcnt vmcnt(9)
    v_lshlrev_b32 v5, 16, v56
    v_and_b32 v6, 0xffff0000, v56
    v_add_f32 v8, v8, v5
    v_add_f32 v9, v9, v6
    v_lshlrev_b32 v5, 16, v57
    v_and_b32 v6, 0xffff0000, v57
    v_add_f32 v10, v10, v5
    v_add_f32 v11, v11, v6
    v_lshlrev_b32 v5, 16, v58
    v_and_b32 v6, 0xffff0000, v58
    v_add_f32 v12, v12, v5
    v_add_f32 v13, v13, v6
    v_lshlrev_b32 v5, 16, v59
    v_and_b32 v6, 0xffff0000, v59
    v_add_f32 v14, v14, v5
    v_add_f32 v15, v15, v6
    s_waitcnt vmcnt(8)
    v_lshlrev_b32 v5, 16, v60
    v_and_b32 v6, 0xffff0000, v60
    v_add_f32 v8, v8, v5
    v_add_f32 v9, v9, v6
    v_lshlrev_b32 v5, 16, v61
    v_and_b32 v6, 0xffff0000, v61
    v_add_f32 v10, v10, v5
    v_add_f32 v11, v11, v6
    v_lshlrev_b32 v5, 16, v62
    v_and_b32 v6, 0xffff0000, v62
    v_add_f32 v12, v12, v5
    v_add_f32 v13, v13, v6
    v_lshlrev_b32 v5, 16, v63
    v_and_b32 v6, 0xffff0000, v63
    v_add_f32 v14, v14, v5
    v_add_f32 v15, v15, v6
    s_waitcnt vmcnt(7)
    v_lshlrev_b32 v5, 16, v64
    v_and_b32 v6, 0xffff0000, v64
    v_add_f32 v8, v8, v5
    v_add_f32 v9, v9, v6
    v_lshlrev_b32 v5, 16, v65
    v_and_b32 v6, 0xffff0000, v65
    v_add_f32 v10, v10, v5
    v_add_f32 v11, v11, v6
    v_lshlrev_b32 v5, 16, v66
    v_and_b32 v6, 0xffff0000, v66
    v_add_f32 v12, v12, v5
    v_add_f32 v13, v13, v6
    v_lshlrev_b32 v5, 16, v67
    v_and_b32 v6, 0xffff0000, v67
    v_add_f32 v14, v14, v5
    v_add_f32 v15, v15, v6
    s_waitcnt vmcnt(6)
    v_lshlrev_b32 v5, 16, v68
    v_and_b32 v6, 0xffff0000, v68
    v_add_f32 v8, v8, v5
    v_add_f32 v9, v9, v6
    v_lshlrev_b32 v5, 16, v69
    v_and_b32 v6, 0xffff0000, v69
    v_add_f32 v10, v10, v5
    v_add_f32 v11, v11, v6
    v_lshlrev_b32 v5, 16, v70
    v_and_b32 v6, 0xffff0000, v70
    v_add_f32 v12, v12, v5
    v_add_f32 v13, v13, v6
    v_lshlrev_b32 v5, 16, v71
    v_and_b32 v6, 0xffff0000, v71
    v_add_f32 v14, v14, v5
    v_add_f32 v15, v15, v6
    s_waitcnt vmcnt(5)
    v_lshlrev_b32 v5, 16, v72
    v_and_b32 v6, 0xffff0000, v72
    v_add_f32 v8, v8, v5
    v_add_f32 v9, v9, v6
    v_lshlrev_b32 v5, 16, v73
    v_and_b32 v6, 0xffff0000, v73
    v_add_f32 v10, v10, v5
    v_add_f32 v11, v11, v6
    v_lshlrev_b32 v5, 16, v74
    v_and_b32 v6, 0xffff0000, v74
    v_add_f32 v12, v12, v5
    v_add_f32 v13, v13, v6
    v_lshlrev_b32 v5, 16, v75
    v_and_b32 v6, 0xffff0000, v75
    v_add_f32 v14, v14, v5
    v_add_f32 v15, v15, v6
    s_waitcnt vmcnt(4)
    v_lshlrev_b32 v5, 16, v76
    v_and_b32 v6, 0xffff0000, v76
    v_add_f32 v8, v8, v5
    v_add_f32 v9, v9, v6
    v_lshlrev_b32 v5, 16, v77
    v_and_b32 v6, 0xffff0000, v77
    v_add_f32 v10, v10, v5
    v_add_f32 v11, v11, v6
    v_lshlrev_b32 v5, 16, v78
    v_and_b32 v6, 0xffff0000, v78
    v_add_f32 v12, v12, v5
    v_add_f32 v13, v13, v6
    v_lshlrev_b32 v5, 16, v79
    v_and_b32 v6, 0xffff0000, v79
    v_add_f32 v14, v14, v5
    v_add_f32 v15, v15, v6
    s_waitcnt vmcnt(3)
    v_lshlrev_b32 v5, 16, v80
    v_and_b32 v6, 0xffff0000, v80
    v_add_f32 v8, v8, v5
    v_add_f32 v9, v9, v6
    v_lshlrev_b32 v5, 16, v81
    v_and_b32 v6, 0xffff0000, v81
    v_add_f32 v10, v10, v5
    v_add_f32 v11, v11, v6
    v_lshlrev_b32 v5, 16, v82
    v_and_b32 v6, 0xffff0000, v82
    v_add_f32 v12, v12, v5
    v_add_f32 v13, v13, v6
    v_lshlrev_b32 v5, 16, v83
    v_and_b32 v6, 0xffff0000, v83
    v_add_f32 v14, v14, v5
    v_add_f32 v15, v15, v6
    s_waitcnt vmcnt(2)
    v_lshlrev_b32 v5, 16, v84
    v_and_b32 v6, 0xffff0000, v84
    v_add_f32 v8, v8, v5
    v_add_f32 v9, v9, v6
    v_lshlrev_b32 v5, 16, v85
    v_and_b32 v6, 0xffff0000, v85
    v_add_f32 v10, v10, v5
    v_add_f32 v11, v11, v6
    v_lshlrev_b32 v5, 16, v86
    v_and_b32 v6, 0xffff0000, v86
    v_add_f32 v12, v12, v5
    v_add_f32 v13, v13, v6
    v_lshlrev_b32 v5, 16, v87
    v_and_b32 v6, 0xffff0000, v87
    v_add_f32 v14, v14, v5
    v_add_f32 v15, v15, v6
    s_waitcnt vmcnt(1)
    v_lshlrev_b32 v5, 16, v88
    v_and_b32 v6, 0xffff0000, v88
    v_add_f32 v8, v8, v5
    v_add_f32 v9, v9, v6
    v_lshlrev_b32 v5, 16, v89
    v_and_b32 v6, 0xffff0000, v89
    v_add_f32 v10, v10, v5
    v_add_f32 v11, v11, v6
    v_lshlrev_b32 v5, 16, v90
    v_and_b32 v6, 0xffff0000, v90
    v_add_f32 v12, v12, v5
    v_add_f32 v13, v13, v6
    v_lshlrev_b32 v5, 16, v91
    v_and_b32 v6, 0xffff0000, v91
    v_add_f32 v14, v14, v5
    v_add_f32 v15, v15, v6
    s_waitcnt vmcnt(0)
    v_lshlrev_b32 v5, 16, v92
    v_and_b32 v6, 0xffff0000, v92
    v_add_f32 v8, v8, v5
    v_add_f32 v9, v9, v6
    v_lshlrev_b32 v5, 16, v93
    v_and_b32 v6, 0xffff0000, v93
    v_add_f32 v10, v10, v5
    v_add_f32 v11, v11, v6
    v_lshlrev_b32 v5, 16, v94
    v_and_b32 v6, 0xffff0000, v94
    v_add_f32 v12, v12, v5
    v_add_f32 v13, v13, v6
    v_lshlrev_b32 v5, 16, v95
    v_and_b32 v6, 0xffff0000, v95
    v_add_f32 v14, v14, v5
    v_add_f32 v15, v15, v6
    v_lshlrev_b32 v5, 8, v2
    v_lshl_add_u32 v5, v3, 5, v5
    ds_write_b128 v5, v[8:11]
    ds_write_b128 v5, v[12:15] offset:16
    s_waitcnt lgkmcnt(0)
    s_barrier
    s_cmp_lg_u32 s4, 0
    s_cbranch_scc1 P_exit
    v_lshlrev_b32 v5, 2, v0
    ds_read_b32 v24, v5 offset:0
    ds_read_b32 v25, v5 offset:256
    ds_read_b32 v26, v5 offset:512
    ds_read_b32 v27, v5 offset:768
    ds_read_b32 v28, v5 offset:1024
    ds_read_b32 v29, v5 offset:1280
    ds_read_b32 v30, v5 offset:1536
    ds_read_b32 v31, v5 offset:1792
    ds_read_b32 v32, v5 offset:2048
    ds_read_b32 v33, v5 offset:2304
    ds_read_b32 v34, v5 offset:2560
    ds_read_b32 v35, v5 offset:2816
    ds_read_b32 v36, v5 offset:3072
    ds_read_b32 v37, v5 offset:3328
    ds_read_b32 v38, v5 offset:3584
    ds_read_b32 v39, v5 offset:3840
    ds_read_b32 v40, v5 offset:4096
    ds_read_b32 v41, v5 offset:4352
    ds_read_b32 v42, v5 offset:4608
    ds_read_b32 v43, v5 offset:4864
    ds_read_b32 v44, v5 offset:5120
    ds_read_b32 v45, v5 offset:5376
    ds_read_b32 v46, v5 offset:5632
    ds_read_b32 v47, v5 offset:5888
    ds_read_b32 v48, v5 offset:6144
    ds_read_b32 v49, v5 offset:6400
    ds_read_b32 v50, v5 offset:6656
    ds_read_b32 v51, v5 offset:6912
    ds_read_b32 v52, v5 offset:7168
    ds_read_b32 v53, v5 offset:7424
    ds_read_b32 v54, v5 offset:7680
    ds_read_b32 v55, v5 offset:7936
    s_waitcnt lgkmcnt(0)
    v_add_f32 v24, v24, v40
    v_add_f32 v25, v25, v41
    v_add_f32 v26, v26, v42
    v_add_f32 v27, v27, v43
    v_add_f32 v28, v28, v44
    v_add_f32 v29, v29, v45
    v_add_f32 v30, v30, v46
    v_add_f32 v31, v31, v47
    v_add_f32 v32, v32, v48
    v_add_f32 v33, v33, v49
    v_add_f32 v34, v34, v50
    v_add_f32 v35, v35, v51
    v_add_f32 v36, v36, v52
    v_add_f32 v37, v37, v53
    v_add_f32 v38, v38, v54
    v_add_f32 v39, v39, v55
    v_add_f32 v24, v24, v32
    v_add_f32 v25, v25, v33
    v_add_f32 v26, v26, v34
    v_add_f32 v27, v27, v35
    v_add_f32 v28, v28, v36
    v_add_f32 v29, v29, v37
    v_add_f32 v30, v30, v38
    v_add_f32 v31, v31, v39
    v_add_f32 v24, v24, v28
    v_add_f32 v25, v25, v29
    v_add_f32 v26, v26, v30
    v_add_f32 v27, v27, v31
    v_add_f32 v24, v24, v26
    v_add_f32 v25, v25, v27
    v_add_f32 v24, v24, v25
    buffer_store_dword v24, v5, s[16:19], s22 offen
    s_endpgm
P_flg:
    v_mov_b32 v8, 0
    v_mov_b32 v9, 0
    v_mov_b32 v10, 0
    v_mov_b32 v11, 0
    s_lshl_b32 s5, s4, 13
    s_add_u32 s5, s5, 28442624
    buffer_store_dwordx4 v[8:11], v14, s[16:19], s5 offen
    s_add_u32 s5, s5, 1024
    buffer_store_dwordx4 v[8:11], v14, s[16:19], s5 offen
    s_add_u32 s5, s5, 1024
    buffer_store_dwordx4 v[8:11], v14, s[16:19], s5 offen
    s_add_u32 s5, s5, 1024
    buffer_store_dwordx4 v[8:11], v14, s[16:19], s5 offen
    s_add_u32 s5, s5, 1024
    buffer_store_dwordx4 v[8:11], v14, s[16:19], s5 offen
    s_add_u32 s5, s5, 1024
    buffer_store_dwordx4 v[8:11], v14, s[16:19], s5 offen
    s_add_u32 s5, s5, 1024
    buffer_store_dwordx4 v[8:11], v14, s[16:19], s5 offen
    s_add_u32 s5, s5, 1024
    buffer_store_dwordx4 v[8:11], v14, s[16:19], s5 offen
    s_add_u32 s5, s5, 1024
    s_endpgm
P_warm:
    s_getpc_b64 s[20:21]
    s_add_u32 s20, s20, m_kernel - . + 4
    s_addc_u32 s21, s21, 0
    s_mul_i32 s5, s4, 12288
    v_add_u32 v2, s5, v14
    v_min_u32 v3, M_exit - m_kernel - 16, v2
    global_load_dwordx4 v[20:23], v3, s[20:21]
    v_add_u32 v2, 1024, v2
    v_min_u32 v3, M_exit - m_kernel - 16, v2
    global_load_dwordx4 v[24:27], v3, s[20:21]
    v_add_u32 v2, 1024, v2
    v_min_u32 v3, M_exit - m_kernel - 16, v2
    global_load_dwordx4 v[28:31], v3, s[20:21]
    v_add_u32 v2, 1024, v2
    v_min_u32 v3, M_exit - m_kernel - 16, v2
    global_load_dwordx4 v[32:35], v3, s[20:21]
    v_add_u32 v2, 1024, v2
    v_min_u32 v3, M_exit - m_kernel - 16, v2
    global_load_dwordx4 v[36:39], v3, s[20:21]
    v_add_u32 v2, 1024, v2
    v_min_u32 v3, M_exit - m_kernel - 16, v2
    global_load_dwordx4 v[40:43], v3, s[20:21]
    v_add_u32 v2, 1024, v2
    v_min_u32 v3, M_exit - m_kernel - 16, v2
    global_load_dwordx4 v[44:47], v3, s[20:21]
    v_add_u32 v2, 1024, v2
    v_min_u32 v3, M_exit - m_kernel - 16, v2
    global_load_dwordx4 v[48:51], v3, s[20:21]
    v_add_u32 v2, 1024, v2
    v_min_u32 v3, M_exit - m_kernel - 16, v2
    global_load_dwordx4 v[52:55], v3, s[20:21]
    v_add_u32 v2, 1024, v2
    v_min_u32 v3, M_exit - m_kernel - 16, v2
    global_load_dwordx4 v[56:59], v3, s[20:21]
    v_add_u32 v2, 1024, v2
    v_min_u32 v3, M_exit - m_kernel - 16, v2
    global_load_dwordx4 v[60:63], v3, s[20:21]
    v_add_u32 v2, 1024, v2
    v_min_u32 v3, M_exit - m_kernel - 16, v2
    global_load_dwordx4 v[64:67], v3, s[20:21]
    v_add_u32 v2, 1024, v2
    s_waitcnt vmcnt(0)
    s_endpgm
P_x:
    s_sub_u32 s5, s2, 439
    s_lshl_b32 s5, s5, 2
    s_add_u32 s5, s5, s4
    s_mul_i32 s6, s5, 7282
    s_lshr_b32 s6, s6, 16
    s_mul_i32 s7, s6, 9
    s_sub_u32 s7, s5, s7
    s_mov_b32 s8, s32
    s_mov_b32 s9, s33
    s_mov_b32 s10, 2359296
    s_lshr_b32 s22, s6, 4
    s_and_b32 s23, s6, 15
    s_mul_i32 s24, s23, 147456
    s_mul_i32 s25, s22, 1152
    s_add_u32 s24, s24, s25
    s_lshl_b32 s25, s7, 7
    s_add_u32 s24, s24, s25
    s_mul_i32 s26, s6, 73728
    s_lshl_b32 s25, s7, 13
    s_add_u32 s26, s26, s25
    s_add_u32 s26, s26, 0
    v_lshrrev_b32 v2, 3, v0
    v_and_b32 v3, 7, v0
    v_mul_u32_u24 v4, 2304, v2
    v_lshl_add_u32 v4, v3, 4, v4
    v_lshlrev_b32 v5, 10, v3
    v_lshl_add_u32 v5, v2, 4, v5
    buffer_load_dwordx4 v[20:23], v4, s[8:11], s24 offen
    s_add_u32 s24, s24, 18432
    buffer_load_dwordx4 v[24:27], v4, s[8:11], s24 offen
    s_add_u32 s24, s24, 18432
    buffer_load_dwordx4 v[28:31], v4, s[8:11], s24 offen
    s_add_u32 s24, s24, 18432
    buffer_load_dwordx4 v[32:35], v4, s[8:11], s24 offen
    s_add_u32 s24, s24, 18432
    buffer_load_dwordx4 v[36:39], v4, s[8:11], s24 offen
    s_add_u32 s24, s24, 18432
    buffer_load_dwordx4 v[40:43], v4, s[8:11], s24 offen
    s_add_u32 s24, s24, 18432
    buffer_load_dwordx4 v[44:47], v4, s[8:11], s24 offen
    s_add_u32 s24, s24, 18432
    buffer_load_dwordx4 v[48:51], v4, s[8:11], s24 offen
    s_add_u32 s24, s24, 18432
    s_waitcnt vmcnt(7)
    buffer_store_dwordx4 v[20:23], v5, s[16:19], s26 offen offset:0
    s_waitcnt vmcnt(7)
    buffer_store_dwordx4 v[24:27], v5, s[16:19], s26 offen offset:128
    s_waitcnt vmcnt(7)
    buffer_store_dwordx4 v[28:31], v5, s[16:19], s26 offen offset:256
    s_waitcnt vmcnt(7)
    buffer_store_dwordx4 v[32:35], v5, s[16:19], s26 offen offset:384
    s_waitcnt vmcnt(7)
    buffer_store_dwordx4 v[36:39], v5, s[16:19], s26 offen offset:512
    s_waitcnt vmcnt(7)
    buffer_store_dwordx4 v[40:43], v5, s[16:19], s26 offen offset:640
    s_waitcnt vmcnt(7)
    buffer_store_dwordx4 v[44:47], v5, s[16:19], s26 offen offset:768
    s_waitcnt vmcnt(7)
    buffer_store_dwordx4 v[48:51], v5, s[16:19], s26 offen offset:896
    v_mov_b32 v6, 0x3f803f80
    s_lshl_b32 s27, s6, 13
    s_lshl_b32 s25, s7, 9
    s_add_u32 s27, s27, s25
    s_add_u32 s27, s27, 29360128
    v_lshlrev_b32 v7, 3, v2
    v_cmp_eq_u32 s[52:53], 0, v3
    v_dot2_f32_bf16 v56, v20, v6, 0
    v_dot2_f32_bf16 v57, v20, v20, 0
    v_dot2_f32_bf16 v56, v21, v6, v56
    v_dot2_f32_bf16 v57, v21, v21, v57
    v_dot2_f32_bf16 v56, v22, v6, v56
    v_dot2_f32_bf16 v57, v22, v22, v57
    v_dot2_f32_bf16 v56, v23, v6, v56
    v_dot2_f32_bf16 v57, v23, v23, v57
    v_dot2_f32_bf16 v58, v24, v6, 0
    v_dot2_f32_bf16 v59, v24, v24, 0
    v_dot2_f32_bf16 v58, v25, v6, v58
    v_dot2_f32_bf16 v59, v25, v25, v59
    v_dot2_f32_bf16 v58, v26, v6, v58
    v_dot2_f32_bf16 v59, v26, v26, v59
    v_dot2_f32_bf16 v58, v27, v6, v58
    v_dot2_f32_bf16 v59, v27, v27, v59
    v_dot2_f32_bf16 v60, v28, v6, 0
    v_dot2_f32_bf16 v61, v28, v28, 0
    v_dot2_f32_bf16 v60, v29, v6, v60
    v_dot2_f32_bf16 v61, v29, v29, v61
    v_dot2_f32_bf16 v60, v30, v6, v60
    v_dot2_f32_bf16 v61, v30, v30, v61
    v_dot2_f32_bf16 v60, v31, v6, v60
    v_dot2_f32_bf16 v61, v31, v31, v61
    v_dot2_f32_bf16 v62, v32, v6, 0
    v_dot2_f32_bf16 v63, v32, v32, 0
    v_dot2_f32_bf16 v62, v33, v6, v62
    v_dot2_f32_bf16 v63, v33, v33, v63
    v_dot2_f32_bf16 v62, v34, v6, v62
    v_dot2_f32_bf16 v63, v34, v34, v63
    v_dot2_f32_bf16 v62, v35, v6, v62
    v_dot2_f32_bf16 v63, v35, v35, v63
    v_dot2_f32_bf16 v64, v36, v6, 0
    v_dot2_f32_bf16 v65, v36, v36, 0
    v_dot2_f32_bf16 v64, v37, v6, v64
    v_dot2_f32_bf16 v65, v37, v37, v65
    v_dot2_f32_bf16 v64, v38, v6, v64
    v_dot2_f32_bf16 v65, v38, v38, v65
    v_dot2_f32_bf16 v64, v39, v6, v64
    v_dot2_f32_bf16 v65, v39, v39, v65
    v_dot2_f32_bf16 v66, v40, v6, 0
    v_dot2_f32_bf16 v67, v40, v40, 0
    v_dot2_f32_bf16 v66, v41, v6, v66
    v_dot2_f32_bf16 v67, v41, v41, v67
    v_dot2_f32_bf16 v66, v42, v6, v66
    v_dot2_f32_bf16 v67, v42, v42, v67
    v_dot2_f32_bf16 v66, v43, v6, v66
    v_dot2_f32_bf16 v67, v43, v43, v67
    v_dot2_f32_bf16 v68, v44, v6, 0
    v_dot2_f32_bf16 v69, v44, v44, 0
    v_dot2_f32_bf16 v68, v45, v6, v68
    v_dot2_f32_bf16 v69, v45, v45, v69
    v_dot2_f32_bf16 v68, v46, v6, v68
    v_dot2_f32_bf16 v69, v46, v46, v69
    v_dot2_f32_bf16 v68, v47, v6, v68
    v_dot2_f32_bf16 v69, v47, v47, v69
    v_dot2_f32_bf16 v70, v48, v6, 0
    v_dot2_f32_bf16 v71, v48, v48, 0
    v_dot2_f32_bf16 v70, v49, v6, v70
    v_dot2_f32_bf16 v71, v49, v49, v71
    v_dot2_f32_bf16 v70, v50, v6, v70
    v_dot2_f32_bf16 v71, v50, v50, v71
    v_dot2_f32_bf16 v70, v51, v6, v70
    v_dot2_f32_bf16 v71, v51, v51, v71
    s_nop 3
    v_add_f32_dpp v56, v56, v56 quad_perm:[1,0,3,2] row_mask:0xf bank_mask:0xf
    v_add_f32_dpp v57, v57, v57 quad_perm:[1,0,3,2] row_mask:0xf bank_mask:0xf
    v_add_f32_dpp v58, v58, v58 quad_perm:[1,0,3,2] row_mask:0xf bank_mask:0xf
    v_add_f32_dpp v59, v59, v59 quad_perm:[1,0,3,2] row_mask:0xf bank_mask:0xf
    v_add_f32_dpp v60, v60, v60 quad_perm:[1,0,3,2] row_mask:0xf bank_mask:0xf
    v_add_f32_dpp v61, v61, v61 quad_perm:[1,0,3,2] row_mask:0xf bank_mask:0xf
    v_add_f32_dpp v62, v62, v62 quad_perm:[1,0,3,2] row_mask:0xf bank_mask:0xf
    v_add_f32_dpp v63, v63, v63 quad_perm:[1,0,3,2] row_mask:0xf bank_mask:0xf
    v_add_f32_dpp v64, v64, v64 quad_perm:[1,0,3,2] row_mask:0xf bank_mask:0xf
    v_add_f32_dpp v65, v65, v65 quad_perm:[1,0,3,2] row_mask:0xf bank_mask:0xf
    v_add_f32_dpp v66, v66, v66 quad_perm:[1,0,3,2] row_mask:0xf bank_mask:0xf
    v_add_f32_dpp v67, v67, v67 quad_perm:[1,0,3,2] row_mask:0xf bank_mask:0xf
    v_add_f32_dpp v68, v68, v68 quad_perm:[1,0,3,2] row_mask:0xf bank_mask:0xf
    v_add_f32_dpp v69, v69, v69 quad_perm:[1,0,3,2] row_mask:0xf bank_mask:0xf
    v_add_f32_dpp v70, v70, v70 quad_perm:[1,0,3,2] row_mask:0xf bank_mask:0xf
    v_add_f32_dpp v71, v71, v71 quad_perm:[1,0,3,2] row_mask:0xf bank_mask:0xf
    v_add_f32_dpp v56, v56, v56 quad_perm:[2,3,0,1] row_mask:0xf bank_mask:0xf
    v_add_f32_dpp v57, v57, v57 quad_perm:[2,3,0,1] row_mask:0xf bank_mask:0xf
    v_add_f32_dpp v58, v58, v58 quad_perm:[2,3,0,1] row_mask:0xf bank_mask:0xf
    v_add_f32_dpp v59, v59, v59 quad_perm:[2,3,0,1] row_mask:0xf bank_mask:0xf
    v_add_f32_dpp v60, v60, v60 quad_perm:[2,3,0,1] row_mask:0xf bank_mask:0xf
    v_add_f32_dpp v61, v61, v61 quad_perm:[2,3,0,1] row_mask:0xf bank_mask:0xf
    v_add_f32_dpp v62, v62, v62 quad_perm:[2,3,0,1] row_mask:0xf bank_mask:0xf
    v_add_f32_dpp v63, v63, v63 quad_perm:[2,3,0,1] row_mask:0xf bank_mask:0xf
    v_add_f32_dpp v64, v64, v64 quad_perm:[2,3,0,1] row_mask:0xf bank_mask:0xf
    v_add_f32_dpp v65, v65, v65 quad_perm:[2,3,0,1] row_mask:0xf bank_mask:0xf
    v_add_f32_dpp v66, v66, v66 quad_perm:[2,3,0,1] row_mask:0xf bank_mask:0xf
    v_add_f32_dpp v67, v67, v67 quad_perm:[2,3,0,1] row_mask:0xf bank_mask:0xf
    v_add_f32_dpp v68, v68, v68 quad_perm:[2,3,0,1] row_mask:0xf bank_mask:0xf
    v_add_f32_dpp v69, v69, v69 quad_perm:[2,3,0,1] row_mask:0xf bank_mask:0xf
    v_add_f32_dpp v70, v70, v70 quad_perm:[2,3,0,1] row_mask:0xf bank_mask:0xf
    v_add_f32_dpp v71, v71, v71 quad_perm:[2,3,0,1] row_mask:0xf bank_mask:0xf
    v_add_f32_dpp v56, v56, v56 row_half_mirror row_mask:0xf bank_mask:0xf
    v_add_f32_dpp v57, v57, v57 row_half_mirror row_mask:0xf bank_mask:0xf
    v_add_f32_dpp v58, v58, v58 row_half_mirror row_mask:0xf bank_mask:0xf
    v_add_f32_dpp v59, v59, v59 row_half_mirror row_mask:0xf bank_mask:0xf
    v_add_f32_dpp v60, v60, v60 row_half_mirror row_mask:0xf bank_mask:0xf
    v_add_f32_dpp v61, v61, v61 row_half_mirror row_mask:0xf bank_mask:0xf
    v_add_f32_dpp v62, v62, v62 row_half_mirror row_mask:0xf bank_mask:0xf
    v_add_f32_dpp v63, v63, v63 row_half_mirror row_mask:0xf bank_mask:0xf
    v_add_f32_dpp v64, v64, v64 row_half_mirror row_mask:0xf bank_mask:0xf
    v_add_f32_dpp v65, v65, v65 row_half_mirror row_mask:0xf bank_mask:0xf
    v_add_f32_dpp v66, v66, v66 row_half_mirror row_mask:0xf bank_mask:0xf
    v_add_f32_dpp v67, v67, v67 row_half_mirror row_mask:0xf bank_mask:0xf
    v_add_f32_dpp v68, v68, v68 row_half_mirror row_mask:0xf bank_mask:0xf
    v_add_f32_dpp v69, v69, v69 row_half_mirror row_mask:0xf bank_mask:0xf
    v_add_f32_dpp v70, v70, v70 row_half_mirror row_mask:0xf bank_mask:0xf
    v_add_f32_dpp v71, v71, v71 row_half_mirror row_mask:0xf bank_mask:0xf
    s_mov_b64 exec, s[52:53]
    buffer_store_dwordx2 v[56:57], v7, s[16:19], s27 offen offset:0
    buffer_store_dwordx2 v[58:59], v7, s[16:19], s27 offen offset:64
    buffer_store_dwordx2 v[60:61], v7, s[16:19], s27 offen offset:128
    buffer_store_dwordx2 v[62:63], v7, s[16:19], s27 offen offset:192
    buffer_store_dwordx2 v[64:65], v7, s[16:19], s27 offen offset:256
    buffer_store_dwordx2 v[66:67], v7, s[16:19], s27 offen offset:320
    buffer_store_dwordx2 v[68:69], v7, s[16:19], s27 offen offset:384
    buffer_store_dwordx2 v[70:71], v7, s[16:19], s27 offen offset:448
    s_mov_b64 exec, -1
    s_cmp_ge_u32 s7, 7
    s_cbranch_scc1 P_exit
    v_mov_b32 v8, 0
    v_mov_b32 v9, 0
    v_lshlrev_b32 v7, 3, v0
    s_add_u32 s27, s27, 4608
    buffer_store_dwordx2 v[8:9], v7, s[16:19], s27 offen
P_exit:
    s_endpgm
.globl m_kernel
.p2align 8
.type m_kernel,@function
m_kernel:
M_body:
    s_cmp_ge_u32 s2, 256
    s_cbranch_scc1 M_exit
    s_load_dwordx16 s[32:47], s[0:1], 0
    s_load_dwordx2 s[48:49], s[0:1], 64
    v_lshrrev_b32 v1, 6, v0
    v_and_b32 v0, 63, v0
    v_readfirstlane_b32 s4, v1
    s_and_b32 s5, s2, 7
    s_lshr_b32 s6, s2, 3
    s_and_b32 s7, s5, 1
    s_lshl_b32 s7, s7, 2
    s_and_b32 s20, s6, 3
    s_add_u32 s20, s20, s7
    s_lshr_b32 s7, s5, 1
    s_lshl_b32 s7, s7, 3
    s_lshr_b32 s21, s6, 2
    s_add_u32 s21, s21, s7
    s_lshr_b32 s22, s21, 4
    s_and_b32 s23, s21, 15
    s_mul_i32 s24, s21, 73728
    s_mul_i32 s25, s20, 144
    s_mov_b32 s3, 0
    s_mov_b32 s100, 0
    s_mov_b32 s101, 1
    v_mov_b32 v68, 0
    v_lshlrev_b32 v70, 4, v0
    s_lshl_b32 s26, s4, 10
    s_add_u32 s26, s26, 3072
    s_add_u32 s31, s4, 9
    s_mov_b32 s30, s4
    s_cmp_lt_u32 s4, 4
    s_cbranch_scc1 M_tiles_ok
    s_add_u32 s30, s4, 1
    s_cmp_lt_u32 s4, 6
    s_cselect_b32 s31, 13, 4
M_tiles_ok:
    s_lshl_b32 s5, s30, 10
    v_add_u32 v58, s5, v70
    s_lshl_b32 s5, s31, 10
    v_add_u32 v59, s5, v70
    v_and_b32 v2, 15, v0
    v_lshrrev_b32 v3, 4, v0
    v_and_b32 v8, 7, v0
    v_lshl_add_u32 v10, v3, 3, v8
    v_lshlrev_b32 v10, 4, v10
    s_cmp_lg_u32 s31, 13
    s_cbranch_scc1 M_nh
    v_add_u32 v59, 13312, v10
M_nh:
    v_lshlrev_b32 v6, 4, v2
    v_lshl_add_u32 v1, v3, 10, v6
    v_add_u32 v1, 3072, v1
    v_add_u32 v4, 36864, v1
    v_and_b32 v8, 0x70, v6
    v_lshl_add_u32 v5, v3, 7, v8
    v_add_u32 v5, 76800, v5
    v_lshrrev_b32 v8, 3, v0
    v_and_b32 v9, 7, v0
    v_lshlrev_b32 v9, 4, v9
    v_lshl_add_u32 v8, v8, 10, v9
    v_add_u32 v8, 896, v8
    v_bfrev_b32 v9, 1
    s_cmp_eq_u32 s23, 0
    s_cselect_b64 vcc, -1, 0
    s_and_b32 s6, s4, 3
    s_lshl_b32 s6, s6, 4
    v_cndmask_b32 v57, v8, v9, vcc
    v_add_u32 v8, s6, v2
    v_lshrrev_b32 v9, 1, v3
    v_lshlrev_b32 v9, 10, v9
    v_lshl_add_u32 v9, v8, 4, v9
    v_and_b32 v10, 1, v3
    v_lshl_add_u32 v9, v10, 3, v9
    s_lshr_b32 s7, s4, 2
    s_mul_i32 s5, s7, 6144
    v_add_u32 v67, s5, v9
    s_lshl_b32 s5, s23, 6
    v_add_u32 v8, s5, v8
    v_lshlrev_b32 v8, 1, v8
    v_add_u32 v8, s22, v8
    v_mul_u32_u24 v8, 1152, v8
    v_lshl_add_u32 v8, v3, 3, v8
    s_mul_i32 s7, s7, 96
    s_add_u32 s7, s7, s25
    v_add_u32 v66, s7, v8
    s_waitcnt lgkmcnt(0)
    s_mov_b32 s12, s48
    s_mov_b32 s13, s49
    s_mov_b32 s14, 33554432
    s_mov_b32 s15, 0x20000
    s_mov_b32 s16, s48
    s_mov_b32 s17, s49
    s_mov_b32 s18, 33554432
    s_mov_b32 s19, 0x20000
    s_mov_b32 s92, s44
    s_mov_b32 s93, s45
    s_mov_b32 s94, 2359296
    s_mov_b32 s95, 0x20000
    s_mul_i32 s96, s20, 248832
    s_add_u32 s28, s96, 23068672
    s_add_u32 s86, s96, 20971520
    s_mul_i32 s27, s3, 2621440
    s_add_u32 s27, s27, s24
    s_sub_u32 s85, s27, 73728
    s_lshl_b32 s5, s4, 10
    s_add_u32 s27, s27, s5
    s_max_i32 s85, s85, 0
    s_and_b32 s5, s3, 1
    s_cmp_eq_u32 s5, 0
    s_mov_b32 s89, 27262976
    s_cselect_b32 s89, 25165824, s89
    s_mul_i32 s5, s20, 82944
    s_add_u32 s89, s89, s5
    s_lshl_b32 s87, s4, 10
    s_add_u32 s87, s87, 5120
    s_cmp_lt_u32 s4, 4
    s_cbranch_scc1 M_PV
    s_cmp_eq_u32 s4, 4
    s_cbranch_scc1 M_S4
    s_cmp_eq_u32 s4, 5
    s_cbranch_scc1 M_S5
    s_cmp_eq_u32 s4, 6
    s_cbranch_scc1 M_S6
    s_branch M_S7
M_PV:
    v_mov_b32 v72, 0
    v_mov_b32 v73, 0
    v_mov_b32 v74, 0
    v_mov_b32 v75, 0
    v_mov_b32 v76, 0
    v_mov_b32 v77, 0
    v_mov_b32 v78, 0
    v_mov_b32 v79, 0
    v_mov_b32 v80, 0
    v_mov_b32 v81, 0
    v_mov_b32 v82, 0
    v_mov_b32 v83, 0
    v_mov_b32 v84, 0
    v_mov_b32 v85, 0
    v_mov_b32 v86, 0
    v_mov_b32 v87, 0
    v_mov_b32 v88, 0
    v_mov_b32 v89, 0
    v_mov_b32 v90, 0
    v_mov_b32 v91, 0
    v_mov_b32 v92, 0
    v_mov_b32 v93, 0
    v_mov_b32 v94, 0
    v_mov_b32 v95, 0
    v_mov_b32 v96, 0
    v_mov_b32 v97, 0
    v_mov_b32 v98, 0
    v_mov_b32 v99, 0
    v_mov_b32 v100, 0
    v_mov_b32 v101, 0
    v_mov_b32 v102, 0
    v_mov_b32 v103, 0
    v_mov_b32 v104, 0
    v_mov_b32 v105, 0
    v_mov_b32 v106, 0
    v_mov_b32 v107, 0
    s_setprio 3
    s_add_u32 m0, s26, 0
    s_nop 0
    buffer_load_dwordx4 v70, s[12:15], s27 offen sc1 lds
    s_add_u32 s27, s27, 8192
    buffer_load_dwordx4 v[112:115], v58, s[16:19], s86 offen
    buffer_load_dwordx4 v[116:119], v59, s[16:19], s86 offen
    s_add_u32 s86, s86, 13824
    buffer_load_dwordx4 v[120:123], v58, s[16:19], s86 offen
    buffer_load_dwordx4 v[124:127], v59, s[16:19], s86 offen
    s_add_u32 s86, s86, 13824
    s_setprio 2
    s_add_u32 m0, s26, 8192
    s_nop 0
    buffer_load_dwordx4 v70, s[12:15], s27 offen sc1 lds
    s_add_u32 s27, s27, 8192
    buffer_load_dwordx4 v[128:131], v58, s[16:19], s86 offen
    buffer_load_dwordx4 v[132:135], v59, s[16:19], s86 offen
    s_add_u32 s86, s86, 13824
    buffer_load_dwordx4 v[136:139], v58, s[16:19], s86 offen
    buffer_load_dwordx4 v[140:143], v59, s[16:19], s86 offen
    s_add_u32 s86, s86, 13824
    s_lshl_b32 s5, s3, 18
    s_lshl_b32 s6, s21, 13
    s_add_u32 s5, s5, s6
    s_add_u32 s5, s5, 29360128
    v_lshrrev_b32 v2, 3, v0
    v_and_b32 v3, 7, v0
    v_lshlrev_b32 v3, 4, v3
    v_lshl_add_u32 v2, v2, 9, v3
    s_lshl_b32 s6, s4, 7
    s_add_u32 s5, s5, s6
    buffer_load_dwordx4 v[88:91], v2, s[12:15], s5 offen sc1
    s_add_u32 s5, s5, 4096
    buffer_load_dwordx4 v[92:95], v2, s[12:15], s5 offen sc1
    s_setprio 1
    s_add_u32 m0, s26, 16384
    s_nop 0
    buffer_load_dwordx4 v70, s[12:15], s27 offen sc1 lds
    s_add_u32 s27, s27, 8192
    buffer_load_dwordx4 v[144:147], v58, s[16:19], s86 offen
    buffer_load_dwordx4 v[148:151], v59, s[16:19], s86 offen
    s_add_u32 s86, s86, 13824
    buffer_load_dwordx4 v[152:155], v58, s[16:19], s86 offen
    buffer_load_dwordx4 v[156:159], v59, s[16:19], s86 offen
    s_add_u32 s86, s86, 13824
    s_setprio 0
    s_add_u32 m0, s26, 24576
    s_nop 0
    buffer_load_dwordx4 v70, s[12:15], s27 offen sc1 lds
    s_add_u32 s27, s27, 8192
    buffer_load_dwordx4 v[160:163], v58, s[16:19], s86 offen
    buffer_load_dwordx4 v[164:167], v59, s[16:19], s86 offen
    s_add_u32 s86, s86, 13824
    buffer_load_dwordx4 v[168:171], v58, s[16:19], s86 offen
    buffer_load_dwordx4 v[172:175], v59, s[16:19], s86 offen
    s_add_u32 s86, s86, 13824
    s_setprio 0
    buffer_load_dwordx4 v[176:179], v58, s[16:19], s86 offen
    buffer_load_dwordx4 v[180:183], v59, s[16:19], s86 offen
    s_add_u32 s86, s86, 13824
    buffer_load_dwordx4 v[184:187], v58, s[16:19], s86 offen
    buffer_load_dwordx4 v[188:191], v59, s[16:19], s86 offen
    s_add_u32 s86, s86, 13824
    s_waitcnt vmcnt(25)
    s_barrier
    ds_read_b128 v[12:15], v1 offset:0
    ds_read_b128 v[16:19], v1 offset:256
    ds_read_b128 v[20:23], v1 offset:512
    ds_read_b128 v[24:27], v1 offset:768
    ds_read_b128 v[32:35], v1 offset:4096
    ds_read_b128 v[36:39], v1 offset:4352
    ds_read_b128 v[40:43], v1 offset:4608
    ds_read_b128 v[44:47], v1 offset:4864
    s_waitcnt lgkmcnt(4)
    s_waitcnt vmcnt(23)
    v_mfma_f32_16x16x32_bf16 v[72:75], v[112:115], v[12:15], v[72:75]
    v_mfma_f32_16x16x32_bf16 v[76:79], v[112:115], v[16:19], v[76:79]
    s_add_u32 m0, s26, 32768
    s_nop 0
    buffer_load_dwordx4 v70, s[12:15], s27 offen sc1 lds
    s_add_u32 s27, s27, 8192
    buffer_load_dwordx4 v[192:195], v58, s[16:19], s86 offen
    buffer_load_dwordx4 v[196:199], v59, s[16:19], s86 offen
    s_add_u32 s86, s86, 13824
    v_mfma_f32_16x16x32_bf16 v[80:83], v[112:115], v[20:23], v[80:83]
    v_mfma_f32_16x16x32_bf16 v[84:87], v[112:115], v[24:27], v[84:87]
    s_waitcnt vmcnt(16)
    s_barrier
    ds_read_b128 v[12:15], v1 offset:8192
    ds_read_b128 v[16:19], v1 offset:8448
    ds_read_b128 v[20:23], v1 offset:8704
    ds_read_b128 v[24:27], v1 offset:8960
    s_waitcnt lgkmcnt(4)
    v_mfma_f32_16x16x32_bf16 v[72:75], v[120:123], v[32:35], v[72:75]
    v_mfma_f32_16x16x32_bf16 v[76:79], v[120:123], v[36:39], v[76:79]
    buffer_load_dwordx4 v[200:203], v58, s[16:19], s86 offen
    buffer_load_dwordx4 v[204:207], v59, s[16:19], s86 offen
    s_add_u32 s86, s86, 13824
    v_mfma_f32_16x16x32_bf16 v[80:83], v[120:123], v[40:43], v[80:83]
    v_mfma_f32_16x16x32_bf16 v[84:87], v[120:123], v[44:47], v[84:87]
    ds_read_b128 v[32:35], v1 offset:12288
    ds_read_b128 v[36:39], v1 offset:12544
    ds_read_b128 v[40:43], v1 offset:12800
    ds_read_b128 v[44:47], v1 offset:13056
    s_waitcnt lgkmcnt(4)
    v_mfma_f32_16x16x32_bf16 v[72:75], v[128:131], v[12:15], v[72:75]
    v_add_f32 v88, v88, v92
    v_add_f32 v89, v89, v93
    v_add_f32 v90, v90, v94
    v_mfma_f32_16x16x32_bf16 v[76:79], v[128:131], v[16:19], v[76:79]
    v_add_f32 v91, v91, v95
    s_nop 1
    v_add_f32_dpp v88, v88, v88 row_ror:8 row_mask:0xf bank_mask:0xf
    s_add_u32 m0, s26, 40960
    s_nop 0
    buffer_load_dwordx4 v70, s[12:15], s27 offen sc1 lds
    s_add_u32 s27, s27, 8192
    buffer_load_dwordx4 v[208:211], v58, s[16:19], s86 offen
    buffer_load_dwordx4 v[212:215], v59, s[16:19], s86 offen
    s_add_u32 s86, s86, 13824
    v_mfma_f32_16x16x32_bf16 v[80:83], v[128:131], v[20:23], v[80:83]
    v_add_f32_dpp v89, v89, v89 row_ror:8 row_mask:0xf bank_mask:0xf
    v_add_f32_dpp v90, v90, v90 row_ror:8 row_mask:0xf bank_mask:0xf
    v_add_f32_dpp v91, v91, v91 row_ror:8 row_mask:0xf bank_mask:0xf
    v_mfma_f32_16x16x32_bf16 v[84:87], v[128:131], v[24:27], v[84:87]
    v_mov_b32 v92, v88
    v_mov_b32 v93, v89
    v_mov_b32 v94, v90
    ds_read_b128 v[12:15], v1 offset:16384
    ds_read_b128 v[16:19], v1 offset:16640
    ds_read_b128 v[20:23], v1 offset:16896
    ds_read_b128 v[24:27], v1 offset:17152
    s_waitcnt lgkmcnt(4)
    v_mfma_f32_16x16x32_bf16 v[72:75], v[136:139], v[32:35], v[72:75]
    v_mov_b32 v95, v91
    s_nop 1
    v_permlane16_swap_b32 v88, v92
    v_mfma_f32_16x16x32_bf16 v[76:79], v[136:139], v[36:39], v[76:79]
    v_permlane16_swap_b32 v89, v93
    v_permlane16_swap_b32 v90, v94
    v_permlane16_swap_b32 v91, v95
    buffer_load_dwordx4 v[216:219], v58, s[16:19], s86 offen
    buffer_load_dwordx4 v[220:223], v59, s[16:19], s86 offen
    s_add_u32 s86, s86, 13824
    v_mfma_f32_16x16x32_bf16 v[80:83], v[136:139], v[40:43], v[80:83]
    v_add_f32 v88, v88, v92
    v_add_f32 v89, v89, v93
    v_add_f32 v90, v90, v94
    v_mfma_f32_16x16x32_bf16 v[84:87], v[136:139], v[44:47], v[84:87]
    v_add_f32 v91, v91, v95
    v_mov_b32 v92, v88
    v_mov_b32 v93, v89
    ds_read_b128 v[32:35], v1 offset:20480
    ds_read_b128 v[36:39], v1 offset:20736
    ds_read_b128 v[40:43], v1 offset:20992
    ds_read_b128 v[44:47], v1 offset:21248
    s_waitcnt lgkmcnt(4)
    s_waitcnt vmcnt(21)
    v_mfma_f32_16x16x32_bf16 v[72:75], v[144:147], v[12:15], v[72:75]
    v_mov_b32 v94, v90
    v_mov_b32 v95, v91
    s_nop 1
    v_mfma_f32_16x16x32_bf16 v[76:79], v[144:147], v[16:19], v[76:79]
    v_permlane32_swap_b32 v88, v92
    v_permlane32_swap_b32 v89, v93
    v_permlane32_swap_b32 v90, v94
    s_add_u32 m0, s26, 49152
    s_nop 0
    buffer_load_dwordx4 v70, s[12:15], s27 offen sc1 lds
    s_add_u32 s27, s27, 8192
    buffer_load_dwordx4 v[224:227], v58, s[16:19], s86 offen
    buffer_load_dwordx4 v[228:231], v59, s[16:19], s86 offen
    s_add_u32 s86, s86, 13824
    v_mfma_f32_16x16x32_bf16 v[80:83], v[144:147], v[20:23], v[80:83]
    v_permlane32_swap_b32 v91, v95
    v_add_f32 v88, v88, v92
    v_add_f32 v89, v89, v93
    v_mfma_f32_16x16x32_bf16 v[84:87], v[144:147], v[24:27], v[84:87]
    v_add_f32 v90, v90, v94
    v_add_f32 v91, v91, v95
    s_mov_b32 s64, 0x3ae38e39
    s_waitcnt vmcnt(12)
    s_barrier
    ds_read_b128 v[12:15], v1 offset:24576
    ds_read_b128 v[16:19], v1 offset:24832
    ds_read_b128 v[20:23], v1 offset:25088
    ds_read_b128 v[24:27], v1 offset:25344
    s_waitcnt lgkmcnt(4)
    v_mfma_f32_16x16x32_bf16 v[72:75], v[152:155], v[32:35], v[72:75]
    s_mov_b32 s65, 0x3727c5ac
    v_mul_f32 v88, s64, v88
    v_mul_f32 v89, s64, v89
    v_mfma_f32_16x16x32_bf16 v[76:79], v[152:155], v[36:39], v[76:79]
    v_fma_f32 v89, -v88, v88, v89
    v_max_f32 v89, 0, v89
    v_add_f32 v89, s65, v89
    buffer_load_dwordx4 v[232:235], v58, s[16:19], s86 offen
    buffer_load_dwordx4 v[236:239], v59, s[16:19], s86 offen
    s_add_u32 s86, s86, 13824
    v_mfma_f32_16x16x32_bf16 v[80:83], v[152:155], v[40:43], v[80:83]
    v_rsq_f32 v89, v89
    v_mul_f32 v90, s64, v90
    v_mul_f32 v91, s64, v91
    v_mfma_f32_16x16x32_bf16 v[84:87], v[152:155], v[44:47], v[84:87]
    v_fma_f32 v91, -v90, v90, v91
    v_max_f32 v91, 0, v91
    v_add_f32 v91, s65, v91
    ds_read_b128 v[32:35], v1 offset:28672
    ds_read_b128 v[36:39], v1 offset:28928
    ds_read_b128 v[40:43], v1 offset:29184
    ds_read_b128 v[44:47], v1 offset:29440
    s_waitcnt lgkmcnt(4)
    v_mfma_f32_16x16x32_bf16 v[72:75], v[160:163], v[12:15], v[72:75]
    v_rsq_f32 v91, v91
    s_nop 0
    v_mul_f32 v88, v88, v89
    v_mfma_f32_16x16x32_bf16 v[76:79], v[160:163], v[16:19], v[76:79]
    v_mul_f32 v90, v90, v91
    s_lshl_b32 s64, s4, 6
    v_lshl_add_u32 v92, v0, 3, s64
    s_mov_b64 exec, 0xff
    ds_write2_b32 v92, v89, v91 offset0:16 offset1:17
    ds_write2_b32 v92, v88, v90 offset0:96 offset1:97
    s_mov_b64 exec, -1
    s_add_u32 m0, s26, 57344
    s_nop 0
    buffer_load_dwordx4 v70, s[12:15], s27 offen sc1 lds
    s_add_u32 s27, s27, 8192
    buffer_load_dwordx4 v[240:243], v58, s[16:19], s86 offen
    buffer_load_dwordx4 v[244:247], v59, s[16:19], s86 offen
    s_add_u32 s86, s86, 13824
    v_mfma_f32_16x16x32_bf16 v[80:83], v[160:163], v[20:23], v[80:83]
    v_mov_b32 v88, 0
    v_mov_b32 v89, 0
    v_mov_b32 v90, 0
    v_mfma_f32_16x16x32_bf16 v[84:87], v[160:163], v[24:27], v[84:87]
    v_mov_b32 v91, 0
    v_mov_b32 v92, 0
    v_mov_b32 v93, 0
    ds_read_b128 v[12:15], v1 offset:32768
    ds_read_b128 v[16:19], v1 offset:33024
    ds_read_b128 v[20:23], v1 offset:33280
    ds_read_b128 v[24:27], v1 offset:33536
    s_waitcnt lgkmcnt(4)
    v_mfma_f32_16x16x32_bf16 v[72:75], v[168:171], v[32:35], v[72:75]
    v_mov_b32 v94, 0
    v_mov_b32 v95, 0
    v_mfma_f32_16x16x32_bf16 v[76:79], v[168:171], v[36:39], v[76:79]
    buffer_load_dwordx4 v[248:251], v58, s[16:19], s86 offen
    buffer_load_dwordx4 v[252:255], v59, s[16:19], s86 offen
    s_add_u32 s86, s86, 13824
    v_mfma_f32_16x16x32_bf16 v[80:83], v[168:171], v[40:43], v[80:83]
    v_mfma_f32_16x16x32_bf16 v[84:87], v[168:171], v[44:47], v[84:87]
    ds_read_b128 v[32:35], v4 offset:0
    ds_read_b128 v[36:39], v4 offset:256
    ds_read_b128 v[40:43], v4 offset:512
    ds_read_b128 v[44:47], v4 offset:768
    s_waitcnt lgkmcnt(4)
    v_mfma_f32_16x16x32_bf16 v[72:75], v[176:179], v[12:15], v[72:75]
    v_mfma_f32_16x16x32_bf16 v[76:79], v[176:179], v[16:19], v[76:79]
    s_add_u32 m0, s26, 65536
    s_nop 0
    buffer_load_dwordx4 v70, s[12:15], s27 offen sc1 lds
    s_add_u32 s27, s27, 8192
    v_mfma_f32_16x16x32_bf16 v[80:83], v[176:179], v[20:23], v[80:83]
    v_mfma_f32_16x16x32_bf16 v[84:87], v[176:179], v[24:27], v[84:87]
    s_waitcnt vmcnt(10)
    s_barrier
    ds_read_b128 v[12:15], v4 offset:4096
    ds_read_b128 v[16:19], v4 offset:4352
    ds_read_b128 v[20:23], v4 offset:4608
    ds_read_b128 v[24:27], v4 offset:4864
    s_waitcnt lgkmcnt(4)
    v_mfma_f32_16x16x32_bf16 v[72:75], v[184:187], v[32:35], v[72:75]
    v_mfma_f32_16x16x32_bf16 v[76:79], v[184:187], v[36:39], v[76:79]
    v_mfma_f32_16x16x32_bf16 v[80:83], v[184:187], v[40:43], v[80:83]
    v_mfma_f32_16x16x32_bf16 v[84:87], v[184:187], v[44:47], v[84:87]
    ds_read_b128 v[32:35], v4 offset:8192
    ds_read_b128 v[36:39], v4 offset:8448
    ds_read_b128 v[40:43], v4 offset:8704
    ds_read_b128 v[44:47], v4 offset:8960
    s_waitcnt lgkmcnt(4)
    v_mfma_f32_16x16x32_bf16 v[72:75], v[192:195], v[12:15], v[72:75]
    v_mfma_f32_16x16x32_bf16 v[76:79], v[192:195], v[16:19], v[76:79]
    v_mfma_f32_16x16x32_bf16 v[80:83], v[192:195], v[20:23], v[80:83]
    v_mfma_f32_16x16x32_bf16 v[84:87], v[192:195], v[24:27], v[84:87]
    s_mul_i32 s5, s20, 9216
    s_add_u32 s5, s5, s24
    buffer_load_dwordx2 v[60:61], v67, s[12:15], s5 offen
    s_add_u32 s5, s5, 2048
    buffer_load_dwordx2 v[62:63], v67, s[12:15], s5 offen
    s_add_u32 s5, s5, 2048
    buffer_load_dwordx2 v[64:65], v67, s[12:15], s5 offen
    s_add_u32 s5, s5, 2048
    s_min_u32 s6, s87, 46080
    s_add_u32 m0, s6, 80896
    s_add_u32 s7, s6, s89
    buffer_load_dwordx4 v70, s[12:15], s7 offen lds
    s_add_u32 s87, s87, 7168
    ds_read_b128 v[12:15], v4 offset:12288
    ds_read_b128 v[16:19], v4 offset:12544
    ds_read_b128 v[20:23], v4 offset:12800
    ds_read_b128 v[24:27], v4 offset:13056
    s_waitcnt lgkmcnt(4)
    v_mfma_f32_16x16x32_bf16 v[72:75], v[200:203], v[32:35], v[72:75]
    v_mfma_f32_16x16x32_bf16 v[76:79], v[200:203], v[36:39], v[76:79]
    v_mfma_f32_16x16x32_bf16 v[80:83], v[200:203], v[40:43], v[80:83]
    v_mfma_f32_16x16x32_bf16 v[84:87], v[200:203], v[44:47], v[84:87]
    s_min_u32 s6, s87, 46080
    s_add_u32 m0, s6, 80896
    s_add_u32 s7, s6, s89
    buffer_load_dwordx4 v70, s[12:15], s7 offen lds
    s_add_u32 s87, s87, 7168
    ds_read_b128 v[32:35], v4 offset:16384
    ds_read_b128 v[36:39], v4 offset:16640
    ds_read_b128 v[40:43], v4 offset:16896
    ds_read_b128 v[44:47], v4 offset:17152
    s_waitcnt lgkmcnt(4)
    v_mfma_f32_16x16x32_bf16 v[72:75], v[208:211], v[12:15], v[72:75]
    v_mfma_f32_16x16x32_bf16 v[76:79], v[208:211], v[16:19], v[76:79]
    v_mfma_f32_16x16x32_bf16 v[80:83], v[208:211], v[20:23], v[80:83]
    v_mfma_f32_16x16x32_bf16 v[84:87], v[208:211], v[24:27], v[84:87]
    s_min_u32 s6, s87, 46080
    s_add_u32 m0, s6, 80896
    s_add_u32 s7, s6, s89
    buffer_load_dwordx4 v70, s[12:15], s7 offen lds
    s_add_u32 s87, s87, 7168
    s_waitcnt vmcnt(6)
    s_barrier
    ds_read_b128 v[12:15], v4 offset:20480
    ds_read_b128 v[16:19], v4 offset:20736
    ds_read_b128 v[20:23], v4 offset:20992
    ds_read_b128 v[24:27], v4 offset:21248
    s_waitcnt lgkmcnt(4)
    v_mfma_f32_16x16x32_bf16 v[72:75], v[216:219], v[32:35], v[72:75]
    v_mfma_f32_16x16x32_bf16 v[76:79], v[216:219], v[36:39], v[76:79]
    v_mfma_f32_16x16x32_bf16 v[80:83], v[216:219], v[40:43], v[80:83]
    v_mfma_f32_16x16x32_bf16 v[84:87], v[216:219], v[44:47], v[84:87]
    s_min_u32 s6, s87, 46080
    s_add_u32 m0, s6, 80896
    s_add_u32 s7, s6, s89
    buffer_load_dwordx4 v70, s[12:15], s7 offen lds
    s_add_u32 s87, s87, 7168
    ds_read_b128 v[32:35], v4 offset:24576
    ds_read_b128 v[36:39], v4 offset:24832
    ds_read_b128 v[40:43], v4 offset:25088
    ds_read_b128 v[44:47], v4 offset:25344
    s_waitcnt lgkmcnt(4)
    v_mfma_f32_16x16x32_bf16 v[72:75], v[224:227], v[12:15], v[72:75]
    v_mfma_f32_16x16x32_bf16 v[76:79], v[224:227], v[16:19], v[76:79]
    v_mfma_f32_16x16x32_bf16 v[80:83], v[224:227], v[20:23], v[80:83]
    v_mfma_f32_16x16x32_bf16 v[84:87], v[224:227], v[24:27], v[84:87]
    s_min_u32 s6, s87, 46080
    s_add_u32 m0, s6, 80896
    s_add_u32 s7, s6, s89
    buffer_load_dwordx4 v70, s[12:15], s7 offen lds
    s_add_u32 s87, s87, 7168
    ds_read_b128 v[12:15], v4 offset:28672
    ds_read_b128 v[16:19], v4 offset:28928
    ds_read_b128 v[20:23], v4 offset:29184
    ds_read_b128 v[24:27], v4 offset:29440
    s_waitcnt lgkmcnt(4)
    v_mfma_f32_16x16x32_bf16 v[72:75], v[232:235], v[32:35], v[72:75]
    v_mfma_f32_16x16x32_bf16 v[76:79], v[232:235], v[36:39], v[76:79]
    v_mfma_f32_16x16x32_bf16 v[80:83], v[232:235], v[40:43], v[80:83]
    v_mfma_f32_16x16x32_bf16 v[84:87], v[232:235], v[44:47], v[84:87]
    s_min_u32 s6, s87, 46080
    s_add_u32 m0, s6, 80896
    s_add_u32 s7, s6, s89
    buffer_load_dwordx4 v70, s[12:15], s7 offen lds
    s_add_u32 s87, s87, 7168
    ds_read_b128 v[32:35], v4 offset:32768
    ds_read_b128 v[36:39], v4 offset:33024
    ds_read_b128 v[40:43], v4 offset:33280
    ds_read_b128 v[44:47], v4 offset:33536
    s_waitcnt lgkmcnt(4)
    v_mfma_f32_16x16x32_bf16 v[72:75], v[240:243], v[12:15], v[72:75]
    v_and_b32 v2, 15, v0
    v_lshrrev_b32 v3, 4, v0
    v_lshlrev_b32 v224, 2, v2
    v_mfma_f32_16x16x32_bf16 v[76:79], v[240:243], v[16:19], v[76:79]
    v_lshlrev_b32 v225, 4, v3
    v_lshlrev_b32 v6, 3, v0
    s_mul_i32 s5, s30, 2560
    v_mfma_f32_16x16x32_bf16 v[80:83], v[240:243], v[20:23], v[80:83]
    s_add_u32 s5, s5, 128000
    v_add_u32 v226, s5, v6
    s_mul_i32 s5, s31, 2560
    v_mfma_f32_16x16x32_bf16 v[84:87], v[240:243], v[24:27], v[84:87]
    s_add_u32 s5, s5, 128000
    v_add_u32 v227, s5, v6
    s_and_b32 s7, s3, 1
    ds_read_b128 v[8:11], v5 offset:0
    ds_read_b128 v[12:15], v1 offset:0
    ds_read_b128 v[16:19], v1 offset:256
    ds_read_b128 v[20:23], v1 offset:512
    ds_read_b128 v[24:27], v1 offset:768
    s_waitcnt lgkmcnt(5)
    v_mfma_f32_16x16x32_bf16 v[72:75], v[248:251], v[32:35], v[72:75]
    s_mul_i32 s7, s7, 896
    s_add_u32 s7, s7, 640
    s_lshl_b32 s5, s4, 6
    v_mfma_f32_16x16x32_bf16 v[76:79], v[248:251], v[36:39], v[76:79]
    s_add_u32 s5, s5, s7
    v_add_u32 v232, s5, v225
    s_add_u32 s5, s5, 576
    v_mfma_f32_16x16x32_bf16 v[80:83], v[248:251], v[40:43], v[80:83]
    v_add_u32 v233, s5, v224
    v_mfma_f32_16x16x32_bf16 v[84:87], v[248:251], v[44:47], v[84:87]
    s_setprio 1
    s_branch M_PV_epi
M_PV_loop:
    v_mov_b32 v72, 0
    v_mov_b32 v73, 0
    v_mov_b32 v74, 0
    v_mov_b32 v75, 0
    v_mov_b32 v76, 0
    v_mov_b32 v77, 0
    v_mov_b32 v78, 0
    v_mov_b32 v79, 0
    v_mov_b32 v80, 0
    v_mov_b32 v81, 0
    v_mov_b32 v82, 0
    v_mov_b32 v83, 0
    v_mov_b32 v84, 0
    v_mov_b32 v85, 0
    v_mov_b32 v86, 0
    v_mov_b32 v87, 0
    v_mov_b32 v88, 0
    v_mov_b32 v89, 0
    v_mov_b32 v90, 0
    v_mov_b32 v91, 0
    v_mov_b32 v92, 0
    v_mov_b32 v93, 0
    v_mov_b32 v94, 0
    v_mov_b32 v95, 0
    v_mov_b32 v96, 0
    v_mov_b32 v97, 0
    v_mov_b32 v98, 0
    v_mov_b32 v99, 0
    v_mov_b32 v100, 0
    v_mov_b32 v101, 0
    v_mov_b32 v102, 0
    v_mov_b32 v103, 0
    v_mov_b32 v104, 0
    v_mov_b32 v105, 0
    v_mov_b32 v106, 0
    v_mov_b32 v107, 0
    s_setprio 3
    s_add_u32 m0, s26, 0
    s_nop 0
    buffer_load_dwordx4 v70, s[12:15], s27 offen sc1 lds
    s_add_u32 s27, s27, 8192
    s_setprio 2
    s_add_u32 m0, s26, 8192
    s_nop 0
    buffer_load_dwordx4 v70, s[12:15], s27 offen sc1 lds
    s_add_u32 s27, s27, 8192
    s_lshl_b32 s5, s3, 18
    s_lshl_b32 s6, s21, 13
    s_add_u32 s5, s5, s6
    s_add_u32 s5, s5, 29360128
    v_lshrrev_b32 v2, 3, v0
    v_and_b32 v3, 7, v0
    v_lshlrev_b32 v3, 4, v3
    v_lshl_add_u32 v2, v2, 9, v3
    s_lshl_b32 s6, s4, 7
    s_add_u32 s5, s5, s6
    buffer_load_dwordx4 v[88:91], v2, s[12:15], s5 offen sc1
    s_add_u32 s5, s5, 4096
    buffer_load_dwordx4 v[92:95], v2, s[12:15], s5 offen sc1
    s_setprio 1
    s_add_u32 m0, s26, 16384
    s_nop 0
    buffer_load_dwordx4 v70, s[12:15], s27 offen sc1 lds
    s_add_u32 s27, s27, 8192
    s_setprio 0
    s_add_u32 m0, s26, 24576
    s_nop 0
    buffer_load_dwordx4 v70, s[12:15], s27 offen sc1 lds
    s_add_u32 s27, s27, 8192
    s_waitcnt vmcnt(5)
    s_barrier
    ds_read_b128 v[12:15], v1 offset:0
    ds_read_b128 v[16:19], v1 offset:256
    ds_read_b128 v[20:23], v1 offset:512
    ds_read_b128 v[24:27], v1 offset:768
    ds_read_b128 v[32:35], v1 offset:4096
    ds_read_b128 v[36:39], v1 offset:4352
    ds_read_b128 v[40:43], v1 offset:4608
    ds_read_b128 v[44:47], v1 offset:4864
    s_waitcnt lgkmcnt(4)
    v_mfma_f32_16x16x32_bf16 v[72:75], v[112:115], v[12:15], v[72:75]
    v_mfma_f32_16x16x32_bf16 v[76:79], v[112:115], v[16:19], v[76:79]
    s_add_u32 m0, s26, 32768
    s_nop 0
    buffer_load_dwordx4 v70, s[12:15], s27 offen sc1 lds
    s_add_u32 s27, s27, 8192
    v_mfma_f32_16x16x32_bf16 v[80:83], v[112:115], v[20:23], v[80:83]
    v_mfma_f32_16x16x32_bf16 v[84:87], v[112:115], v[24:27], v[84:87]
    s_waitcnt vmcnt(2)
    s_barrier
    ds_read_b128 v[12:15], v1 offset:8192
    ds_read_b128 v[16:19], v1 offset:8448
    ds_read_b128 v[20:23], v1 offset:8704
    ds_read_b128 v[24:27], v1 offset:8960
    s_waitcnt lgkmcnt(4)
    v_mfma_f32_16x16x32_bf16 v[72:75], v[120:123], v[32:35], v[72:75]
    v_mfma_f32_16x16x32_bf16 v[76:79], v[120:123], v[36:39], v[76:79]
    v_mfma_f32_16x16x32_bf16 v[80:83], v[120:123], v[40:43], v[80:83]
    v_mfma_f32_16x16x32_bf16 v[84:87], v[120:123], v[44:47], v[84:87]
    ds_read_b128 v[32:35], v1 offset:12288
    ds_read_b128 v[36:39], v1 offset:12544
    ds_read_b128 v[40:43], v1 offset:12800
    ds_read_b128 v[44:47], v1 offset:13056
    s_waitcnt lgkmcnt(4)
    v_mfma_f32_16x16x32_bf16 v[72:75], v[128:131], v[12:15], v[72:75]
    v_add_f32 v88, v88, v92
    v_add_f32 v89, v89, v93
    v_add_f32 v90, v90, v94
    v_mfma_f32_16x16x32_bf16 v[76:79], v[128:131], v[16:19], v[76:79]
    v_add_f32 v91, v91, v95
    s_nop 1
    v_add_f32_dpp v88, v88, v88 row_ror:8 row_mask:0xf bank_mask:0xf
    s_add_u32 m0, s26, 40960
    s_nop 0
    buffer_load_dwordx4 v70, s[12:15], s27 offen sc1 lds
    s_add_u32 s27, s27, 8192
    v_mfma_f32_16x16x32_bf16 v[80:83], v[128:131], v[20:23], v[80:83]
    v_add_f32_dpp v89, v89, v89 row_ror:8 row_mask:0xf bank_mask:0xf
    v_add_f32_dpp v90, v90, v90 row_ror:8 row_mask:0xf bank_mask:0xf
    v_add_f32_dpp v91, v91, v91 row_ror:8 row_mask:0xf bank_mask:0xf
    v_mfma_f32_16x16x32_bf16 v[84:87], v[128:131], v[24:27], v[84:87]
    v_mov_b32 v92, v88
    v_mov_b32 v93, v89
    v_mov_b32 v94, v90
    ds_read_b128 v[12:15], v1 offset:16384
    ds_read_b128 v[16:19], v1 offset:16640
    ds_read_b128 v[20:23], v1 offset:16896
    ds_read_b128 v[24:27], v1 offset:17152
    s_waitcnt lgkmcnt(4)
    v_mfma_f32_16x16x32_bf16 v[72:75], v[136:139], v[32:35], v[72:75]
    v_mov_b32 v95, v91
    s_nop 1
    v_permlane16_swap_b32 v88, v92
    v_mfma_f32_16x16x32_bf16 v[76:79], v[136:139], v[36:39], v[76:79]
    v_permlane16_swap_b32 v89, v93
    v_permlane16_swap_b32 v90, v94
    v_permlane16_swap_b32 v91, v95
    v_mfma_f32_16x16x32_bf16 v[80:83], v[136:139], v[40:43], v[80:83]
    v_add_f32 v88, v88, v92
    v_add_f32 v89, v89, v93
    v_add_f32 v90, v90, v94
    v_mfma_f32_16x16x32_bf16 v[84:87], v[136:139], v[44:47], v[84:87]
    v_add_f32 v91, v91, v95
    v_mov_b32 v92, v88
    v_mov_b32 v93, v89
    ds_read_b128 v[32:35], v1 offset:20480
    ds_read_b128 v[36:39], v1 offset:20736
    ds_read_b128 v[40:43], v1 offset:20992
    ds_read_b128 v[44:47], v1 offset:21248
    s_waitcnt lgkmcnt(4)
    v_mfma_f32_16x16x32_bf16 v[72:75], v[144:147], v[12:15], v[72:75]
    v_mov_b32 v94, v90
    v_mov_b32 v95, v91
    s_nop 1
    v_mfma_f32_16x16x32_bf16 v[76:79], v[144:147], v[16:19], v[76:79]
    v_permlane32_swap_b32 v88, v92
    v_permlane32_swap_b32 v89, v93
    v_permlane32_swap_b32 v90, v94
    s_add_u32 m0, s26, 49152
    s_nop 0
    buffer_load_dwordx4 v70, s[12:15], s27 offen sc1 lds
    s_add_u32 s27, s27, 8192
    v_mfma_f32_16x16x32_bf16 v[80:83], v[144:147], v[20:23], v[80:83]
    v_permlane32_swap_b32 v91, v95
    v_add_f32 v88, v88, v92
    v_add_f32 v89, v89, v93
    v_mfma_f32_16x16x32_bf16 v[84:87], v[144:147], v[24:27], v[84:87]
    v_add_f32 v90, v90, v94
    v_add_f32 v91, v91, v95
    s_mov_b32 s64, 0x3ae38e39
    s_waitcnt vmcnt(2)
    s_barrier
    ds_read_b128 v[12:15], v1 offset:24576
    ds_read_b128 v[16:19], v1 offset:24832
    ds_read_b128 v[20:23], v1 offset:25088
    ds_read_b128 v[24:27], v1 offset:25344
    s_waitcnt lgkmcnt(4)
    v_mfma_f32_16x16x32_bf16 v[72:75], v[152:155], v[32:35], v[72:75]
    s_mov_b32 s65, 0x3727c5ac
    v_mul_f32 v88, s64, v88
    v_mul_f32 v89, s64, v89
    v_mfma_f32_16x16x32_bf16 v[76:79], v[152:155], v[36:39], v[76:79]
    v_fma_f32 v89, -v88, v88, v89
    v_max_f32 v89, 0, v89
    v_add_f32 v89, s65, v89
    v_mfma_f32_16x16x32_bf16 v[80:83], v[152:155], v[40:43], v[80:83]
    v_rsq_f32 v89, v89
    v_mul_f32 v90, s64, v90
    v_mul_f32 v91, s64, v91
    v_mfma_f32_16x16x32_bf16 v[84:87], v[152:155], v[44:47], v[84:87]
    v_fma_f32 v91, -v90, v90, v91
    v_max_f32 v91, 0, v91
    v_add_f32 v91, s65, v91
    ds_read_b128 v[32:35], v1 offset:28672
    ds_read_b128 v[36:39], v1 offset:28928
    ds_read_b128 v[40:43], v1 offset:29184
    ds_read_b128 v[44:47], v1 offset:29440
    s_waitcnt lgkmcnt(4)
    v_mfma_f32_16x16x32_bf16 v[72:75], v[160:163], v[12:15], v[72:75]
    v_rsq_f32 v91, v91
    s_nop 0
    v_mul_f32 v88, v88, v89
    v_mfma_f32_16x16x32_bf16 v[76:79], v[160:163], v[16:19], v[76:79]
    v_mul_f32 v90, v90, v91
    s_lshl_b32 s64, s4, 6
    v_lshl_add_u32 v92, v0, 3, s64
    s_mov_b64 exec, 0xff
    ds_write2_b32 v92, v89, v91 offset0:16 offset1:17
    ds_write2_b32 v92, v88, v90 offset0:96 offset1:97
    s_mov_b64 exec, -1
    s_add_u32 m0, s26, 57344
    s_nop 0
    buffer_load_dwordx4 v70, s[12:15], s27 offen sc1 lds
    s_add_u32 s27, s27, 8192
    v_mfma_f32_16x16x32_bf16 v[80:83], v[160:163], v[20:23], v[80:83]
    v_mov_b32 v88, 0
    v_mov_b32 v89, 0
    v_mov_b32 v90, 0
    v_mfma_f32_16x16x32_bf16 v[84:87], v[160:163], v[24:27], v[84:87]
    v_mov_b32 v91, 0
    v_mov_b32 v92, 0
    v_mov_b32 v93, 0
    s_add_u32 s84, s28, 0
    buffer_load_dwordx4 v[112:115], v58, s[16:19], s84 offen
    ds_read_b128 v[12:15], v1 offset:32768
    ds_read_b128 v[16:19], v1 offset:33024
    ds_read_b128 v[20:23], v1 offset:33280
    ds_read_b128 v[24:27], v1 offset:33536
    s_waitcnt lgkmcnt(4)
    v_mfma_f32_16x16x32_bf16 v[72:75], v[168:171], v[32:35], v[72:75]
    v_mov_b32 v94, 0
    v_mov_b32 v95, 0
    v_mfma_f32_16x16x32_bf16 v[76:79], v[168:171], v[36:39], v[76:79]
    v_mfma_f32_16x16x32_bf16 v[80:83], v[168:171], v[40:43], v[80:83]
    v_mfma_f32_16x16x32_bf16 v[84:87], v[168:171], v[44:47], v[84:87]
    s_add_u32 s84, s28, 13824
    buffer_load_dwordx4 v[120:123], v58, s[16:19], s84 offen
    ds_read_b128 v[32:35], v4 offset:0
    ds_read_b128 v[36:39], v4 offset:256
    ds_read_b128 v[40:43], v4 offset:512
    ds_read_b128 v[44:47], v4 offset:768
    s_waitcnt lgkmcnt(4)
    v_mfma_f32_16x16x32_bf16 v[72:75], v[176:179], v[12:15], v[72:75]
    v_mfma_f32_16x16x32_bf16 v[76:79], v[176:179], v[16:19], v[76:79]
    s_add_u32 m0, s26, 65536
    s_nop 0
    buffer_load_dwordx4 v70, s[12:15], s27 offen sc1 lds
    s_add_u32 s27, s27, 8192
    v_mfma_f32_16x16x32_bf16 v[80:83], v[176:179], v[20:23], v[80:83]
    v_mfma_f32_16x16x32_bf16 v[84:87], v[176:179], v[24:27], v[84:87]
    s_add_u32 s84, s28, 27648
    buffer_load_dwordx4 v[128:131], v58, s[16:19], s84 offen
    s_waitcnt vmcnt(5)
    s_barrier
    ds_read_b128 v[12:15], v4 offset:4096
    ds_read_b128 v[16:19], v4 offset:4352
    ds_read_b128 v[20:23], v4 offset:4608
    ds_read_b128 v[24:27], v4 offset:4864
    s_waitcnt lgkmcnt(4)
    v_mfma_f32_16x16x32_bf16 v[72:75], v[184:187], v[32:35], v[72:75]
    v_mfma_f32_16x16x32_bf16 v[76:79], v[184:187], v[36:39], v[76:79]
    v_mfma_f32_16x16x32_bf16 v[80:83], v[184:187], v[40:43], v[80:83]
    v_mfma_f32_16x16x32_bf16 v[84:87], v[184:187], v[44:47], v[84:87]
    s_add_u32 s84, s28, 41472
    buffer_load_dwordx4 v[136:139], v58, s[16:19], s84 offen
    ds_read_b128 v[32:35], v4 offset:8192
    ds_read_b128 v[36:39], v4 offset:8448
    ds_read_b128 v[40:43], v4 offset:8704
    ds_read_b128 v[44:47], v4 offset:8960
    s_waitcnt lgkmcnt(4)
    v_mfma_f32_16x16x32_bf16 v[72:75], v[192:195], v[12:15], v[72:75]
    v_mfma_f32_16x16x32_bf16 v[76:79], v[192:195], v[16:19], v[76:79]
    v_mfma_f32_16x16x32_bf16 v[80:83], v[192:195], v[20:23], v[80:83]
    v_mfma_f32_16x16x32_bf16 v[84:87], v[192:195], v[24:27], v[84:87]
    s_add_u32 s84, s28, 55296
    buffer_load_dwordx4 v[144:147], v58, s[16:19], s84 offen
    ds_read_b128 v[12:15], v4 offset:12288
    ds_read_b128 v[16:19], v4 offset:12544
    ds_read_b128 v[20:23], v4 offset:12800
    ds_read_b128 v[24:27], v4 offset:13056
    s_waitcnt lgkmcnt(4)
    v_mfma_f32_16x16x32_bf16 v[72:75], v[200:203], v[32:35], v[72:75]
    v_mfma_f32_16x16x32_bf16 v[76:79], v[200:203], v[36:39], v[76:79]
    v_mfma_f32_16x16x32_bf16 v[80:83], v[200:203], v[40:43], v[80:83]
    v_mfma_f32_16x16x32_bf16 v[84:87], v[200:203], v[44:47], v[84:87]
    s_add_u32 s84, s28, 69120
    buffer_load_dwordx4 v[152:155], v58, s[16:19], s84 offen
    ds_read_b128 v[32:35], v4 offset:16384
    ds_read_b128 v[36:39], v4 offset:16640
    ds_read_b128 v[40:43], v4 offset:16896
    ds_read_b128 v[44:47], v4 offset:17152
    s_waitcnt lgkmcnt(4)
    v_mfma_f32_16x16x32_bf16 v[72:75], v[208:211], v[12:15], v[72:75]
    v_mfma_f32_16x16x32_bf16 v[76:79], v[208:211], v[16:19], v[76:79]
    v_mfma_f32_16x16x32_bf16 v[80:83], v[208:211], v[20:23], v[80:83]
    v_mfma_f32_16x16x32_bf16 v[84:87], v[208:211], v[24:27], v[84:87]
    s_add_u32 s84, s28, 82944
    buffer_load_dwordx4 v[160:163], v58, s[16:19], s84 offen
    s_waitcnt vmcnt(5)
    s_barrier
    ds_read_b128 v[12:15], v4 offset:20480
    ds_read_b128 v[16:19], v4 offset:20736
    ds_read_b128 v[20:23], v4 offset:20992
    ds_read_b128 v[24:27], v4 offset:21248
    s_waitcnt lgkmcnt(4)
    v_mfma_f32_16x16x32_bf16 v[72:75], v[216:219], v[32:35], v[72:75]
    v_mfma_f32_16x16x32_bf16 v[76:79], v[216:219], v[36:39], v[76:79]
    v_mfma_f32_16x16x32_bf16 v[80:83], v[216:219], v[40:43], v[80:83]
    v_mfma_f32_16x16x32_bf16 v[84:87], v[216:219], v[44:47], v[84:87]
    s_add_u32 s84, s28, 96768
    buffer_load_dwordx4 v[168:171], v58, s[16:19], s84 offen
    ds_read_b128 v[32:35], v4 offset:24576
    ds_read_b128 v[36:39], v4 offset:24832
    ds_read_b128 v[40:43], v4 offset:25088
    ds_read_b128 v[44:47], v4 offset:25344
    s_waitcnt lgkmcnt(4)
    v_mfma_f32_16x16x32_bf16 v[72:75], v[224:227], v[12:15], v[72:75]
    v_mfma_f32_16x16x32_bf16 v[76:79], v[224:227], v[16:19], v[76:79]
    v_mfma_f32_16x16x32_bf16 v[80:83], v[224:227], v[20:23], v[80:83]
    v_mfma_f32_16x16x32_bf16 v[84:87], v[224:227], v[24:27], v[84:87]
    s_add_u32 s84, s28, 110592
    buffer_load_dwordx4 v[176:179], v58, s[16:19], s84 offen
    ds_read_b128 v[12:15], v4 offset:28672
    ds_read_b128 v[16:19], v4 offset:28928
    ds_read_b128 v[20:23], v4 offset:29184
    ds_read_b128 v[24:27], v4 offset:29440
    s_waitcnt lgkmcnt(4)
    v_mfma_f32_16x16x32_bf16 v[72:75], v[232:235], v[32:35], v[72:75]
    v_mfma_f32_16x16x32_bf16 v[76:79], v[232:235], v[36:39], v[76:79]
    v_mfma_f32_16x16x32_bf16 v[80:83], v[232:235], v[40:43], v[80:83]
    v_mfma_f32_16x16x32_bf16 v[84:87], v[232:235], v[44:47], v[84:87]
    s_add_u32 s84, s28, 124416
    buffer_load_dwordx4 v[184:187], v58, s[16:19], s84 offen
    ds_read_b128 v[32:35], v4 offset:32768
    ds_read_b128 v[36:39], v4 offset:33024
    ds_read_b128 v[40:43], v4 offset:33280
    ds_read_b128 v[44:47], v4 offset:33536
    s_waitcnt lgkmcnt(4)
    v_mfma_f32_16x16x32_bf16 v[72:75], v[240:243], v[12:15], v[72:75]
    v_and_b32 v2, 15, v0
    v_lshrrev_b32 v3, 4, v0
    v_lshlrev_b32 v224, 2, v2
    v_mfma_f32_16x16x32_bf16 v[76:79], v[240:243], v[16:19], v[76:79]
    v_lshlrev_b32 v225, 4, v3
    v_lshlrev_b32 v6, 3, v0
    s_mul_i32 s5, s30, 2560
    v_mfma_f32_16x16x32_bf16 v[80:83], v[240:243], v[20:23], v[80:83]
    s_add_u32 s5, s5, 128000
    v_add_u32 v226, s5, v6
    s_mul_i32 s5, s31, 2560
    v_mfma_f32_16x16x32_bf16 v[84:87], v[240:243], v[24:27], v[84:87]
    s_add_u32 s5, s5, 128000
    v_add_u32 v227, s5, v6
    s_and_b32 s7, s3, 1
    ds_read_b128 v[8:11], v5 offset:0
    ds_read_b128 v[12:15], v1 offset:0
    ds_read_b128 v[16:19], v1 offset:256
    ds_read_b128 v[20:23], v1 offset:512
    ds_read_b128 v[24:27], v1 offset:768
    s_waitcnt lgkmcnt(5)
    v_mfma_f32_16x16x32_bf16 v[72:75], v[248:251], v[32:35], v[72:75]
    s_mul_i32 s7, s7, 896
    s_add_u32 s7, s7, 640
    s_lshl_b32 s5, s4, 6
    v_mfma_f32_16x16x32_bf16 v[76:79], v[248:251], v[36:39], v[76:79]
    s_add_u32 s5, s5, s7
    v_add_u32 v232, s5, v225
    s_add_u32 s5, s5, 576
    v_mfma_f32_16x16x32_bf16 v[80:83], v[248:251], v[40:43], v[80:83]
    v_add_u32 v233, s5, v224
    v_mfma_f32_16x16x32_bf16 v[84:87], v[248:251], v[44:47], v[84:87]
    s_setprio 1
M_PV_epi:
    ds_read_b128 v[200:203], v232
    ds_read2_b32 v[208:209], v224 offset0:16 offset1:96
    ds_read2_b32 v[210:211], v224 offset0:32 offset1:112
    ds_read2_b32 v[216:217], v224 offset0:48 offset1:128
    ds_read2_b32 v[218:219], v224 offset0:64 offset1:144
    ds_read_b128 v[28:31], v5 offset:512
    ds_read_b128 v[32:35], v1 offset:4096
    ds_read_b128 v[36:39], v1 offset:4352
    ds_read_b128 v[40:43], v1 offset:4608
    ds_read_b128 v[44:47], v1 offset:4864
    s_waitcnt lgkmcnt(5)
    v_mfma_f32_16x16x32_bf16 v[88:91], v[8:11], v[116:119], v[88:91]
    v_mfma_f32_16x16x32_bf16 v[92:95], v[12:15], v[116:119], v[92:95]
    v_mfma_f32_16x16x32_bf16 v[96:99], v[16:19], v[116:119], v[96:99]
    v_mul_f32 v72, v72, v208
    v_mul_f32 v73, v73, v208
    v_mul_f32 v74, v74, v208
    v_mul_f32 v75, v75, v208
    v_mfma_f32_16x16x32_bf16 v[100:103], v[20:23], v[116:119], v[100:103]
    v_mul_f32 v76, v76, v210
    v_mul_f32 v77, v77, v210
    v_mul_f32 v78, v78, v210
    v_mul_f32 v79, v79, v210
    v_mfma_f32_16x16x32_bf16 v[104:107], v[24:27], v[116:119], v[104:107]
    v_mul_f32 v80, v80, v216
    v_mul_f32 v81, v81, v216
    v_mul_f32 v82, v82, v216
    v_mul_f32 v83, v83, v216
    ds_read_b128 v[8:11], v5 offset:1024
    ds_read_b128 v[12:15], v1 offset:8192
    ds_read_b128 v[16:19], v1 offset:8448
    ds_read_b128 v[20:23], v1 offset:8704
    ds_read_b128 v[24:27], v1 offset:8960
    s_waitcnt lgkmcnt(5)
    v_mfma_f32_16x16x32_bf16 v[88:91], v[28:31], v[124:127], v[88:91]
    v_mul_f32 v84, v84, v218
    v_mul_f32 v85, v85, v218
    v_mul_f32 v86, v86, v218
    v_mul_f32 v87, v87, v218
    v_mfma_f32_16x16x32_bf16 v[92:95], v[32:35], v[124:127], v[92:95]
    v_fma_f32 v72, -v209, v200, v72
    v_fma_f32 v73, -v209, v201, v73
    v_fma_f32 v74, -v209, v202, v74
    v_fma_f32 v75, -v209, v203, v75
    v_mfma_f32_16x16x32_bf16 v[96:99], v[36:39], v[124:127], v[96:99]
    v_fma_f32 v76, -v211, v200, v76
    v_fma_f32 v77, -v211, v201, v77
    v_fma_f32 v78, -v211, v202, v78
    v_fma_f32 v79, -v211, v203, v79
    v_mfma_f32_16x16x32_bf16 v[100:103], v[40:43], v[124:127], v[100:103]
    v_fma_f32 v80, -v217, v200, v80
    v_fma_f32 v81, -v217, v201, v81
    v_fma_f32 v82, -v217, v202, v82
    v_fma_f32 v83, -v217, v203, v83
    v_mfma_f32_16x16x32_bf16 v[104:107], v[44:47], v[124:127], v[104:107]
    v_fma_f32 v84, -v219, v200, v84
    v_fma_f32 v85, -v219, v201, v85
    v_fma_f32 v86, -v219, v202, v86
    v_fma_f32 v87, -v219, v203, v87
    ds_read_b128 v[28:31], v5 offset:1536
    ds_read_b128 v[32:35], v1 offset:12288
    ds_read_b128 v[36:39], v1 offset:12544
    ds_read_b128 v[40:43], v1 offset:12800
    ds_read_b128 v[44:47], v1 offset:13056
    s_waitcnt lgkmcnt(5)
    v_mfma_f32_16x16x32_bf16 v[88:91], v[8:11], v[132:135], v[88:91]
    v_cvt_pk_bf16_f32 v72, v72, v73
    v_cvt_pk_bf16_f32 v73, v74, v75
    ds_write_b64 v226, v[72:73] offset:512
    v_cvt_pk_bf16_f32 v76, v76, v77
    v_mfma_f32_16x16x32_bf16 v[92:95], v[12:15], v[132:135], v[92:95]
    v_cvt_pk_bf16_f32 v77, v78, v79
    ds_write_b64 v226, v[76:77] offset:1024
    v_cvt_pk_bf16_f32 v80, v80, v81
    v_cvt_pk_bf16_f32 v81, v82, v83
    v_mfma_f32_16x16x32_bf16 v[96:99], v[16:19], v[132:135], v[96:99]
    ds_write_b64 v226, v[80:81] offset:1536
    v_cvt_pk_bf16_f32 v84, v84, v85
    v_cvt_pk_bf16_f32 v85, v86, v87
    ds_write_b64 v226, v[84:85] offset:2048
    v_mfma_f32_16x16x32_bf16 v[100:103], v[20:23], v[132:135], v[100:103]
    v_mfma_f32_16x16x32_bf16 v[104:107], v[24:27], v[132:135], v[104:107]
    ds_read_b128 v[72:75], v5 offset:2048
    ds_read_b128 v[76:79], v1 offset:16384
    ds_read_b128 v[80:83], v1 offset:16640
    ds_read_b128 v[84:87], v1 offset:16896
    ds_read_b128 v[108:111], v1 offset:17152
    ds_read_b128 v[8:11], v5 offset:2560
    ds_read_b128 v[12:15], v1 offset:20480
    ds_read_b128 v[16:19], v1 offset:20736
    ds_read_b128 v[20:23], v1 offset:20992
    ds_read_b128 v[24:27], v1 offset:21248
    s_waitcnt lgkmcnt(10)
    v_mfma_f32_16x16x32_bf16 v[88:91], v[28:31], v[140:143], v[88:91]
    v_mfma_f32_16x16x32_bf16 v[92:95], v[32:35], v[140:143], v[92:95]
    v_mfma_f32_16x16x32_bf16 v[96:99], v[36:39], v[140:143], v[96:99]
    v_mfma_f32_16x16x32_bf16 v[100:103], v[40:43], v[140:143], v[100:103]
    v_mfma_f32_16x16x32_bf16 v[104:107], v[44:47], v[140:143], v[104:107]
    s_add_u32 s84, s28, 0
    buffer_load_dwordx4 v[116:119], v59, s[16:19], s84 offen
    ds_read_b128 v[28:31], v5 offset:3072
    ds_read_b128 v[32:35], v1 offset:24576
    ds_read_b128 v[36:39], v1 offset:24832
    ds_read_b128 v[40:43], v1 offset:25088
    ds_read_b128 v[44:47], v1 offset:25344
    s_waitcnt lgkmcnt(10)
    v_mfma_f32_16x16x32_bf16 v[88:91], v[72:75], v[148:151], v[88:91]
    v_mfma_f32_16x16x32_bf16 v[92:95], v[76:79], v[148:151], v[92:95]
    v_mfma_f32_16x16x32_bf16 v[96:99], v[80:83], v[148:151], v[96:99]
    v_mfma_f32_16x16x32_bf16 v[100:103], v[84:87], v[148:151], v[100:103]
    v_mfma_f32_16x16x32_bf16 v[104:107], v[108:111], v[148:151], v[104:107]
    s_add_u32 s84, s28, 13824
    buffer_load_dwordx4 v[124:127], v59, s[16:19], s84 offen
    s_add_u32 s84, s28, 138240
    buffer_load_dwordx4 v[192:195], v58, s[16:19], s84 offen
    ds_read_b128 v[72:75], v5 offset:3584
    ds_read_b128 v[76:79], v1 offset:28672
    ds_read_b128 v[80:83], v1 offset:28928
    ds_read_b128 v[84:87], v1 offset:29184
    ds_read_b128 v[108:111], v1 offset:29440
    s_waitcnt lgkmcnt(10)
    s_barrier
    v_mfma_f32_16x16x32_bf16 v[88:91], v[8:11], v[156:159], v[88:91]
    v_mfma_f32_16x16x32_bf16 v[92:95], v[12:15], v[156:159], v[92:95]
    v_mfma_f32_16x16x32_bf16 v[96:99], v[16:19], v[156:159], v[96:99]
    v_mfma_f32_16x16x32_bf16 v[100:103], v[20:23], v[156:159], v[100:103]
    v_mfma_f32_16x16x32_bf16 v[104:107], v[24:27], v[156:159], v[104:107]
    s_add_u32 s84, s28, 27648
    buffer_load_dwordx4 v[132:135], v59, s[16:19], s84 offen
    ds_read_b128 v[8:11], v5 offset:4096
    ds_read_b128 v[12:15], v1 offset:32768
    ds_read_b128 v[16:19], v1 offset:33024
    ds_read_b128 v[20:23], v1 offset:33280
    ds_read_b128 v[24:27], v1 offset:33536
    s_waitcnt lgkmcnt(10)
    v_mfma_f32_16x16x32_bf16 v[88:91], v[28:31], v[164:167], v[88:91]
    v_mfma_f32_16x16x32_bf16 v[92:95], v[32:35], v[164:167], v[92:95]
    v_mfma_f32_16x16x32_bf16 v[96:99], v[36:39], v[164:167], v[96:99]
    v_mfma_f32_16x16x32_bf16 v[100:103], v[40:43], v[164:167], v[100:103]
    v_mfma_f32_16x16x32_bf16 v[104:107], v[44:47], v[164:167], v[104:107]
    s_add_u32 s84, s28, 41472
    buffer_load_dwordx4 v[140:143], v59, s[16:19], s84 offen
    s_add_u32 s84, s28, 221184
    buffer_load_dwordx4 v[240:243], v58, s[16:19], s84 offen
    ds_read_b128 v[28:31], v5 offset:4608
    ds_read_b128 v[32:35], v4 offset:0
    ds_read_b128 v[36:39], v4 offset:256
    ds_read_b128 v[40:43], v4 offset:512
    ds_read_b128 v[44:47], v4 offset:768
    s_waitcnt lgkmcnt(10)
    v_mfma_f32_16x16x32_bf16 v[88:91], v[72:75], v[172:175], v[88:91]
    v_mfma_f32_16x16x32_bf16 v[92:95], v[76:79], v[172:175], v[92:95]
    v_mfma_f32_16x16x32_bf16 v[96:99], v[80:83], v[172:175], v[96:99]
    v_mfma_f32_16x16x32_bf16 v[100:103], v[84:87], v[172:175], v[100:103]
    v_mfma_f32_16x16x32_bf16 v[104:107], v[108:111], v[172:175], v[104:107]
    s_add_u32 s84, s28, 55296
    buffer_load_dwordx4 v[148:151], v59, s[16:19], s84 offen
    ds_read_b128 v[72:75], v5 offset:5120
    ds_read_b128 v[76:79], v4 offset:4096
    ds_read_b128 v[80:83], v4 offset:4352
    ds_read_b128 v[84:87], v4 offset:4608
    ds_read_b128 v[108:111], v4 offset:4864
    s_waitcnt lgkmcnt(10)
    v_mfma_f32_16x16x32_bf16 v[88:91], v[8:11], v[180:183], v[88:91]
    v_mfma_f32_16x16x32_bf16 v[92:95], v[12:15], v[180:183], v[92:95]
    v_mfma_f32_16x16x32_bf16 v[96:99], v[16:19], v[180:183], v[96:99]
    v_mfma_f32_16x16x32_bf16 v[100:103], v[20:23], v[180:183], v[100:103]
    v_mfma_f32_16x16x32_bf16 v[104:107], v[24:27], v[180:183], v[104:107]
    s_add_u32 s84, s28, 69120
    buffer_load_dwordx4 v[156:159], v59, s[16:19], s84 offen
    s_add_u32 s84, s28, 235008
    buffer_load_dwordx4 v[248:251], v58, s[16:19], s84 offen
    ds_read_b128 v[8:11], v5 offset:5632
    ds_read_b128 v[12:15], v4 offset:8192
    ds_read_b128 v[16:19], v4 offset:8448
    ds_read_b128 v[20:23], v4 offset:8704
    ds_read_b128 v[24:27], v4 offset:8960
    s_waitcnt lgkmcnt(10)
    v_mfma_f32_16x16x32_bf16 v[88:91], v[28:31], v[188:191], v[88:91]
    v_mfma_f32_16x16x32_bf16 v[92:95], v[32:35], v[188:191], v[92:95]
    v_mfma_f32_16x16x32_bf16 v[96:99], v[36:39], v[188:191], v[96:99]
    v_mfma_f32_16x16x32_bf16 v[100:103], v[40:43], v[188:191], v[100:103]
    v_mfma_f32_16x16x32_bf16 v[104:107], v[44:47], v[188:191], v[104:107]
    s_add_u32 s84, s28, 82944
    buffer_load_dwordx4 v[164:167], v59, s[16:19], s84 offen
    ds_read_b128 v[28:31], v5 offset:6144
    ds_read_b128 v[32:35], v4 offset:12288
    ds_read_b128 v[36:39], v4 offset:12544
    ds_read_b128 v[40:43], v4 offset:12800
    ds_read_b128 v[44:47], v4 offset:13056
    s_waitcnt lgkmcnt(10)
    v_mfma_f32_16x16x32_bf16 v[88:91], v[72:75], v[196:199], v[88:91]
    v_mfma_f32_16x16x32_bf16 v[92:95], v[76:79], v[196:199], v[92:95]
    v_mfma_f32_16x16x32_bf16 v[96:99], v[80:83], v[196:199], v[96:99]
    v_mfma_f32_16x16x32_bf16 v[100:103], v[84:87], v[196:199], v[100:103]
    v_mfma_f32_16x16x32_bf16 v[104:107], v[108:111], v[196:199], v[104:107]
    s_add_u32 s84, s28, 96768
    buffer_load_dwordx4 v[172:175], v59, s[16:19], s84 offen
    s_add_u32 s84, s28, 152064
    buffer_load_dwordx4 v[200:203], v58, s[16:19], s84 offen
    ds_read_b128 v[72:75], v5 offset:6656
    ds_read_b128 v[76:79], v4 offset:16384
    ds_read_b128 v[80:83], v4 offset:16640
    ds_read_b128 v[84:87], v4 offset:16896
    ds_read_b128 v[108:111], v4 offset:17152
    s_waitcnt lgkmcnt(10)
    v_mfma_f32_16x16x32_bf16 v[88:91], v[8:11], v[204:207], v[88:91]
    v_mfma_f32_16x16x32_bf16 v[92:95], v[12:15], v[204:207], v[92:95]
    v_mfma_f32_16x16x32_bf16 v[96:99], v[16:19], v[204:207], v[96:99]
    v_mfma_f32_16x16x32_bf16 v[100:103], v[20:23], v[204:207], v[100:103]
    v_mfma_f32_16x16x32_bf16 v[104:107], v[24:27], v[204:207], v[104:107]
    s_add_u32 s84, s28, 110592
    buffer_load_dwordx4 v[180:183], v59, s[16:19], s84 offen
    ds_read_b128 v[8:11], v5 offset:7168
    ds_read_b128 v[12:15], v4 offset:20480
    ds_read_b128 v[16:19], v4 offset:20736
    ds_read_b128 v[20:23], v4 offset:20992
    ds_read_b128 v[24:27], v4 offset:21248
    s_waitcnt lgkmcnt(10)
    v_mfma_f32_16x16x32_bf16 v[88:91], v[28:31], v[212:215], v[88:91]
    v_mfma_f32_16x16x32_bf16 v[92:95], v[32:35], v[212:215], v[92:95]
    v_mfma_f32_16x16x32_bf16 v[96:99], v[36:39], v[212:215], v[96:99]
    v_mfma_f32_16x16x32_bf16 v[100:103], v[40:43], v[212:215], v[100:103]
    v_mfma_f32_16x16x32_bf16 v[104:107], v[44:47], v[212:215], v[104:107]
    s_add_u32 s84, s28, 124416
    buffer_load_dwordx4 v[188:191], v59, s[16:19], s84 offen
    s_add_u32 s84, s28, 165888
    buffer_load_dwordx4 v[208:211], v58, s[16:19], s84 offen
    ds_read_b128 v[28:31], v5 offset:7680
    ds_read_b128 v[32:35], v4 offset:24576
    ds_read_b128 v[36:39], v4 offset:24832
    ds_read_b128 v[40:43], v4 offset:25088
    ds_read_b128 v[44:47], v4 offset:25344
    s_waitcnt lgkmcnt(10)
    v_mfma_f32_16x16x32_bf16 v[88:91], v[72:75], v[220:223], v[88:91]
    v_mfma_f32_16x16x32_bf16 v[92:95], v[76:79], v[220:223], v[92:95]
    v_mfma_f32_16x16x32_bf16 v[96:99], v[80:83], v[220:223], v[96:99]
    v_mfma_f32_16x16x32_bf16 v[100:103], v[84:87], v[220:223], v[100:103]
    v_mfma_f32_16x16x32_bf16 v[104:107], v[108:111], v[220:223], v[104:107]
    s_add_u32 s84, s28, 138240
    buffer_load_dwordx4 v[196:199], v59, s[16:19], s84 offen
    ds_read_b128 v[72:75], v5 offset:8192
    ds_read_b128 v[76:79], v4 offset:28672
    ds_read_b128 v[80:83], v4 offset:28928
    ds_read_b128 v[84:87], v4 offset:29184
    ds_read_b128 v[108:111], v4 offset:29440
    s_waitcnt lgkmcnt(10)
    v_mfma_f32_16x16x32_bf16 v[88:91], v[8:11], v[228:231], v[88:91]
    v_mfma_f32_16x16x32_bf16 v[92:95], v[12:15], v[228:231], v[92:95]
    v_mfma_f32_16x16x32_bf16 v[96:99], v[16:19], v[228:231], v[96:99]
    v_mfma_f32_16x16x32_bf16 v[100:103], v[20:23], v[228:231], v[100:103]
    v_mfma_f32_16x16x32_bf16 v[104:107], v[24:27], v[228:231], v[104:107]
    s_add_u32 s84, s28, 152064
    buffer_load_dwordx4 v[204:207], v59, s[16:19], s84 offen
    s_add_u32 s84, s28, 179712
    buffer_load_dwordx4 v[216:219], v58, s[16:19], s84 offen
    ds_read_b128 v[8:11], v5 offset:8704
    ds_read_b128 v[12:15], v4 offset:32768
    ds_read_b128 v[16:19], v4 offset:33024
    ds_read_b128 v[20:23], v4 offset:33280
    ds_read_b128 v[24:27], v4 offset:33536
    s_waitcnt lgkmcnt(10)
    v_mfma_f32_16x16x32_bf16 v[88:91], v[28:31], v[236:239], v[88:91]
    v_mfma_f32_16x16x32_bf16 v[92:95], v[32:35], v[236:239], v[92:95]
    v_mfma_f32_16x16x32_bf16 v[96:99], v[36:39], v[236:239], v[96:99]
    v_mfma_f32_16x16x32_bf16 v[100:103], v[40:43], v[236:239], v[100:103]
    v_mfma_f32_16x16x32_bf16 v[104:107], v[44:47], v[236:239], v[104:107]
    s_add_u32 s84, s28, 165888
    buffer_load_dwordx4 v[212:215], v59, s[16:19], s84 offen
    s_waitcnt lgkmcnt(5)
    v_mfma_f32_16x16x32_bf16 v[88:91], v[72:75], v[244:247], v[88:91]
    v_mfma_f32_16x16x32_bf16 v[92:95], v[76:79], v[244:247], v[92:95]
    v_mfma_f32_16x16x32_bf16 v[96:99], v[80:83], v[244:247], v[96:99]
    v_mfma_f32_16x16x32_bf16 v[100:103], v[84:87], v[244:247], v[100:103]
    v_mfma_f32_16x16x32_bf16 v[104:107], v[108:111], v[244:247], v[104:107]
    s_add_u32 s84, s28, 179712
    buffer_load_dwordx4 v[220:223], v59, s[16:19], s84 offen
    s_waitcnt lgkmcnt(0)
    v_mfma_f32_16x16x32_bf16 v[88:91], v[8:11], v[252:255], v[88:91]
    v_mfma_f32_16x16x32_bf16 v[92:95], v[12:15], v[252:255], v[92:95]
    v_mfma_f32_16x16x32_bf16 v[96:99], v[16:19], v[252:255], v[96:99]
    v_mfma_f32_16x16x32_bf16 v[100:103], v[20:23], v[252:255], v[100:103]
    v_mfma_f32_16x16x32_bf16 v[104:107], v[24:27], v[252:255], v[104:107]
    s_add_u32 s84, s28, 193536
    buffer_load_dwordx4 v[228:231], v59, s[16:19], s84 offen
    ds_read_b32 v48, v233
    ds_read_b128 v[8:11], v225 offset:0
    ds_read_b128 v[12:15], v225 offset:320
    ds_read_b128 v[16:19], v225 offset:64
    ds_read_b128 v[20:23], v225 offset:384
    ds_read_b128 v[24:27], v225 offset:128
    ds_read_b128 v[28:31], v225 offset:448
    ds_read_b128 v[32:35], v225 offset:192
    ds_read_b128 v[36:39], v225 offset:512
    ds_read_b128 v[40:43], v225 offset:256
    ds_read_b128 v[44:47], v225 offset:576
    s_waitcnt lgkmcnt(0)
    v_pk_mul_f32 v[88:89], v[88:89], v[8:9]
    v_pk_mul_f32 v[90:91], v[90:91], v[10:11]
    v_pk_mul_f32 v[92:93], v[92:93], v[16:17]
    v_pk_mul_f32 v[94:95], v[94:95], v[18:19]
    v_pk_mul_f32 v[96:97], v[96:97], v[24:25]
    v_pk_mul_f32 v[98:99], v[98:99], v[26:27]
    v_pk_mul_f32 v[100:101], v[100:101], v[32:33]
    v_pk_mul_f32 v[102:103], v[102:103], v[34:35]
    v_pk_mul_f32 v[104:105], v[104:105], v[40:41]
    v_pk_mul_f32 v[106:107], v[106:107], v[42:43]
    v_pk_fma_f32 v[88:89], v[12:13], v[48:49], v[88:89] op_sel_hi:[1,0,1] neg_lo:[1,0,0] neg_hi:[1,0,0]
    v_pk_fma_f32 v[90:91], v[14:15], v[48:49], v[90:91] op_sel_hi:[1,0,1] neg_lo:[1,0,0] neg_hi:[1,0,0]
    v_pk_fma_f32 v[92:93], v[20:21], v[48:49], v[92:93] op_sel_hi:[1,0,1] neg_lo:[1,0,0] neg_hi:[1,0,0]
    v_pk_fma_f32 v[94:95], v[22:23], v[48:49], v[94:95] op_sel_hi:[1,0,1] neg_lo:[1,0,0] neg_hi:[1,0,0]
    v_pk_fma_f32 v[96:97], v[28:29], v[48:49], v[96:97] op_sel_hi:[1,0,1] neg_lo:[1,0,0] neg_hi:[1,0,0]
    v_pk_fma_f32 v[98:99], v[30:31], v[48:49], v[98:99] op_sel_hi:[1,0,1] neg_lo:[1,0,0] neg_hi:[1,0,0]
    v_pk_fma_f32 v[100:101], v[36:37], v[48:49], v[100:101] op_sel_hi:[1,0,1] neg_lo:[1,0,0] neg_hi:[1,0,0]
    v_pk_fma_f32 v[102:103], v[38:39], v[48:49], v[102:103] op_sel_hi:[1,0,1] neg_lo:[1,0,0] neg_hi:[1,0,0]
    v_pk_fma_f32 v[104:105], v[44:45], v[48:49], v[104:105] op_sel_hi:[1,0,1] neg_lo:[1,0,0] neg_hi:[1,0,0]
    v_pk_fma_f32 v[106:107], v[46:47], v[48:49], v[106:107] op_sel_hi:[1,0,1] neg_lo:[1,0,0] neg_hi:[1,0,0]
    v_cvt_pk_bf16_f32 v88, v88, v89
    v_cvt_pk_bf16_f32 v89, v90, v91
    ds_write_b64 v227, v[88:89] offset:0
    v_cvt_pk_bf16_f32 v92, v92, v93
    v_cvt_pk_bf16_f32 v93, v94, v95
    ds_write_b64 v227, v[92:93] offset:512
    v_cvt_pk_bf16_f32 v96, v96, v97
    v_cvt_pk_bf16_f32 v97, v98, v99
    ds_write_b64 v227, v[96:97] offset:1024
    v_cvt_pk_bf16_f32 v100, v100, v101
    v_cvt_pk_bf16_f32 v101, v102, v103
    ds_write_b64 v227, v[100:101] offset:1536
    v_cvt_pk_bf16_f32 v104, v104, v105
    v_cvt_pk_bf16_f32 v105, v106, v107
    ds_write_b64 v227, v[104:105] offset:2048
    s_waitcnt lgkmcnt(0)
    s_setprio 0
    s_barrier
    s_add_u32 s84, s28, 207360
    buffer_load_dwordx4 v[236:239], v59, s[16:19], s84 offen
    s_add_u32 s84, s28, 221184
    buffer_load_dwordx4 v[244:247], v59, s[16:19], s84 offen
    s_branch M_mid
M_S4:
    v_mov_b32 v72, 0
    v_mov_b32 v73, 0
    v_mov_b32 v74, 0
    v_mov_b32 v75, 0
    v_mov_b32 v76, 0
    v_mov_b32 v77, 0
    v_mov_b32 v78, 0
    v_mov_b32 v79, 0
    v_mov_b32 v80, 0
    v_mov_b32 v81, 0
    v_mov_b32 v82, 0
    v_mov_b32 v83, 0
    v_mov_b32 v84, 0
    v_mov_b32 v85, 0
    v_mov_b32 v86, 0
    v_mov_b32 v87, 0
    v_mov_b32 v88, 0
    v_mov_b32 v89, 0
    v_mov_b32 v90, 0
    v_mov_b32 v91, 0
    v_mov_b32 v92, 0
    v_mov_b32 v93, 0
    v_mov_b32 v94, 0
    v_mov_b32 v95, 0
    v_mov_b32 v96, 0
    v_mov_b32 v97, 0
    v_mov_b32 v98, 0
    v_mov_b32 v99, 0
    v_mov_b32 v100, 0
    v_mov_b32 v101, 0
    v_mov_b32 v102, 0
    v_mov_b32 v103, 0
    s_setprio 3
    s_add_u32 m0, s26, 0
    s_nop 0
    buffer_load_dwordx4 v70, s[12:15], s27 offen sc1 lds
    s_add_u32 s27, s27, 8192
    buffer_load_dwordx4 v[112:115], v58, s[16:19], s86 offen
    buffer_load_dwordx4 v[116:119], v59, s[16:19], s86 offen
    s_add_u32 s86, s86, 13824
    buffer_load_dwordx4 v[120:123], v58, s[16:19], s86 offen
    buffer_load_dwordx4 v[124:127], v59, s[16:19], s86 offen
    s_add_u32 s86, s86, 13824
    s_setprio 2
    s_add_u32 m0, s26, 8192
    s_nop 0
    buffer_load_dwordx4 v70, s[12:15], s27 offen sc1 lds
    s_add_u32 s27, s27, 8192
    buffer_load_dwordx4 v[128:131], v58, s[16:19], s86 offen
    buffer_load_dwordx4 v[132:135], v59, s[16:19], s86 offen
    s_add_u32 s86, s86, 13824
    buffer_load_dwordx4 v[136:139], v58, s[16:19], s86 offen
    buffer_load_dwordx4 v[140:143], v59, s[16:19], s86 offen
    s_add_u32 s86, s86, 13824
    s_setprio 1
    s_add_u32 m0, s26, 16384
    s_nop 0
    buffer_load_dwordx4 v70, s[12:15], s27 offen sc1 lds
    s_add_u32 s27, s27, 8192
    buffer_load_dwordx4 v[144:147], v58, s[16:19], s86 offen
    buffer_load_dwordx4 v[148:151], v59, s[16:19], s86 offen
    s_add_u32 s86, s86, 13824
    buffer_load_dwordx4 v[152:155], v58, s[16:19], s86 offen
    buffer_load_dwordx4 v[156:159], v59, s[16:19], s86 offen
    s_add_u32 s86, s86, 13824
    s_setprio 0
    s_add_u32 m0, s26, 24576
    s_nop 0
    buffer_load_dwordx4 v70, s[12:15], s27 offen sc1 lds
    s_add_u32 s27, s27, 8192
    buffer_load_dwordx4 v[160:163], v58, s[16:19], s86 offen
    buffer_load_dwordx4 v[164:167], v59, s[16:19], s86 offen
    s_add_u32 s86, s86, 13824
    buffer_load_dwordx4 v[168:171], v58, s[16:19], s86 offen
    buffer_load_dwordx4 v[172:175], v59, s[16:19], s86 offen
    s_add_u32 s86, s86, 13824
    s_setprio 0
    buffer_load_dwordx4 v[176:179], v58, s[16:19], s86 offen
    buffer_load_dwordx4 v[180:183], v59, s[16:19], s86 offen
    s_add_u32 s86, s86, 13824
    buffer_load_dwordx4 v[184:187], v58, s[16:19], s86 offen
    buffer_load_dwordx4 v[188:191], v59, s[16:19], s86 offen
    s_add_u32 s86, s86, 13824
    v_mul_u32_u24 v2, 3641, v0
    v_lshrrev_b32 v2, 16, v2
    v_mul_u32_u24 v3, 2016, v2
    v_lshl_add_u32 v6, v0, 4, v3
    s_lshl_b32 s5, s25, 1
    s_add_u32 s5, s5, 28311552
    buffer_load_dwordx4 v[104:107], v6, s[12:15], s5 offen
    s_setprio 2
    s_waitcnt vmcnt(24)
    s_barrier
    ds_read_b128 v[8:11], v5 offset:0
    ds_read_b128 v[12:15], v1 offset:0
    ds_read_b128 v[16:19], v1 offset:256
    ds_read_b128 v[20:23], v1 offset:512
    ds_read_b128 v[24:27], v1 offset:768
    ds_read_b128 v[28:31], v5 offset:512
    ds_read_b128 v[32:35], v1 offset:4096
    ds_read_b128 v[36:39], v1 offset:4352
    ds_read_b128 v[40:43], v1 offset:4608
    ds_read_b128 v[44:47], v1 offset:4864
    s_waitcnt lgkmcnt(5)
    s_waitcnt vmcnt(22)
    v_mfma_f32_16x16x32_bf16 v[72:75], v[112:115], v[8:11], v[72:75]
    v_mfma_f32_16x16x32_bf16 v[76:79], v[112:115], v[12:15], v[76:79]
    s_add_u32 m0, s26, 32768
    s_nop 0
    buffer_load_dwordx4 v70, s[12:15], s27 offen sc1 lds
    s_add_u32 s27, s27, 8192
    buffer_load_dwordx4 v[192:195], v58, s[16:19], s86 offen
    buffer_load_dwordx4 v[196:199], v59, s[16:19], s86 offen
    s_add_u32 s86, s86, 13824
    v_mfma_f32_16x16x32_bf16 v[80:83], v[112:115], v[16:19], v[80:83]
    v_mfma_f32_16x16x32_bf16 v[84:87], v[112:115], v[20:23], v[84:87]
    v_mfma_f32_16x16x32_bf16 v[88:91], v[112:115], v[24:27], v[88:91]
    v_mfma_f32_16x16x32_bf16 v[92:95], v[8:11], v[116:119], v[92:95]
    v_mfma_f32_16x16x32_bf16 v[96:99], v[12:15], v[116:119], v[96:99]
    v_mfma_f32_16x16x32_bf16 v[100:103], v[16:19], v[116:119], v[100:103]
    s_waitcnt vmcnt(17)
    s_barrier
    ds_read_b128 v[8:11], v5 offset:1024
    ds_read_b128 v[12:15], v1 offset:8192
    ds_read_b128 v[16:19], v1 offset:8448
    ds_read_b128 v[20:23], v1 offset:8704
    ds_read_b128 v[24:27], v1 offset:8960
    s_waitcnt lgkmcnt(5)
    v_mfma_f32_16x16x32_bf16 v[72:75], v[120:123], v[28:31], v[72:75]
    v_mfma_f32_16x16x32_bf16 v[76:79], v[120:123], v[32:35], v[76:79]
    buffer_load_dwordx4 v[200:203], v58, s[16:19], s86 offen
    buffer_load_dwordx4 v[204:207], v59, s[16:19], s86 offen
    s_add_u32 s86, s86, 13824
    v_mfma_f32_16x16x32_bf16 v[80:83], v[120:123], v[36:39], v[80:83]
    v_mfma_f32_16x16x32_bf16 v[84:87], v[120:123], v[40:43], v[84:87]
    v_mfma_f32_16x16x32_bf16 v[88:91], v[120:123], v[44:47], v[88:91]
    v_mfma_f32_16x16x32_bf16 v[92:95], v[28:31], v[124:127], v[92:95]
    v_mfma_f32_16x16x32_bf16 v[96:99], v[32:35], v[124:127], v[96:99]
    v_mfma_f32_16x16x32_bf16 v[100:103], v[36:39], v[124:127], v[100:103]
    ds_read_b128 v[28:31], v5 offset:1536
    ds_read_b128 v[32:35], v1 offset:12288
    ds_read_b128 v[36:39], v1 offset:12544
    ds_read_b128 v[40:43], v1 offset:12800
    ds_read_b128 v[44:47], v1 offset:13056
    s_waitcnt lgkmcnt(5)
    v_mfma_f32_16x16x32_bf16 v[72:75], v[128:131], v[8:11], v[72:75]
    v_mfma_f32_16x16x32_bf16 v[76:79], v[128:131], v[12:15], v[76:79]
    s_add_u32 m0, s26, 40960
    s_nop 0
    buffer_load_dwordx4 v70, s[12:15], s27 offen sc1 lds
    s_add_u32 s27, s27, 8192
    buffer_load_dwordx4 v[208:211], v58, s[16:19], s86 offen
    buffer_load_dwordx4 v[212:215], v59, s[16:19], s86 offen
    s_add_u32 s86, s86, 13824
    v_mfma_f32_16x16x32_bf16 v[80:83], v[128:131], v[16:19], v[80:83]
    v_mfma_f32_16x16x32_bf16 v[84:87], v[128:131], v[20:23], v[84:87]
    v_mfma_f32_16x16x32_bf16 v[88:91], v[128:131], v[24:27], v[88:91]
    v_mfma_f32_16x16x32_bf16 v[92:95], v[8:11], v[132:135], v[92:95]
    v_mfma_f32_16x16x32_bf16 v[96:99], v[12:15], v[132:135], v[96:99]
    v_mfma_f32_16x16x32_bf16 v[100:103], v[16:19], v[132:135], v[100:103]
    ds_read_b128 v[8:11], v5 offset:2048
    ds_read_b128 v[12:15], v1 offset:16384
    ds_read_b128 v[16:19], v1 offset:16640
    ds_read_b128 v[20:23], v1 offset:16896
    ds_read_b128 v[24:27], v1 offset:17152
    s_waitcnt lgkmcnt(5)
    v_mfma_f32_16x16x32_bf16 v[72:75], v[136:139], v[28:31], v[72:75]
    v_mfma_f32_16x16x32_bf16 v[76:79], v[136:139], v[32:35], v[76:79]
    buffer_load_dwordx4 v[216:219], v58, s[16:19], s86 offen
    buffer_load_dwordx4 v[220:223], v59, s[16:19], s86 offen
    s_add_u32 s86, s86, 13824
    v_mfma_f32_16x16x32_bf16 v[80:83], v[136:139], v[36:39], v[80:83]
    v_mfma_f32_16x16x32_bf16 v[84:87], v[136:139], v[40:43], v[84:87]
    v_mfma_f32_16x16x32_bf16 v[88:91], v[136:139], v[44:47], v[88:91]
    v_mfma_f32_16x16x32_bf16 v[92:95], v[28:31], v[140:143], v[92:95]
    v_mfma_f32_16x16x32_bf16 v[96:99], v[32:35], v[140:143], v[96:99]
    v_mfma_f32_16x16x32_bf16 v[100:103], v[36:39], v[140:143], v[100:103]
    ds_read_b128 v[28:31], v5 offset:2560
    ds_read_b128 v[32:35], v1 offset:20480
    ds_read_b128 v[36:39], v1 offset:20736
    ds_read_b128 v[40:43], v1 offset:20992
    ds_read_b128 v[44:47], v1 offset:21248
    s_waitcnt lgkmcnt(5)
    s_waitcnt vmcnt(22)
    v_mfma_f32_16x16x32_bf16 v[72:75], v[144:147], v[8:11], v[72:75]
    v_mfma_f32_16x16x32_bf16 v[76:79], v[144:147], v[12:15], v[76:79]
    s_add_u32 m0, s26, 49152
    s_nop 0
    buffer_load_dwordx4 v70, s[12:15], s27 offen sc1 lds
    s_add_u32 s27, s27, 8192
    buffer_load_dwordx4 v[224:227], v58, s[16:19], s86 offen
    buffer_load_dwordx4 v[228:231], v59, s[16:19], s86 offen
    s_add_u32 s86, s86, 13824
    v_mfma_f32_16x16x32_bf16 v[80:83], v[144:147], v[16:19], v[80:83]
    v_mfma_f32_16x16x32_bf16 v[84:87], v[144:147], v[20:23], v[84:87]
    v_mfma_f32_16x16x32_bf16 v[88:91], v[144:147], v[24:27], v[88:91]
    v_mfma_f32_16x16x32_bf16 v[92:95], v[8:11], v[148:151], v[92:95]
    v_mfma_f32_16x16x32_bf16 v[96:99], v[12:15], v[148:151], v[96:99]
    v_mfma_f32_16x16x32_bf16 v[100:103], v[16:19], v[148:151], v[100:103]
    s_waitcnt vmcnt(12)
    s_barrier
    ds_read_b128 v[8:11], v5 offset:3072
    ds_read_b128 v[12:15], v1 offset:24576
    ds_read_b128 v[16:19], v1 offset:24832
    ds_read_b128 v[20:23], v1 offset:25088
    ds_read_b128 v[24:27], v1 offset:25344
    s_waitcnt lgkmcnt(5)
    v_mfma_f32_16x16x32_bf16 v[72:75], v[152:155], v[28:31], v[72:75]
    v_mfma_f32_16x16x32_bf16 v[76:79], v[152:155], v[32:35], v[76:79]
    buffer_load_dwordx4 v[232:235], v58, s[16:19], s86 offen
    buffer_load_dwordx4 v[236:239], v59, s[16:19], s86 offen
    s_add_u32 s86, s86, 13824
    v_mfma_f32_16x16x32_bf16 v[80:83], v[152:155], v[36:39], v[80:83]
    v_mfma_f32_16x16x32_bf16 v[84:87], v[152:155], v[40:43], v[84:87]
    v_mfma_f32_16x16x32_bf16 v[88:91], v[152:155], v[44:47], v[88:91]
    v_mfma_f32_16x16x32_bf16 v[92:95], v[28:31], v[156:159], v[92:95]
    v_mfma_f32_16x16x32_bf16 v[96:99], v[32:35], v[156:159], v[96:99]
    v_mfma_f32_16x16x32_bf16 v[100:103], v[36:39], v[156:159], v[100:103]
    ds_read_b128 v[28:31], v5 offset:3584
    ds_read_b128 v[32:35], v1 offset:28672
    ds_read_b128 v[36:39], v1 offset:28928
    ds_read_b128 v[40:43], v1 offset:29184
    ds_read_b128 v[44:47], v1 offset:29440
    s_waitcnt lgkmcnt(5)
    v_mfma_f32_16x16x32_bf16 v[72:75], v[160:163], v[8:11], v[72:75]
    v_mfma_f32_16x16x32_bf16 v[76:79], v[160:163], v[12:15], v[76:79]
    s_add_u32 m0, s26, 57344
    s_nop 0
    buffer_load_dwordx4 v70, s[12:15], s27 offen sc1 lds
    s_add_u32 s27, s27, 8192
    buffer_load_dwordx4 v[240:243], v58, s[16:19], s86 offen
    buffer_load_dwordx4 v[244:247], v59, s[16:19], s86 offen
    s_add_u32 s86, s86, 13824
    v_mfma_f32_16x16x32_bf16 v[80:83], v[160:163], v[16:19], v[80:83]
    v_mfma_f32_16x16x32_bf16 v[84:87], v[160:163], v[20:23], v[84:87]
    v_mfma_f32_16x16x32_bf16 v[88:91], v[160:163], v[24:27], v[88:91]
    v_mfma_f32_16x16x32_bf16 v[92:95], v[8:11], v[164:167], v[92:95]
    v_mfma_f32_16x16x32_bf16 v[96:99], v[12:15], v[164:167], v[96:99]
    v_mfma_f32_16x16x32_bf16 v[100:103], v[16:19], v[164:167], v[100:103]
    ds_read_b128 v[8:11], v5 offset:4096
    ds_read_b128 v[12:15], v1 offset:32768
    ds_read_b128 v[16:19], v1 offset:33024
    ds_read_b128 v[20:23], v1 offset:33280
    ds_read_b128 v[24:27], v1 offset:33536
    s_waitcnt lgkmcnt(5)
    v_mfma_f32_16x16x32_bf16 v[72:75], v[168:171], v[28:31], v[72:75]
    v_mfma_f32_16x16x32_bf16 v[76:79], v[168:171], v[32:35], v[76:79]
    buffer_load_dwordx4 v[248:251], v58, s[16:19], s86 offen
    buffer_load_dwordx4 v[252:255], v59, s[16:19], s86 offen
    s_add_u32 s86, s86, 13824
    v_mfma_f32_16x16x32_bf16 v[80:83], v[168:171], v[36:39], v[80:83]
    v_mfma_f32_16x16x32_bf16 v[84:87], v[168:171], v[40:43], v[84:87]
    v_mfma_f32_16x16x32_bf16 v[88:91], v[168:171], v[44:47], v[88:91]
    v_mfma_f32_16x16x32_bf16 v[92:95], v[28:31], v[172:175], v[92:95]
    v_mfma_f32_16x16x32_bf16 v[96:99], v[32:35], v[172:175], v[96:99]
    v_mfma_f32_16x16x32_bf16 v[100:103], v[36:39], v[172:175], v[100:103]
    ds_read_b128 v[28:31], v5 offset:4608
    ds_read_b128 v[32:35], v4 offset:0
    ds_read_b128 v[36:39], v4 offset:256
    ds_read_b128 v[40:43], v4 offset:512
    ds_read_b128 v[44:47], v4 offset:768
    s_waitcnt lgkmcnt(5)
    v_mfma_f32_16x16x32_bf16 v[72:75], v[176:179], v[8:11], v[72:75]
    v_mfma_f32_16x16x32_bf16 v[76:79], v[176:179], v[12:15], v[76:79]
    s_add_u32 m0, s26, 65536
    s_nop 0
    buffer_load_dwordx4 v70, s[12:15], s27 offen sc1 lds
    s_add_u32 s27, s27, 8192
    v_mfma_f32_16x16x32_bf16 v[80:83], v[176:179], v[16:19], v[80:83]
    v_mfma_f32_16x16x32_bf16 v[84:87], v[176:179], v[20:23], v[84:87]
    v_mfma_f32_16x16x32_bf16 v[88:91], v[176:179], v[24:27], v[88:91]
    v_mfma_f32_16x16x32_bf16 v[92:95], v[8:11], v[180:183], v[92:95]
    v_mfma_f32_16x16x32_bf16 v[96:99], v[12:15], v[180:183], v[96:99]
    v_mfma_f32_16x16x32_bf16 v[100:103], v[16:19], v[180:183], v[100:103]
    s_waitcnt vmcnt(10)
    s_barrier
    ds_read_b128 v[8:11], v5 offset:5120
    ds_read_b128 v[12:15], v4 offset:4096
    ds_read_b128 v[16:19], v4 offset:4352
    ds_read_b128 v[20:23], v4 offset:4608
    ds_read_b128 v[24:27], v4 offset:4864
    s_waitcnt lgkmcnt(5)
    v_mfma_f32_16x16x32_bf16 v[72:75], v[184:187], v[28:31], v[72:75]
    v_mfma_f32_16x16x32_bf16 v[76:79], v[184:187], v[32:35], v[76:79]
    v_mfma_f32_16x16x32_bf16 v[80:83], v[184:187], v[36:39], v[80:83]
    v_mfma_f32_16x16x32_bf16 v[84:87], v[184:187], v[40:43], v[84:87]
    v_mfma_f32_16x16x32_bf16 v[88:91], v[184:187], v[44:47], v[88:91]
    v_mfma_f32_16x16x32_bf16 v[92:95], v[28:31], v[188:191], v[92:95]
    v_mfma_f32_16x16x32_bf16 v[96:99], v[32:35], v[188:191], v[96:99]
    v_mfma_f32_16x16x32_bf16 v[100:103], v[36:39], v[188:191], v[100:103]
    ds_read_b128 v[28:31], v5 offset:5632
    ds_read_b128 v[32:35], v4 offset:8192
    ds_read_b128 v[36:39], v4 offset:8448
    ds_read_b128 v[40:43], v4 offset:8704
    ds_read_b128 v[44:47], v4 offset:8960
    s_waitcnt lgkmcnt(5)
    v_mfma_f32_16x16x32_bf16 v[72:75], v[192:195], v[8:11], v[72:75]
    v_mfma_f32_16x16x32_bf16 v[76:79], v[192:195], v[12:15], v[76:79]
    v_mfma_f32_16x16x32_bf16 v[80:83], v[192:195], v[16:19], v[80:83]
    v_mfma_f32_16x16x32_bf16 v[84:87], v[192:195], v[20:23], v[84:87]
    v_mfma_f32_16x16x32_bf16 v[88:91], v[192:195], v[24:27], v[88:91]
    v_mfma_f32_16x16x32_bf16 v[92:95], v[8:11], v[196:199], v[92:95]
    v_mfma_f32_16x16x32_bf16 v[96:99], v[12:15], v[196:199], v[96:99]
    v_mfma_f32_16x16x32_bf16 v[100:103], v[16:19], v[196:199], v[100:103]
    s_mov_b32 exec_hi, 0x3fffff
    ds_write_b128 v70, v[104:107] offset:640
    s_mov_b64 exec, -1
    s_mul_i32 s5, s20, 9216
    s_add_u32 s5, s5, s24
    buffer_load_dwordx2 v[60:61], v67, s[12:15], s5 offen
    s_add_u32 s5, s5, 2048
    buffer_load_dwordx2 v[62:63], v67, s[12:15], s5 offen
    s_add_u32 s5, s5, 2048
    buffer_load_dwordx2 v[64:65], v67, s[12:15], s5 offen
    s_add_u32 s5, s5, 2048
    s_min_u32 s6, s87, 46080
    s_add_u32 m0, s6, 80896
    s_add_u32 s7, s6, s89
    buffer_load_dwordx4 v70, s[12:15], s7 offen lds
    s_add_u32 s87, s87, 7168
    ds_read_b128 v[8:11], v5 offset:6144
    ds_read_b128 v[12:15], v4 offset:12288
    ds_read_b128 v[16:19], v4 offset:12544
    ds_read_b128 v[20:23], v4 offset:12800
    ds_read_b128 v[24:27], v4 offset:13056
    s_waitcnt lgkmcnt(5)
    v_mfma_f32_16x16x32_bf16 v[72:75], v[200:203], v[28:31], v[72:75]
    v_mfma_f32_16x16x32_bf16 v[76:79], v[200:203], v[32:35], v[76:79]
    v_mfma_f32_16x16x32_bf16 v[80:83], v[200:203], v[36:39], v[80:83]
    v_mfma_f32_16x16x32_bf16 v[84:87], v[200:203], v[40:43], v[84:87]
    v_mfma_f32_16x16x32_bf16 v[88:91], v[200:203], v[44:47], v[88:91]
    v_mfma_f32_16x16x32_bf16 v[92:95], v[28:31], v[204:207], v[92:95]
    v_mfma_f32_16x16x32_bf16 v[96:99], v[32:35], v[204:207], v[96:99]
    v_mfma_f32_16x16x32_bf16 v[100:103], v[36:39], v[204:207], v[100:103]
    s_min_u32 s6, s87, 46080
    s_add_u32 m0, s6, 80896
    s_add_u32 s7, s6, s89
    buffer_load_dwordx4 v70, s[12:15], s7 offen lds
    s_add_u32 s87, s87, 7168
    ds_read_b128 v[28:31], v5 offset:6656
    ds_read_b128 v[32:35], v4 offset:16384
    ds_read_b128 v[36:39], v4 offset:16640
    ds_read_b128 v[40:43], v4 offset:16896
    ds_read_b128 v[44:47], v4 offset:17152
    s_waitcnt lgkmcnt(5)
    v_mfma_f32_16x16x32_bf16 v[72:75], v[208:211], v[8:11], v[72:75]
    v_mfma_f32_16x16x32_bf16 v[76:79], v[208:211], v[12:15], v[76:79]
    v_mfma_f32_16x16x32_bf16 v[80:83], v[208:211], v[16:19], v[80:83]
    v_mfma_f32_16x16x32_bf16 v[84:87], v[208:211], v[20:23], v[84:87]
    v_mfma_f32_16x16x32_bf16 v[88:91], v[208:211], v[24:27], v[88:91]
    v_mfma_f32_16x16x32_bf16 v[92:95], v[8:11], v[212:215], v[92:95]
    v_mfma_f32_16x16x32_bf16 v[96:99], v[12:15], v[212:215], v[96:99]
    v_mfma_f32_16x16x32_bf16 v[100:103], v[16:19], v[212:215], v[100:103]
    s_min_u32 s6, s87, 46080
    s_add_u32 m0, s6, 80896
    s_add_u32 s7, s6, s89
    buffer_load_dwordx4 v70, s[12:15], s7 offen lds
    s_add_u32 s87, s87, 7168
    s_waitcnt vmcnt(6)
    s_barrier
    ds_read_b128 v[8:11], v5 offset:7168
    ds_read_b128 v[12:15], v4 offset:20480
    ds_read_b128 v[16:19], v4 offset:20736
    ds_read_b128 v[20:23], v4 offset:20992
    ds_read_b128 v[24:27], v4 offset:21248
    s_waitcnt lgkmcnt(5)
    v_mfma_f32_16x16x32_bf16 v[72:75], v[216:219], v[28:31], v[72:75]
    v_mfma_f32_16x16x32_bf16 v[76:79], v[216:219], v[32:35], v[76:79]
    v_mfma_f32_16x16x32_bf16 v[80:83], v[216:219], v[36:39], v[80:83]
    v_mfma_f32_16x16x32_bf16 v[84:87], v[216:219], v[40:43], v[84:87]
    v_mfma_f32_16x16x32_bf16 v[88:91], v[216:219], v[44:47], v[88:91]
    v_mfma_f32_16x16x32_bf16 v[92:95], v[28:31], v[220:223], v[92:95]
    v_mfma_f32_16x16x32_bf16 v[96:99], v[32:35], v[220:223], v[96:99]
    v_mfma_f32_16x16x32_bf16 v[100:103], v[36:39], v[220:223], v[100:103]
    s_min_u32 s6, s87, 46080
    s_add_u32 m0, s6, 80896
    s_add_u32 s7, s6, s89
    buffer_load_dwordx4 v70, s[12:15], s7 offen lds
    s_add_u32 s87, s87, 7168
    ds_read_b128 v[28:31], v5 offset:7680
    ds_read_b128 v[32:35], v4 offset:24576
    ds_read_b128 v[36:39], v4 offset:24832
    ds_read_b128 v[40:43], v4 offset:25088
    ds_read_b128 v[44:47], v4 offset:25344
    s_waitcnt lgkmcnt(5)
    v_mfma_f32_16x16x32_bf16 v[72:75], v[224:227], v[8:11], v[72:75]
    v_mfma_f32_16x16x32_bf16 v[76:79], v[224:227], v[12:15], v[76:79]
    v_mfma_f32_16x16x32_bf16 v[80:83], v[224:227], v[16:19], v[80:83]
    v_mfma_f32_16x16x32_bf16 v[84:87], v[224:227], v[20:23], v[84:87]
    v_mfma_f32_16x16x32_bf16 v[88:91], v[224:227], v[24:27], v[88:91]
    v_mfma_f32_16x16x32_bf16 v[92:95], v[8:11], v[228:231], v[92:95]
    v_mfma_f32_16x16x32_bf16 v[96:99], v[12:15], v[228:231], v[96:99]
    v_mfma_f32_16x16x32_bf16 v[100:103], v[16:19], v[228:231], v[100:103]
    s_min_u32 s6, s87, 46080
    s_add_u32 m0, s6, 80896
    s_add_u32 s7, s6, s89
    buffer_load_dwordx4 v70, s[12:15], s7 offen lds
    s_add_u32 s87, s87, 7168
    ds_read_b128 v[8:11], v5 offset:8192
    ds_read_b128 v[12:15], v4 offset:28672
    ds_read_b128 v[16:19], v4 offset:28928
    ds_read_b128 v[20:23], v4 offset:29184
    ds_read_b128 v[24:27], v4 offset:29440
    s_waitcnt lgkmcnt(5)
    v_mfma_f32_16x16x32_bf16 v[72:75], v[232:235], v[28:31], v[72:75]
    v_mfma_f32_16x16x32_bf16 v[76:79], v[232:235], v[32:35], v[76:79]
    v_mfma_f32_16x16x32_bf16 v[80:83], v[232:235], v[36:39], v[80:83]
    v_mfma_f32_16x16x32_bf16 v[84:87], v[232:235], v[40:43], v[84:87]
    v_mfma_f32_16x16x32_bf16 v[88:91], v[232:235], v[44:47], v[88:91]
    v_mfma_f32_16x16x32_bf16 v[92:95], v[28:31], v[236:239], v[92:95]
    v_mfma_f32_16x16x32_bf16 v[96:99], v[32:35], v[236:239], v[96:99]
    v_mfma_f32_16x16x32_bf16 v[100:103], v[36:39], v[236:239], v[100:103]
    s_min_u32 s6, s87, 46080
    s_add_u32 m0, s6, 80896
    s_add_u32 s7, s6, s89
    buffer_load_dwordx4 v70, s[12:15], s7 offen lds
    s_add_u32 s87, s87, 7168
    ds_read_b128 v[28:31], v5 offset:8704
    ds_read_b128 v[32:35], v4 offset:32768
    ds_read_b128 v[36:39], v4 offset:33024
    ds_read_b128 v[40:43], v4 offset:33280
    ds_read_b128 v[44:47], v4 offset:33536
    s_waitcnt lgkmcnt(5)
    v_mfma_f32_16x16x32_bf16 v[72:75], v[240:243], v[8:11], v[72:75]
    v_and_b32 v2, 15, v0
    v_lshrrev_b32 v3, 4, v0
    v_lshlrev_b32 v224, 2, v2
    v_lshlrev_b32 v225, 4, v3
    v_lshlrev_b32 v6, 3, v0
    v_mfma_f32_16x16x32_bf16 v[76:79], v[240:243], v[12:15], v[76:79]
    s_mul_i32 s5, s30, 2560
    s_add_u32 s5, s5, 128000
    v_add_u32 v226, s5, v6
    s_mul_i32 s5, s31, 2560
    s_add_u32 s5, s5, 128000
    v_mfma_f32_16x16x32_bf16 v[80:83], v[240:243], v[16:19], v[80:83]
    v_add_u32 v227, s5, v6
    s_and_b32 s7, s3, 1
    s_mul_i32 s7, s7, 896
    s_add_u32 s7, s7, 640
    s_add_u32 s5, s7, 288
    v_mfma_f32_16x16x32_bf16 v[84:87], v[240:243], v[20:23], v[84:87]
    v_add_u32 v232, s5, v225
    s_add_u32 s5, s7, 832
    v_add_u32 v233, s5, v224
    v_add_u32 v234, 128000, v6
    v_add_u32 v6, 256, v6
    v_mfma_f32_16x16x32_bf16 v[88:91], v[240:243], v[24:27], v[88:91]
    v_and_b32 v6, 0x1ff, v6
    v_add_u32 v235, 138240, v6
    v_lshlrev_b32 v3, 2, v3
    v_cmp_le_u32 s[80:81], v3, v2
    v_sub_u32 v6, v2, v3
    v_mfma_f32_16x16x32_bf16 v[92:95], v[8:11], v[244:247], v[92:95]
    v_mov_b32 v2, 0xf149f2ca
    s_cmp_lg_u32 s23, 0
    s_cselect_b32 s5, 8, 0
    v_add_u32 v3, 16, v6
    v_cmp_gt_u32 s[76:77], s5, v3
    v_mfma_f32_16x16x32_bf16 v[96:99], v[12:15], v[244:247], v[96:99]
    v_subrev_u32 v3, 0, v6
    v_cmp_gt_u32 s[78:79], 8, v3
    s_nop 0
    v_cndmask_b32 v228, v2, 0, s[76:77]
    v_cndmask_b32 v236, v2, 0, s[78:79]
    v_mfma_f32_16x16x32_bf16 v[100:103], v[16:19], v[244:247], v[100:103]
    v_add_u32 v3, 15, v6
    v_cmp_gt_u32 s[76:77], s5, v3
    v_subrev_u32 v3, 1, v6
    v_cmp_gt_u32 s[78:79], 8, v3
    s_nop 0
    s_waitcnt lgkmcnt(0)
    v_mfma_f32_16x16x32_bf16 v[72:75], v[248:251], v[28:31], v[72:75]
    v_cndmask_b32 v229, v2, 0, s[76:77]
    v_cndmask_b32 v237, v2, 0, s[78:79]
    v_add_u32 v3, 14, v6
    v_cmp_gt_u32 s[76:77], s5, v3
    v_subrev_u32 v3, 2, v6
    v_mfma_f32_16x16x32_bf16 v[76:79], v[248:251], v[32:35], v[76:79]
    v_cmp_gt_u32 s[78:79], 8, v3
    s_nop 0
    v_cndmask_b32 v230, v2, 0, s[76:77]
    v_cndmask_b32 v238, v2, 0, s[78:79]
    v_add_u32 v3, 13, v6
    v_mfma_f32_16x16x32_bf16 v[80:83], v[248:251], v[36:39], v[80:83]
    v_cmp_gt_u32 s[76:77], s5, v3
    v_subrev_u32 v3, 3, v6
    v_cmp_gt_u32 s[78:79], 8, v3
    s_nop 0
    v_cndmask_b32 v231, v2, 0, s[76:77]
    v_mfma_f32_16x16x32_bf16 v[84:87], v[248:251], v[40:43], v[84:87]
    v_cndmask_b32 v239, v2, 0, s[78:79]
    v_mfma_f32_16x16x32_bf16 v[88:91], v[248:251], v[44:47], v[88:91]
    v_mfma_f32_16x16x32_bf16 v[92:95], v[28:31], v[252:255], v[92:95]
    v_mfma_f32_16x16x32_bf16 v[96:99], v[32:35], v[252:255], v[96:99]
    v_mfma_f32_16x16x32_bf16 v[100:103], v[36:39], v[252:255], v[100:103]
    s_setprio 0
    s_branch M_S4_epi
M_S4_loop:
    v_mov_b32 v72, 0
    v_mov_b32 v73, 0
    v_mov_b32 v74, 0
    v_mov_b32 v75, 0
    v_mov_b32 v76, 0
    v_mov_b32 v77, 0
    v_mov_b32 v78, 0
    v_mov_b32 v79, 0
    v_mov_b32 v80, 0
    v_mov_b32 v81, 0
    v_mov_b32 v82, 0
    v_mov_b32 v83, 0
    v_mov_b32 v84, 0
    v_mov_b32 v85, 0
    v_mov_b32 v86, 0
    v_mov_b32 v87, 0
    v_mov_b32 v88, 0
    v_mov_b32 v89, 0
    v_mov_b32 v90, 0
    v_mov_b32 v91, 0
    v_mov_b32 v92, 0
    v_mov_b32 v93, 0
    v_mov_b32 v94, 0
    v_mov_b32 v95, 0
    v_mov_b32 v96, 0
    v_mov_b32 v97, 0
    v_mov_b32 v98, 0
    v_mov_b32 v99, 0
    v_mov_b32 v100, 0
    v_mov_b32 v101, 0
    v_mov_b32 v102, 0
    v_mov_b32 v103, 0
    s_setprio 3
    s_add_u32 m0, s26, 0
    s_nop 0
    buffer_load_dwordx4 v70, s[12:15], s27 offen sc1 lds
    s_add_u32 s27, s27, 8192
    s_setprio 2
    s_add_u32 m0, s26, 8192
    s_nop 0
    buffer_load_dwordx4 v70, s[12:15], s27 offen sc1 lds
    s_add_u32 s27, s27, 8192
    s_setprio 1
    s_add_u32 m0, s26, 16384
    s_nop 0
    buffer_load_dwordx4 v70, s[12:15], s27 offen sc1 lds
    s_add_u32 s27, s27, 8192
    s_setprio 0
    s_add_u32 m0, s26, 24576
    s_nop 0
    buffer_load_dwordx4 v70, s[12:15], s27 offen sc1 lds
    s_add_u32 s27, s27, 8192
    s_setprio 2
    s_waitcnt vmcnt(3)
    s_barrier
    ds_read_b128 v[8:11], v5 offset:0
    ds_read_b128 v[12:15], v1 offset:0
    ds_read_b128 v[16:19], v1 offset:256
    ds_read_b128 v[20:23], v1 offset:512
    ds_read_b128 v[24:27], v1 offset:768
    ds_read_b128 v[28:31], v5 offset:512
    ds_read_b128 v[32:35], v1 offset:4096
    ds_read_b128 v[36:39], v1 offset:4352
    ds_read_b128 v[40:43], v1 offset:4608
    ds_read_b128 v[44:47], v1 offset:4864
    s_waitcnt lgkmcnt(5)
    v_mfma_f32_16x16x32_bf16 v[72:75], v[112:115], v[8:11], v[72:75]
    v_mfma_f32_16x16x32_bf16 v[76:79], v[112:115], v[12:15], v[76:79]
    s_add_u32 m0, s26, 32768
    s_nop 0
    buffer_load_dwordx4 v70, s[12:15], s27 offen sc1 lds
    s_add_u32 s27, s27, 8192
    v_mfma_f32_16x16x32_bf16 v[80:83], v[112:115], v[16:19], v[80:83]
    v_mfma_f32_16x16x32_bf16 v[84:87], v[112:115], v[20:23], v[84:87]
    v_mfma_f32_16x16x32_bf16 v[88:91], v[112:115], v[24:27], v[88:91]
    v_mfma_f32_16x16x32_bf16 v[92:95], v[8:11], v[116:119], v[92:95]
    v_mfma_f32_16x16x32_bf16 v[96:99], v[12:15], v[116:119], v[96:99]
    v_mfma_f32_16x16x32_bf16 v[100:103], v[16:19], v[116:119], v[100:103]
    s_waitcnt vmcnt(2)
    s_barrier
    ds_read_b128 v[8:11], v5 offset:1024
    ds_read_b128 v[12:15], v1 offset:8192
    ds_read_b128 v[16:19], v1 offset:8448
    ds_read_b128 v[20:23], v1 offset:8704
    ds_read_b128 v[24:27], v1 offset:8960
    s_waitcnt lgkmcnt(5)
    v_mfma_f32_16x16x32_bf16 v[72:75], v[120:123], v[28:31], v[72:75]
    v_mfma_f32_16x16x32_bf16 v[76:79], v[120:123], v[32:35], v[76:79]
    v_mfma_f32_16x16x32_bf16 v[80:83], v[120:123], v[36:39], v[80:83]
    v_mfma_f32_16x16x32_bf16 v[84:87], v[120:123], v[40:43], v[84:87]
    v_mfma_f32_16x16x32_bf16 v[88:91], v[120:123], v[44:47], v[88:91]
    v_mfma_f32_16x16x32_bf16 v[92:95], v[28:31], v[124:127], v[92:95]
    v_mfma_f32_16x16x32_bf16 v[96:99], v[32:35], v[124:127], v[96:99]
    v_mfma_f32_16x16x32_bf16 v[100:103], v[36:39], v[124:127], v[100:103]
    ds_read_b128 v[28:31], v5 offset:1536
    ds_read_b128 v[32:35], v1 offset:12288
    ds_read_b128 v[36:39], v1 offset:12544
    ds_read_b128 v[40:43], v1 offset:12800
    ds_read_b128 v[44:47], v1 offset:13056
    s_waitcnt lgkmcnt(5)
    v_mfma_f32_16x16x32_bf16 v[72:75], v[128:131], v[8:11], v[72:75]
    v_mfma_f32_16x16x32_bf16 v[76:79], v[128:131], v[12:15], v[76:79]
    s_add_u32 m0, s26, 40960
    s_nop 0
    buffer_load_dwordx4 v70, s[12:15], s27 offen sc1 lds
    s_add_u32 s27, s27, 8192
    v_mfma_f32_16x16x32_bf16 v[80:83], v[128:131], v[16:19], v[80:83]
    v_mfma_f32_16x16x32_bf16 v[84:87], v[128:131], v[20:23], v[84:87]
    v_mfma_f32_16x16x32_bf16 v[88:91], v[128:131], v[24:27], v[88:91]
    v_mfma_f32_16x16x32_bf16 v[92:95], v[8:11], v[132:135], v[92:95]
    v_mfma_f32_16x16x32_bf16 v[96:99], v[12:15], v[132:135], v[96:99]
    v_mfma_f32_16x16x32_bf16 v[100:103], v[16:19], v[132:135], v[100:103]
    ds_read_b128 v[8:11], v5 offset:2048
    ds_read_b128 v[12:15], v1 offset:16384
    ds_read_b128 v[16:19], v1 offset:16640
    ds_read_b128 v[20:23], v1 offset:16896
    ds_read_b128 v[24:27], v1 offset:17152
    s_waitcnt lgkmcnt(5)
    v_mfma_f32_16x16x32_bf16 v[72:75], v[136:139], v[28:31], v[72:75]
    v_mfma_f32_16x16x32_bf16 v[76:79], v[136:139], v[32:35], v[76:79]
    v_mfma_f32_16x16x32_bf16 v[80:83], v[136:139], v[36:39], v[80:83]
    v_mfma_f32_16x16x32_bf16 v[84:87], v[136:139], v[40:43], v[84:87]
    v_mfma_f32_16x16x32_bf16 v[88:91], v[136:139], v[44:47], v[88:91]
    v_mfma_f32_16x16x32_bf16 v[92:95], v[28:31], v[140:143], v[92:95]
    v_mfma_f32_16x16x32_bf16 v[96:99], v[32:35], v[140:143], v[96:99]
    v_mfma_f32_16x16x32_bf16 v[100:103], v[36:39], v[140:143], v[100:103]
    ds_read_b128 v[28:31], v5 offset:2560
    ds_read_b128 v[32:35], v1 offset:20480
    ds_read_b128 v[36:39], v1 offset:20736
    ds_read_b128 v[40:43], v1 offset:20992
    ds_read_b128 v[44:47], v1 offset:21248
    s_waitcnt lgkmcnt(5)
    v_mfma_f32_16x16x32_bf16 v[72:75], v[144:147], v[8:11], v[72:75]
    v_mfma_f32_16x16x32_bf16 v[76:79], v[144:147], v[12:15], v[76:79]
    s_add_u32 m0, s26, 49152
    s_nop 0
    buffer_load_dwordx4 v70, s[12:15], s27 offen sc1 lds
    s_add_u32 s27, s27, 8192
    v_mfma_f32_16x16x32_bf16 v[80:83], v[144:147], v[16:19], v[80:83]
    v_mfma_f32_16x16x32_bf16 v[84:87], v[144:147], v[20:23], v[84:87]
    v_mfma_f32_16x16x32_bf16 v[88:91], v[144:147], v[24:27], v[88:91]
    v_mfma_f32_16x16x32_bf16 v[92:95], v[8:11], v[148:151], v[92:95]
    v_mfma_f32_16x16x32_bf16 v[96:99], v[12:15], v[148:151], v[96:99]
    v_mfma_f32_16x16x32_bf16 v[100:103], v[16:19], v[148:151], v[100:103]
    s_add_u32 s84, s28, 0
    buffer_load_dwordx4 v[112:115], v58, s[16:19], s84 offen
    s_add_u32 s84, s28, 0
    buffer_load_dwordx4 v[116:119], v59, s[16:19], s84 offen
    s_waitcnt vmcnt(4)
    s_barrier
    ds_read_b128 v[8:11], v5 offset:3072
    ds_read_b128 v[12:15], v1 offset:24576
    ds_read_b128 v[16:19], v1 offset:24832
    ds_read_b128 v[20:23], v1 offset:25088
    ds_read_b128 v[24:27], v1 offset:25344
    s_waitcnt lgkmcnt(5)
    v_mfma_f32_16x16x32_bf16 v[72:75], v[152:155], v[28:31], v[72:75]
    v_mfma_f32_16x16x32_bf16 v[76:79], v[152:155], v[32:35], v[76:79]
    v_mfma_f32_16x16x32_bf16 v[80:83], v[152:155], v[36:39], v[80:83]
    v_mfma_f32_16x16x32_bf16 v[84:87], v[152:155], v[40:43], v[84:87]
    v_mfma_f32_16x16x32_bf16 v[88:91], v[152:155], v[44:47], v[88:91]
    v_mfma_f32_16x16x32_bf16 v[92:95], v[28:31], v[156:159], v[92:95]
    v_mfma_f32_16x16x32_bf16 v[96:99], v[32:35], v[156:159], v[96:99]
    v_mfma_f32_16x16x32_bf16 v[100:103], v[36:39], v[156:159], v[100:103]
    s_add_u32 s84, s28, 13824
    buffer_load_dwordx4 v[120:123], v58, s[16:19], s84 offen
    s_add_u32 s84, s28, 13824
    buffer_load_dwordx4 v[124:127], v59, s[16:19], s84 offen
    ds_read_b128 v[28:31], v5 offset:3584
    ds_read_b128 v[32:35], v1 offset:28672
    ds_read_b128 v[36:39], v1 offset:28928
    ds_read_b128 v[40:43], v1 offset:29184
    ds_read_b128 v[44:47], v1 offset:29440
    s_waitcnt lgkmcnt(5)
    v_mfma_f32_16x16x32_bf16 v[72:75], v[160:163], v[8:11], v[72:75]
    v_mfma_f32_16x16x32_bf16 v[76:79], v[160:163], v[12:15], v[76:79]
    s_add_u32 m0, s26, 57344
    s_nop 0
    buffer_load_dwordx4 v70, s[12:15], s27 offen sc1 lds
    s_add_u32 s27, s27, 8192
    v_mfma_f32_16x16x32_bf16 v[80:83], v[160:163], v[16:19], v[80:83]
    v_mfma_f32_16x16x32_bf16 v[84:87], v[160:163], v[20:23], v[84:87]
    v_mfma_f32_16x16x32_bf16 v[88:91], v[160:163], v[24:27], v[88:91]
    v_mfma_f32_16x16x32_bf16 v[92:95], v[8:11], v[164:167], v[92:95]
    v_mfma_f32_16x16x32_bf16 v[96:99], v[12:15], v[164:167], v[96:99]
    v_mfma_f32_16x16x32_bf16 v[100:103], v[16:19], v[164:167], v[100:103]
    s_add_u32 s84, s28, 27648
    buffer_load_dwordx4 v[128:131], v58, s[16:19], s84 offen
    s_add_u32 s84, s28, 27648
    buffer_load_dwordx4 v[132:135], v59, s[16:19], s84 offen
    ds_read_b128 v[8:11], v5 offset:4096
    ds_read_b128 v[12:15], v1 offset:32768
    ds_read_b128 v[16:19], v1 offset:33024
    ds_read_b128 v[20:23], v1 offset:33280
    ds_read_b128 v[24:27], v1 offset:33536
    s_waitcnt lgkmcnt(5)
    v_mfma_f32_16x16x32_bf16 v[72:75], v[168:171], v[28:31], v[72:75]
    v_mfma_f32_16x16x32_bf16 v[76:79], v[168:171], v[32:35], v[76:79]
    v_mfma_f32_16x16x32_bf16 v[80:83], v[168:171], v[36:39], v[80:83]
    v_mfma_f32_16x16x32_bf16 v[84:87], v[168:171], v[40:43], v[84:87]
    v_mfma_f32_16x16x32_bf16 v[88:91], v[168:171], v[44:47], v[88:91]
    v_mfma_f32_16x16x32_bf16 v[92:95], v[28:31], v[172:175], v[92:95]
    v_mfma_f32_16x16x32_bf16 v[96:99], v[32:35], v[172:175], v[96:99]
    v_mfma_f32_16x16x32_bf16 v[100:103], v[36:39], v[172:175], v[100:103]
    s_add_u32 s84, s28, 41472
    buffer_load_dwordx4 v[136:139], v58, s[16:19], s84 offen
    s_add_u32 s84, s28, 41472
    buffer_load_dwordx4 v[140:143], v59, s[16:19], s84 offen
    ds_read_b128 v[28:31], v5 offset:4608
    ds_read_b128 v[32:35], v4 offset:0
    ds_read_b128 v[36:39], v4 offset:256
    ds_read_b128 v[40:43], v4 offset:512
    ds_read_b128 v[44:47], v4 offset:768
    s_waitcnt lgkmcnt(5)
    v_mfma_f32_16x16x32_bf16 v[72:75], v[176:179], v[8:11], v[72:75]
    v_mfma_f32_16x16x32_bf16 v[76:79], v[176:179], v[12:15], v[76:79]
    s_add_u32 m0, s26, 65536
    s_nop 0
    buffer_load_dwordx4 v70, s[12:15], s27 offen sc1 lds
    s_add_u32 s27, s27, 8192
    v_mfma_f32_16x16x32_bf16 v[80:83], v[176:179], v[16:19], v[80:83]
    v_mfma_f32_16x16x32_bf16 v[84:87], v[176:179], v[20:23], v[84:87]
    v_mfma_f32_16x16x32_bf16 v[88:91], v[176:179], v[24:27], v[88:91]
    v_mfma_f32_16x16x32_bf16 v[92:95], v[8:11], v[180:183], v[92:95]
    v_mfma_f32_16x16x32_bf16 v[96:99], v[12:15], v[180:183], v[96:99]
    v_mfma_f32_16x16x32_bf16 v[100:103], v[16:19], v[180:183], v[100:103]
    s_add_u32 s84, s28, 55296
    buffer_load_dwordx4 v[144:147], v58, s[16:19], s84 offen
    s_add_u32 s84, s28, 55296
    buffer_load_dwordx4 v[148:151], v59, s[16:19], s84 offen
    s_waitcnt vmcnt(12)
    s_barrier
    ds_read_b128 v[8:11], v5 offset:5120
    ds_read_b128 v[12:15], v4 offset:4096
    ds_read_b128 v[16:19], v4 offset:4352
    ds_read_b128 v[20:23], v4 offset:4608
    ds_read_b128 v[24:27], v4 offset:4864
    s_waitcnt lgkmcnt(5)
    v_mfma_f32_16x16x32_bf16 v[72:75], v[184:187], v[28:31], v[72:75]
    v_mfma_f32_16x16x32_bf16 v[76:79], v[184:187], v[32:35], v[76:79]
    v_mfma_f32_16x16x32_bf16 v[80:83], v[184:187], v[36:39], v[80:83]
    v_mfma_f32_16x16x32_bf16 v[84:87], v[184:187], v[40:43], v[84:87]
    v_mfma_f32_16x16x32_bf16 v[88:91], v[184:187], v[44:47], v[88:91]
    v_mfma_f32_16x16x32_bf16 v[92:95], v[28:31], v[188:191], v[92:95]
    v_mfma_f32_16x16x32_bf16 v[96:99], v[32:35], v[188:191], v[96:99]
    v_mfma_f32_16x16x32_bf16 v[100:103], v[36:39], v[188:191], v[100:103]
    s_add_u32 s84, s28, 69120
    buffer_load_dwordx4 v[152:155], v58, s[16:19], s84 offen
    s_add_u32 s84, s28, 69120
    buffer_load_dwordx4 v[156:159], v59, s[16:19], s84 offen
    ds_read_b128 v[28:31], v5 offset:5632
    ds_read_b128 v[32:35], v4 offset:8192
    ds_read_b128 v[36:39], v4 offset:8448
    ds_read_b128 v[40:43], v4 offset:8704
    ds_read_b128 v[44:47], v4 offset:8960
    s_waitcnt lgkmcnt(5)
    v_mfma_f32_16x16x32_bf16 v[72:75], v[192:195], v[8:11], v[72:75]
    v_mfma_f32_16x16x32_bf16 v[76:79], v[192:195], v[12:15], v[76:79]
    v_mfma_f32_16x16x32_bf16 v[80:83], v[192:195], v[16:19], v[80:83]
    v_mfma_f32_16x16x32_bf16 v[84:87], v[192:195], v[20:23], v[84:87]
    v_mfma_f32_16x16x32_bf16 v[88:91], v[192:195], v[24:27], v[88:91]
    v_mfma_f32_16x16x32_bf16 v[92:95], v[8:11], v[196:199], v[92:95]
    v_mfma_f32_16x16x32_bf16 v[96:99], v[12:15], v[196:199], v[96:99]
    v_mfma_f32_16x16x32_bf16 v[100:103], v[16:19], v[196:199], v[100:103]
    s_add_u32 s84, s28, 82944
    buffer_load_dwordx4 v[160:163], v58, s[16:19], s84 offen
    s_add_u32 s84, s28, 82944
    buffer_load_dwordx4 v[164:167], v59, s[16:19], s84 offen
    ds_read_b128 v[8:11], v5 offset:6144
    ds_read_b128 v[12:15], v4 offset:12288
    ds_read_b128 v[16:19], v4 offset:12544
    ds_read_b128 v[20:23], v4 offset:12800
    ds_read_b128 v[24:27], v4 offset:13056
    s_waitcnt lgkmcnt(5)
    v_mfma_f32_16x16x32_bf16 v[72:75], v[200:203], v[28:31], v[72:75]
    v_mfma_f32_16x16x32_bf16 v[76:79], v[200:203], v[32:35], v[76:79]
    v_mfma_f32_16x16x32_bf16 v[80:83], v[200:203], v[36:39], v[80:83]
    v_mfma_f32_16x16x32_bf16 v[84:87], v[200:203], v[40:43], v[84:87]
    v_mfma_f32_16x16x32_bf16 v[88:91], v[200:203], v[44:47], v[88:91]
    v_mfma_f32_16x16x32_bf16 v[92:95], v[28:31], v[204:207], v[92:95]
    v_mfma_f32_16x16x32_bf16 v[96:99], v[32:35], v[204:207], v[96:99]
    v_mfma_f32_16x16x32_bf16 v[100:103], v[36:39], v[204:207], v[100:103]
    s_add_u32 s84, s28, 96768
    buffer_load_dwordx4 v[168:171], v58, s[16:19], s84 offen
    s_add_u32 s84, s28, 96768
    buffer_load_dwordx4 v[172:175], v59, s[16:19], s84 offen
    ds_read_b128 v[28:31], v5 offset:6656
    ds_read_b128 v[32:35], v4 offset:16384
    ds_read_b128 v[36:39], v4 offset:16640
    ds_read_b128 v[40:43], v4 offset:16896
    ds_read_b128 v[44:47], v4 offset:17152
    s_waitcnt lgkmcnt(5)
    v_mfma_f32_16x16x32_bf16 v[72:75], v[208:211], v[8:11], v[72:75]
    v_mfma_f32_16x16x32_bf16 v[76:79], v[208:211], v[12:15], v[76:79]
    v_mfma_f32_16x16x32_bf16 v[80:83], v[208:211], v[16:19], v[80:83]
    v_mfma_f32_16x16x32_bf16 v[84:87], v[208:211], v[20:23], v[84:87]
    v_mfma_f32_16x16x32_bf16 v[88:91], v[208:211], v[24:27], v[88:91]
    v_mfma_f32_16x16x32_bf16 v[92:95], v[8:11], v[212:215], v[92:95]
    v_mfma_f32_16x16x32_bf16 v[96:99], v[12:15], v[212:215], v[96:99]
    v_mfma_f32_16x16x32_bf16 v[100:103], v[16:19], v[212:215], v[100:103]
    s_add_u32 s84, s28, 110592
    buffer_load_dwordx4 v[176:179], v58, s[16:19], s84 offen
    s_add_u32 s84, s28, 110592
    buffer_load_dwordx4 v[180:183], v59, s[16:19], s84 offen
    s_waitcnt vmcnt(10)
    s_barrier
    ds_read_b128 v[8:11], v5 offset:7168
    ds_read_b128 v[12:15], v4 offset:20480
    ds_read_b128 v[16:19], v4 offset:20736
    ds_read_b128 v[20:23], v4 offset:20992
    ds_read_b128 v[24:27], v4 offset:21248
    s_waitcnt lgkmcnt(5)
    v_mfma_f32_16x16x32_bf16 v[72:75], v[216:219], v[28:31], v[72:75]
    v_mfma_f32_16x16x32_bf16 v[76:79], v[216:219], v[32:35], v[76:79]
    v_mfma_f32_16x16x32_bf16 v[80:83], v[216:219], v[36:39], v[80:83]
    v_mfma_f32_16x16x32_bf16 v[84:87], v[216:219], v[40:43], v[84:87]
    v_mfma_f32_16x16x32_bf16 v[88:91], v[216:219], v[44:47], v[88:91]
    v_mfma_f32_16x16x32_bf16 v[92:95], v[28:31], v[220:223], v[92:95]
    v_mfma_f32_16x16x32_bf16 v[96:99], v[32:35], v[220:223], v[96:99]
    v_mfma_f32_16x16x32_bf16 v[100:103], v[36:39], v[220:223], v[100:103]
    s_add_u32 s84, s28, 124416
    buffer_load_dwordx4 v[184:187], v58, s[16:19], s84 offen
    s_add_u32 s84, s28, 124416
    buffer_load_dwordx4 v[188:191], v59, s[16:19], s84 offen
    ds_read_b128 v[28:31], v5 offset:7680
    ds_read_b128 v[32:35], v4 offset:24576
    ds_read_b128 v[36:39], v4 offset:24832
    ds_read_b128 v[40:43], v4 offset:25088
    ds_read_b128 v[44:47], v4 offset:25344
    s_waitcnt lgkmcnt(5)
    v_mfma_f32_16x16x32_bf16 v[72:75], v[224:227], v[8:11], v[72:75]
    v_mfma_f32_16x16x32_bf16 v[76:79], v[224:227], v[12:15], v[76:79]
    v_mfma_f32_16x16x32_bf16 v[80:83], v[224:227], v[16:19], v[80:83]
    v_mfma_f32_16x16x32_bf16 v[84:87], v[224:227], v[20:23], v[84:87]
    v_mfma_f32_16x16x32_bf16 v[88:91], v[224:227], v[24:27], v[88:91]
    v_mfma_f32_16x16x32_bf16 v[92:95], v[8:11], v[228:231], v[92:95]
    v_mfma_f32_16x16x32_bf16 v[96:99], v[12:15], v[228:231], v[96:99]
    v_mfma_f32_16x16x32_bf16 v[100:103], v[16:19], v[228:231], v[100:103]
    s_add_u32 s84, s28, 138240
    buffer_load_dwordx4 v[192:195], v58, s[16:19], s84 offen
    s_add_u32 s84, s28, 138240
    buffer_load_dwordx4 v[196:199], v59, s[16:19], s84 offen
    ds_read_b128 v[8:11], v5 offset:8192
    ds_read_b128 v[12:15], v4 offset:28672
    ds_read_b128 v[16:19], v4 offset:28928
    ds_read_b128 v[20:23], v4 offset:29184
    ds_read_b128 v[24:27], v4 offset:29440
    s_waitcnt lgkmcnt(5)
    v_mfma_f32_16x16x32_bf16 v[72:75], v[232:235], v[28:31], v[72:75]
    v_mfma_f32_16x16x32_bf16 v[76:79], v[232:235], v[32:35], v[76:79]
    v_mfma_f32_16x16x32_bf16 v[80:83], v[232:235], v[36:39], v[80:83]
    v_mfma_f32_16x16x32_bf16 v[84:87], v[232:235], v[40:43], v[84:87]
    v_mfma_f32_16x16x32_bf16 v[88:91], v[232:235], v[44:47], v[88:91]
    v_mfma_f32_16x16x32_bf16 v[92:95], v[28:31], v[236:239], v[92:95]
    v_mfma_f32_16x16x32_bf16 v[96:99], v[32:35], v[236:239], v[96:99]
    v_mfma_f32_16x16x32_bf16 v[100:103], v[36:39], v[236:239], v[100:103]
    s_add_u32 s84, s28, 152064
    buffer_load_dwordx4 v[200:203], v58, s[16:19], s84 offen
    s_add_u32 s84, s28, 152064
    buffer_load_dwordx4 v[204:207], v59, s[16:19], s84 offen
    ds_read_b128 v[28:31], v5 offset:8704
    ds_read_b128 v[32:35], v4 offset:32768
    ds_read_b128 v[36:39], v4 offset:33024
    ds_read_b128 v[40:43], v4 offset:33280
    ds_read_b128 v[44:47], v4 offset:33536
    s_waitcnt lgkmcnt(5)
    v_mfma_f32_16x16x32_bf16 v[72:75], v[240:243], v[8:11], v[72:75]
    v_and_b32 v2, 15, v0
    v_lshrrev_b32 v3, 4, v0
    v_lshlrev_b32 v224, 2, v2
    v_lshlrev_b32 v225, 4, v3
    v_lshlrev_b32 v6, 3, v0
    v_mfma_f32_16x16x32_bf16 v[76:79], v[240:243], v[12:15], v[76:79]
    s_mul_i32 s5, s30, 2560
    s_add_u32 s5, s5, 128000
    v_add_u32 v226, s5, v6
    s_mul_i32 s5, s31, 2560
    s_add_u32 s5, s5, 128000
    v_mfma_f32_16x16x32_bf16 v[80:83], v[240:243], v[16:19], v[80:83]
    v_add_u32 v227, s5, v6
    s_and_b32 s7, s3, 1
    s_mul_i32 s7, s7, 896
    s_add_u32 s7, s7, 640
    s_add_u32 s5, s7, 288
    v_mfma_f32_16x16x32_bf16 v[84:87], v[240:243], v[20:23], v[84:87]
    v_add_u32 v232, s5, v225
    s_add_u32 s5, s7, 832
    v_add_u32 v233, s5, v224
    v_add_u32 v234, 128000, v6
    v_add_u32 v6, 256, v6
    v_mfma_f32_16x16x32_bf16 v[88:91], v[240:243], v[24:27], v[88:91]
    v_and_b32 v6, 0x1ff, v6
    v_add_u32 v235, 138240, v6
    v_lshlrev_b32 v3, 2, v3
    v_cmp_le_u32 s[80:81], v3, v2
    v_sub_u32 v6, v2, v3
    v_mfma_f32_16x16x32_bf16 v[92:95], v[8:11], v[244:247], v[92:95]
    v_mov_b32 v2, 0xf149f2ca
    s_cmp_lg_u32 s23, 0
    s_cselect_b32 s5, 8, 0
    v_add_u32 v3, 16, v6
    v_cmp_gt_u32 s[76:77], s5, v3
    v_mfma_f32_16x16x32_bf16 v[96:99], v[12:15], v[244:247], v[96:99]
    v_subrev_u32 v3, 0, v6
    v_cmp_gt_u32 s[78:79], 8, v3
    s_nop 0
    v_cndmask_b32 v228, v2, 0, s[76:77]
    v_cndmask_b32 v236, v2, 0, s[78:79]
    v_mfma_f32_16x16x32_bf16 v[100:103], v[16:19], v[244:247], v[100:103]
    v_add_u32 v3, 15, v6
    v_cmp_gt_u32 s[76:77], s5, v3
    v_subrev_u32 v3, 1, v6
    v_cmp_gt_u32 s[78:79], 8, v3
    s_nop 0
    s_waitcnt lgkmcnt(0)
    v_mfma_f32_16x16x32_bf16 v[72:75], v[248:251], v[28:31], v[72:75]
    v_cndmask_b32 v229, v2, 0, s[76:77]
    v_cndmask_b32 v237, v2, 0, s[78:79]
    v_add_u32 v3, 14, v6
    v_cmp_gt_u32 s[76:77], s5, v3
    v_subrev_u32 v3, 2, v6
    v_mfma_f32_16x16x32_bf16 v[76:79], v[248:251], v[32:35], v[76:79]
    v_cmp_gt_u32 s[78:79], 8, v3
    s_nop 0
    v_cndmask_b32 v230, v2, 0, s[76:77]
    v_cndmask_b32 v238, v2, 0, s[78:79]
    v_add_u32 v3, 13, v6
    v_mfma_f32_16x16x32_bf16 v[80:83], v[248:251], v[36:39], v[80:83]
    v_cmp_gt_u32 s[76:77], s5, v3
    v_subrev_u32 v3, 3, v6
    v_cmp_gt_u32 s[78:79], 8, v3
    s_nop 0
    v_cndmask_b32 v231, v2, 0, s[76:77]
    v_mfma_f32_16x16x32_bf16 v[84:87], v[248:251], v[40:43], v[84:87]
    v_cndmask_b32 v239, v2, 0, s[78:79]
    v_mfma_f32_16x16x32_bf16 v[88:91], v[248:251], v[44:47], v[88:91]
    v_mfma_f32_16x16x32_bf16 v[92:95], v[28:31], v[252:255], v[92:95]
    v_mfma_f32_16x16x32_bf16 v[96:99], v[32:35], v[252:255], v[96:99]
    v_mfma_f32_16x16x32_bf16 v[100:103], v[36:39], v[252:255], v[100:103]
    s_setprio 0
M_S4_epi:
    ds_read_b128 v[48:51], v232
    ds_read_b32 v52, v233
    ds_read2_b32 v[8:9], v224 offset0:0 offset1:80
    ds_read2_b32 v[10:11], v224 offset0:16 offset1:96
    ds_read2_b32 v[12:13], v224 offset0:32 offset1:112
    ds_read2_b32 v[14:15], v224 offset0:48 offset1:128
    ds_read2_b32 v[16:17], v224 offset0:64 offset1:144
    ds_read_b128 v[18:21], v225 offset:0
    ds_read_b128 v[22:25], v225 offset:320
    ds_read_b128 v[26:29], v225 offset:64
    ds_read_b128 v[30:33], v225 offset:384
    ds_read_b128 v[34:37], v225 offset:128
    ds_read_b128 v[38:41], v225 offset:448
    s_waitcnt lgkmcnt(0)
    v_mul_f32 v72, v72, v8
    v_mul_f32 v73, v73, v8
    v_mul_f32 v74, v74, v8
    v_mul_f32 v75, v75, v8
    v_mul_f32 v76, v76, v10
    v_mul_f32 v77, v77, v10
    v_mul_f32 v78, v78, v10
    v_mul_f32 v79, v79, v10
    v_mul_f32 v80, v80, v12
    v_mul_f32 v81, v81, v12
    v_mul_f32 v82, v82, v12
    v_mul_f32 v83, v83, v12
    v_mul_f32 v84, v84, v14
    v_mul_f32 v85, v85, v14
    v_mul_f32 v86, v86, v14
    v_mul_f32 v87, v87, v14
    v_mul_f32 v88, v88, v16
    v_mul_f32 v89, v89, v16
    v_mul_f32 v90, v90, v16
    v_mul_f32 v91, v91, v16
    v_fma_f32 v72, -v9, v48, v72
    v_fma_f32 v73, -v9, v49, v73
    v_fma_f32 v74, -v9, v50, v74
    v_fma_f32 v75, -v9, v51, v75
    v_fma_f32 v76, -v11, v48, v76
    v_fma_f32 v77, -v11, v49, v77
    v_fma_f32 v78, -v11, v50, v78
    v_fma_f32 v79, -v11, v51, v79
    v_fma_f32 v80, -v13, v48, v80
    v_fma_f32 v81, -v13, v49, v81
    v_fma_f32 v82, -v13, v50, v82
    v_fma_f32 v83, -v13, v51, v83
    v_fma_f32 v84, -v15, v48, v84
    v_fma_f32 v85, -v15, v49, v85
    v_fma_f32 v86, -v15, v50, v86
    v_fma_f32 v87, -v15, v51, v87
    v_fma_f32 v88, -v17, v48, v88
    v_fma_f32 v89, -v17, v49, v89
    v_fma_f32 v90, -v17, v50, v90
    v_fma_f32 v91, -v17, v51, v91
    v_cvt_pk_bf16_f32 v72, v72, v73
    v_cvt_pk_bf16_f32 v73, v74, v75
    ds_write_b64 v226, v[72:73] offset:0
    v_cvt_pk_bf16_f32 v76, v76, v77
    v_cvt_pk_bf16_f32 v77, v78, v79
    ds_write_b64 v226, v[76:77] offset:512
    v_cvt_pk_bf16_f32 v80, v80, v81
    v_cvt_pk_bf16_f32 v81, v82, v83
    ds_write_b64 v226, v[80:81] offset:1024
    v_cvt_pk_bf16_f32 v84, v84, v85
    v_cvt_pk_bf16_f32 v85, v86, v87
    ds_write_b64 v226, v[84:85] offset:1536
    v_cvt_pk_bf16_f32 v88, v88, v89
    v_cvt_pk_bf16_f32 v89, v90, v91
    ds_write_b64 v226, v[88:89] offset:2048
    v_mul_f32 v92, v92, v18
    v_mul_f32 v93, v93, v19
    v_mul_f32 v94, v94, v20
    v_mul_f32 v95, v95, v21
    v_mul_f32 v96, v96, v26
    v_mul_f32 v97, v97, v27
    v_mul_f32 v98, v98, v28
    v_mul_f32 v99, v99, v29
    v_mul_f32 v100, v100, v34
    v_mul_f32 v101, v101, v35
    v_mul_f32 v102, v102, v36
    v_mul_f32 v103, v103, v37
    v_fma_f32 v92, -v22, v52, v92
    v_fma_f32 v93, -v23, v52, v93
    v_fma_f32 v94, -v24, v52, v94
    v_fma_f32 v95, -v25, v52, v95
    v_fma_f32 v96, -v30, v52, v96
    v_fma_f32 v97, -v31, v52, v97
    v_fma_f32 v98, -v32, v52, v98
    v_fma_f32 v99, -v33, v52, v99
    v_fma_f32 v100, -v38, v52, v100
    v_fma_f32 v101, -v39, v52, v101
    v_fma_f32 v102, -v40, v52, v102
    v_fma_f32 v103, -v41, v52, v103
    v_cvt_pk_bf16_f32 v92, v92, v93
    v_cvt_pk_bf16_f32 v93, v94, v95
    ds_write_b64 v227, v[92:93] offset:0
    v_cvt_pk_bf16_f32 v96, v96, v97
    v_cvt_pk_bf16_f32 v97, v98, v99
    ds_write_b64 v227, v[96:97] offset:512
    v_cvt_pk_bf16_f32 v100, v100, v101
    v_cvt_pk_bf16_f32 v101, v102, v103
    ds_write_b64 v227, v[100:101] offset:1024
    s_branch M_att
M_S5:
    v_mov_b32 v72, 0
    v_mov_b32 v73, 0
    v_mov_b32 v74, 0
    v_mov_b32 v75, 0
    v_mov_b32 v76, 0
    v_mov_b32 v77, 0
    v_mov_b32 v78, 0
    v_mov_b32 v79, 0
    v_mov_b32 v80, 0
    v_mov_b32 v81, 0
    v_mov_b32 v82, 0
    v_mov_b32 v83, 0
    v_mov_b32 v84, 0
    v_mov_b32 v85, 0
    v_mov_b32 v86, 0
    v_mov_b32 v87, 0
    v_mov_b32 v88, 0
    v_mov_b32 v89, 0
    v_mov_b32 v90, 0
    v_mov_b32 v91, 0
    v_mov_b32 v92, 0
    v_mov_b32 v93, 0
    v_mov_b32 v94, 0
    v_mov_b32 v95, 0
    v_mov_b32 v96, 0
    v_mov_b32 v97, 0
    v_mov_b32 v98, 0
    v_mov_b32 v99, 0
    s_setprio 3
    s_add_u32 m0, s26, 0
    s_nop 0
    buffer_load_dwordx4 v70, s[12:15], s27 offen sc1 lds
    s_add_u32 s27, s27, 8192
    buffer_load_dwordx4 v[112:115], v58, s[16:19], s86 offen
    buffer_load_dwordx4 v[116:119], v59, s[16:19], s86 offen
    s_add_u32 s86, s86, 13824
    buffer_load_dwordx4 v[120:123], v58, s[16:19], s86 offen
    buffer_load_dwordx4 v[124:127], v59, s[16:19], s86 offen
    s_add_u32 s86, s86, 13824
    s_setprio 2
    s_add_u32 m0, s26, 8192
    s_nop 0
    buffer_load_dwordx4 v70, s[12:15], s27 offen sc1 lds
    s_add_u32 s27, s27, 8192
    buffer_load_dwordx4 v[128:131], v58, s[16:19], s86 offen
    buffer_load_dwordx4 v[132:135], v59, s[16:19], s86 offen
    s_add_u32 s86, s86, 13824
    buffer_load_dwordx4 v[136:139], v58, s[16:19], s86 offen
    buffer_load_dwordx4 v[140:143], v59, s[16:19], s86 offen
    s_add_u32 s86, s86, 13824
    s_lshl_b32 s5, s3, 18
    s_lshl_b32 s6, s21, 13
    s_add_u32 s5, s5, s6
    s_add_u32 s5, s5, 29360128
    v_lshrrev_b32 v2, 2, v0
    v_and_b32 v3, 3, v0
    v_lshlrev_b32 v3, 4, v3
    v_lshl_add_u32 v2, v2, 9, v3
    v_bfrev_b32 v3, 1
    s_cmp_eq_u32 s23, 0
    s_cselect_b64 vcc, -1, 0
    s_sub_u32 s5, s5, 7744
    s_nop 0
    v_cndmask_b32 v2, v2, v3, vcc
    buffer_load_dwordx4 v[100:103], v2, s[12:15], s5 offen sc1
    s_setprio 1
    s_add_u32 m0, s26, 16384
    s_nop 0
    buffer_load_dwordx4 v70, s[12:15], s27 offen sc1 lds
    s_add_u32 s27, s27, 8192
    buffer_load_dwordx4 v[144:147], v58, s[16:19], s86 offen
    buffer_load_dwordx4 v[148:151], v59, s[16:19], s86 offen
    s_add_u32 s86, s86, 13824
    buffer_load_dwordx4 v[152:155], v58, s[16:19], s86 offen
    buffer_load_dwordx4 v[156:159], v59, s[16:19], s86 offen
    s_add_u32 s86, s86, 13824
    s_setprio 0
    s_add_u32 m0, s26, 24576
    s_nop 0
    buffer_load_dwordx4 v70, s[12:15], s27 offen sc1 lds
    s_add_u32 s27, s27, 8192
    buffer_load_dwordx4 v[160:163], v58, s[16:19], s86 offen
    buffer_load_dwordx4 v[164:167], v59, s[16:19], s86 offen
    s_add_u32 s86, s86, 13824
    buffer_load_dwordx4 v[168:171], v58, s[16:19], s86 offen
    buffer_load_dwordx4 v[172:175], v59, s[16:19], s86 offen
    s_add_u32 s86, s86, 13824
    s_setprio 0
    buffer_load_dwordx4 v[176:179], v58, s[16:19], s86 offen
    buffer_load_dwordx4 v[180:183], v59, s[16:19], s86 offen
    s_add_u32 s86, s86, 13824
    buffer_load_dwordx4 v[184:187], v58, s[16:19], s86 offen
    buffer_load_dwordx4 v[188:191], v59, s[16:19], s86 offen
    s_add_u32 s86, s86, 13824
    s_setprio 2
    s_waitcnt vmcnt(24)
    s_barrier
    ds_read_b128 v[8:11], v5 offset:0
    ds_read_b128 v[12:15], v1 offset:0
    ds_read_b128 v[16:19], v1 offset:256
    ds_read_b128 v[20:23], v1 offset:512
    ds_read_b128 v[24:27], v1 offset:768
    ds_read_b128 v[28:31], v5 offset:512
    ds_read_b128 v[32:35], v1 offset:4096
    ds_read_b128 v[36:39], v1 offset:4352
    ds_read_b128 v[40:43], v1 offset:4608
    ds_read_b128 v[44:47], v1 offset:4864
    s_waitcnt lgkmcnt(5)
    s_waitcnt vmcnt(22)
    v_mfma_f32_16x16x32_bf16 v[72:75], v[112:115], v[8:11], v[72:75]
    v_mfma_f32_16x16x32_bf16 v[76:79], v[112:115], v[12:15], v[76:79]
    s_add_u32 m0, s26, 32768
    s_nop 0
    buffer_load_dwordx4 v70, s[12:15], s27 offen sc1 lds
    s_add_u32 s27, s27, 8192
    buffer_load_dwordx4 v[192:195], v58, s[16:19], s86 offen
    buffer_load_dwordx4 v[196:199], v59, s[16:19], s86 offen
    s_add_u32 s86, s86, 13824
    v_mfma_f32_16x16x32_bf16 v[80:83], v[112:115], v[16:19], v[80:83]
    v_mfma_f32_16x16x32_bf16 v[84:87], v[112:115], v[20:23], v[84:87]
    v_mfma_f32_16x16x32_bf16 v[88:91], v[112:115], v[24:27], v[88:91]
    v_mfma_f32_16x16x32_bf16 v[92:95], v[20:23], v[116:119], v[92:95]
    v_mfma_f32_16x16x32_bf16 v[96:99], v[24:27], v[116:119], v[96:99]
    s_waitcnt vmcnt(16)
    s_barrier
    ds_read_b128 v[8:11], v5 offset:1024
    ds_read_b128 v[12:15], v1 offset:8192
    ds_read_b128 v[16:19], v1 offset:8448
    ds_read_b128 v[20:23], v1 offset:8704
    ds_read_b128 v[24:27], v1 offset:8960
    s_waitcnt lgkmcnt(5)
    v_mfma_f32_16x16x32_bf16 v[72:75], v[120:123], v[28:31], v[72:75]
    v_mfma_f32_16x16x32_bf16 v[76:79], v[120:123], v[32:35], v[76:79]
    buffer_load_dwordx4 v[200:203], v58, s[16:19], s86 offen
    buffer_load_dwordx4 v[204:207], v59, s[16:19], s86 offen
    s_add_u32 s86, s86, 13824
    v_mfma_f32_16x16x32_bf16 v[80:83], v[120:123], v[36:39], v[80:83]
    v_mfma_f32_16x16x32_bf16 v[84:87], v[120:123], v[40:43], v[84:87]
    v_mfma_f32_16x16x32_bf16 v[88:91], v[120:123], v[44:47], v[88:91]
    v_mfma_f32_16x16x32_bf16 v[92:95], v[40:43], v[124:127], v[92:95]
    v_mfma_f32_16x16x32_bf16 v[96:99], v[44:47], v[124:127], v[96:99]
    ds_read_b128 v[28:31], v5 offset:1536
    ds_read_b128 v[32:35], v1 offset:12288
    ds_read_b128 v[36:39], v1 offset:12544
    ds_read_b128 v[40:43], v1 offset:12800
    ds_read_b128 v[44:47], v1 offset:13056
    s_waitcnt lgkmcnt(5)
    v_mfma_f32_16x16x32_bf16 v[72:75], v[128:131], v[8:11], v[72:75]
    s_nop 1
    v_add_f32_dpp v100, v100, v100 row_ror:4 row_mask:0xf bank_mask:0xf
    v_add_f32_dpp v101, v101, v101 row_ror:4 row_mask:0xf bank_mask:0xf
    v_mfma_f32_16x16x32_bf16 v[76:79], v[128:131], v[12:15], v[76:79]
    v_add_f32_dpp v102, v102, v102 row_ror:4 row_mask:0xf bank_mask:0xf
    v_add_f32_dpp v103, v103, v103 row_ror:4 row_mask:0xf bank_mask:0xf
    s_nop 1
    s_add_u32 m0, s26, 40960
    s_nop 0
    buffer_load_dwordx4 v70, s[12:15], s27 offen sc1 lds
    s_add_u32 s27, s27, 8192
    buffer_load_dwordx4 v[208:211], v58, s[16:19], s86 offen
    buffer_load_dwordx4 v[212:215], v59, s[16:19], s86 offen
    s_add_u32 s86, s86, 13824
    v_mfma_f32_16x16x32_bf16 v[80:83], v[128:131], v[16:19], v[80:83]
    v_add_f32_dpp v100, v100, v100 row_ror:8 row_mask:0xf bank_mask:0xf
    v_add_f32_dpp v101, v101, v101 row_ror:8 row_mask:0xf bank_mask:0xf
    v_add_f32_dpp v102, v102, v102 row_ror:8 row_mask:0xf bank_mask:0xf
    v_mfma_f32_16x16x32_bf16 v[84:87], v[128:131], v[20:23], v[84:87]
    v_add_f32_dpp v103, v103, v103 row_ror:8 row_mask:0xf bank_mask:0xf
    v_mov_b32 v104, v100
    v_mov_b32 v105, v101
    v_mfma_f32_16x16x32_bf16 v[88:91], v[128:131], v[24:27], v[88:91]
    v_mov_b32 v106, v102
    v_mov_b32 v107, v103
    s_nop 1
    v_mfma_f32_16x16x32_bf16 v[92:95], v[20:23], v[132:135], v[92:95]
    v_permlane16_swap_b32 v100, v104
    v_permlane16_swap_b32 v101, v105
    v_permlane16_swap_b32 v102, v106
    v_mfma_f32_16x16x32_bf16 v[96:99], v[24:27], v[132:135], v[96:99]
    v_permlane16_swap_b32 v103, v107
    v_add_f32 v100, v100, v104
    v_add_f32 v101, v101, v105
    ds_read_b128 v[8:11], v5 offset:2048
    ds_read_b128 v[12:15], v1 offset:16384
    ds_read_b128 v[16:19], v1 offset:16640
    ds_read_b128 v[20:23], v1 offset:16896
    ds_read_b128 v[24:27], v1 offset:17152
    s_waitcnt lgkmcnt(5)
    v_mfma_f32_16x16x32_bf16 v[72:75], v[136:139], v[28:31], v[72:75]
    v_add_f32 v102, v102, v106
    v_add_f32 v103, v103, v107
    v_mov_b32 v104, v100
    v_mfma_f32_16x16x32_bf16 v[76:79], v[136:139], v[32:35], v[76:79]
    v_mov_b32 v105, v101
    v_mov_b32 v106, v102
    v_mov_b32 v107, v103
    buffer_load_dwordx4 v[216:219], v58, s[16:19], s86 offen
    buffer_load_dwordx4 v[220:223], v59, s[16:19], s86 offen
    s_add_u32 s86, s86, 13824
    v_mfma_f32_16x16x32_bf16 v[80:83], v[136:139], v[36:39], v[80:83]
    s_nop 1
    v_permlane32_swap_b32 v100, v104
    v_permlane32_swap_b32 v101, v105
    v_mfma_f32_16x16x32_bf16 v[84:87], v[136:139], v[40:43], v[84:87]
    v_permlane32_swap_b32 v102, v106
    v_permlane32_swap_b32 v103, v107
    v_add_f32 v100, v100, v104
    v_mfma_f32_16x16x32_bf16 v[88:91], v[136:139], v[44:47], v[88:91]
    v_add_f32 v101, v101, v105
    v_add_f32 v102, v102, v106
    v_add_f32 v103, v103, v107
    v_mfma_f32_16x16x32_bf16 v[92:95], v[40:43], v[140:143], v[92:95]
    s_mov_b32 s64, 0x3ae38e39
    s_mov_b32 s65, 0x3727c5ac
    v_mul_f32 v100, s64, v100
    v_mfma_f32_16x16x32_bf16 v[96:99], v[44:47], v[140:143], v[96:99]
    v_mul_f32 v101, s64, v101
    v_fma_f32 v101, -v100, v100, v101
    v_max_f32 v101, 0, v101
    ds_read_b128 v[28:31], v5 offset:2560
    ds_read_b128 v[32:35], v1 offset:20480
    ds_read_b128 v[36:39], v1 offset:20736
    ds_read_b128 v[40:43], v1 offset:20992
    ds_read_b128 v[44:47], v1 offset:21248
    s_waitcnt lgkmcnt(5)
    s_waitcnt vmcnt(21)
    v_mfma_f32_16x16x32_bf16 v[72:75], v[144:147], v[8:11], v[72:75]
    v_add_f32 v101, s65, v101
    v_rsq_f32 v101, v101
    v_mul_f32 v102, s64, v102
    v_mfma_f32_16x16x32_bf16 v[76:79], v[144:147], v[12:15], v[76:79]
    v_mul_f32 v103, s64, v103
    v_fma_f32 v103, -v102, v102, v103
    v_max_f32 v103, 0, v103
    s_add_u32 m0, s26, 49152
    s_nop 0
    buffer_load_dwordx4 v70, s[12:15], s27 offen sc1 lds
    s_add_u32 s27, s27, 8192
    buffer_load_dwordx4 v[224:227], v58, s[16:19], s86 offen
    buffer_load_dwordx4 v[228:231], v59, s[16:19], s86 offen
    s_add_u32 s86, s86, 13824
    v_mfma_f32_16x16x32_bf16 v[80:83], v[144:147], v[16:19], v[80:83]
    v_add_f32 v103, s65, v103
    v_rsq_f32 v103, v103
    s_nop 0
    v_mfma_f32_16x16x32_bf16 v[84:87], v[144:147], v[20:23], v[84:87]
    v_mul_f32 v100, v100, v101
    v_mul_f32 v102, v102, v103
    v_lshlrev_b32 v104, 3, v0
    v_mfma_f32_16x16x32_bf16 v[88:91], v[144:147], v[24:27], v[88:91]
    s_mov_b64 exec, 0xff
    ds_write2_b32 v104, v101, v103 offset0:0 offset1:1
    ds_write2_b32 v104, v100, v102 offset0:80 offset1:81
    s_mov_b64 exec, -1
    v_mfma_f32_16x16x32_bf16 v[92:95], v[20:23], v[148:151], v[92:95]
    v_mfma_f32_16x16x32_bf16 v[96:99], v[24:27], v[148:151], v[96:99]
    s_waitcnt vmcnt(12)
    s_barrier
    ds_read_b128 v[8:11], v5 offset:3072
    ds_read_b128 v[12:15], v1 offset:24576
    ds_read_b128 v[16:19], v1 offset:24832
    ds_read_b128 v[20:23], v1 offset:25088
    ds_read_b128 v[24:27], v1 offset:25344
    s_waitcnt lgkmcnt(5)
    v_mfma_f32_16x16x32_bf16 v[72:75], v[152:155], v[28:31], v[72:75]
    v_mfma_f32_16x16x32_bf16 v[76:79], v[152:155], v[32:35], v[76:79]
    buffer_load_dwordx4 v[232:235], v58, s[16:19], s86 offen
    buffer_load_dwordx4 v[236:239], v59, s[16:19], s86 offen
    s_add_u32 s86, s86, 13824
    v_mfma_f32_16x16x32_bf16 v[80:83], v[152:155], v[36:39], v[80:83]
    v_mfma_f32_16x16x32_bf16 v[84:87], v[152:155], v[40:43], v[84:87]
    v_mfma_f32_16x16x32_bf16 v[88:91], v[152:155], v[44:47], v[88:91]
    v_mfma_f32_16x16x32_bf16 v[92:95], v[40:43], v[156:159], v[92:95]
    v_mfma_f32_16x16x32_bf16 v[96:99], v[44:47], v[156:159], v[96:99]
    ds_read_b128 v[28:31], v5 offset:3584
    ds_read_b128 v[32:35], v1 offset:28672
    ds_read_b128 v[36:39], v1 offset:28928
    ds_read_b128 v[40:43], v1 offset:29184
    ds_read_b128 v[44:47], v1 offset:29440
    s_waitcnt lgkmcnt(5)
    v_mfma_f32_16x16x32_bf16 v[72:75], v[160:163], v[8:11], v[72:75]
    v_mfma_f32_16x16x32_bf16 v[76:79], v[160:163], v[12:15], v[76:79]
    s_add_u32 m0, s26, 57344
    s_nop 0
    buffer_load_dwordx4 v70, s[12:15], s27 offen sc1 lds
    s_add_u32 s27, s27, 8192
    buffer_load_dwordx4 v[240:243], v58, s[16:19], s86 offen
    buffer_load_dwordx4 v[244:247], v59, s[16:19], s86 offen
    s_add_u32 s86, s86, 13824
    v_mfma_f32_16x16x32_bf16 v[80:83], v[160:163], v[16:19], v[80:83]
    v_mfma_f32_16x16x32_bf16 v[84:87], v[160:163], v[20:23], v[84:87]
    v_mfma_f32_16x16x32_bf16 v[88:91], v[160:163], v[24:27], v[88:91]
    v_mfma_f32_16x16x32_bf16 v[92:95], v[20:23], v[164:167], v[92:95]
    v_mfma_f32_16x16x32_bf16 v[96:99], v[24:27], v[164:167], v[96:99]
    ds_read_b128 v[8:11], v5 offset:4096
    ds_read_b128 v[12:15], v1 offset:32768
    ds_read_b128 v[16:19], v1 offset:33024
    ds_read_b128 v[20:23], v1 offset:33280
    ds_read_b128 v[24:27], v1 offset:33536
    s_waitcnt lgkmcnt(5)
    v_mfma_f32_16x16x32_bf16 v[72:75], v[168:171], v[28:31], v[72:75]
    v_mfma_f32_16x16x32_bf16 v[76:79], v[168:171], v[32:35], v[76:79]
    buffer_load_dwordx4 v[248:251], v58, s[16:19], s86 offen
    buffer_load_dwordx4 v[252:255], v59, s[16:19], s86 offen
    s_add_u32 s86, s86, 13824
    v_mfma_f32_16x16x32_bf16 v[80:83], v[168:171], v[36:39], v[80:83]
    v_mfma_f32_16x16x32_bf16 v[84:87], v[168:171], v[40:43], v[84:87]
    v_mfma_f32_16x16x32_bf16 v[88:91], v[168:171], v[44:47], v[88:91]
    v_mfma_f32_16x16x32_bf16 v[92:95], v[40:43], v[172:175], v[92:95]
    v_mfma_f32_16x16x32_bf16 v[96:99], v[44:47], v[172:175], v[96:99]
    ds_read_b128 v[28:31], v5 offset:4608
    ds_read_b128 v[32:35], v4 offset:0
    ds_read_b128 v[36:39], v4 offset:256
    ds_read_b128 v[40:43], v4 offset:512
    ds_read_b128 v[44:47], v4 offset:768
    s_waitcnt lgkmcnt(5)
    v_mfma_f32_16x16x32_bf16 v[72:75], v[176:179], v[8:11], v[72:75]
    v_mfma_f32_16x16x32_bf16 v[76:79], v[176:179], v[12:15], v[76:79]
    s_add_u32 m0, s26, 65536
    s_nop 0
    buffer_load_dwordx4 v70, s[12:15], s27 offen sc1 lds
    s_add_u32 s27, s27, 8192
    v_mfma_f32_16x16x32_bf16 v[80:83], v[176:179], v[16:19], v[80:83]
    v_mfma_f32_16x16x32_bf16 v[84:87], v[176:179], v[20:23], v[84:87]
    v_mfma_f32_16x16x32_bf16 v[88:91], v[176:179], v[24:27], v[88:91]
    v_mfma_f32_16x16x32_bf16 v[92:95], v[20:23], v[180:183], v[92:95]
    v_mfma_f32_16x16x32_bf16 v[96:99], v[24:27], v[180:183], v[96:99]
    s_waitcnt vmcnt(10)
    s_barrier
    ds_read_b128 v[8:11], v5 offset:5120
    ds_read_b128 v[12:15], v4 offset:4096
    ds_read_b128 v[16:19], v4 offset:4352
    ds_read_b128 v[20:23], v4 offset:4608
    ds_read_b128 v[24:27], v4 offset:4864
    s_waitcnt lgkmcnt(5)
    v_mfma_f32_16x16x32_bf16 v[72:75], v[184:187], v[28:31], v[72:75]
    v_mfma_f32_16x16x32_bf16 v[76:79], v[184:187], v[32:35], v[76:79]
    v_mfma_f32_16x16x32_bf16 v[80:83], v[184:187], v[36:39], v[80:83]
    v_mfma_f32_16x16x32_bf16 v[84:87], v[184:187], v[40:43], v[84:87]
    v_mfma_f32_16x16x32_bf16 v[88:91], v[184:187], v[44:47], v[88:91]
    v_mfma_f32_16x16x32_bf16 v[92:95], v[40:43], v[188:191], v[92:95]
    v_mfma_f32_16x16x32_bf16 v[96:99], v[44:47], v[188:191], v[96:99]
    ds_read_b128 v[28:31], v5 offset:5632
    ds_read_b128 v[32:35], v4 offset:8192
    ds_read_b128 v[36:39], v4 offset:8448
    ds_read_b128 v[40:43], v4 offset:8704
    ds_read_b128 v[44:47], v4 offset:8960
    s_waitcnt lgkmcnt(5)
    v_mfma_f32_16x16x32_bf16 v[72:75], v[192:195], v[8:11], v[72:75]
    v_mfma_f32_16x16x32_bf16 v[76:79], v[192:195], v[12:15], v[76:79]
    v_mfma_f32_16x16x32_bf16 v[80:83], v[192:195], v[16:19], v[80:83]
    v_mfma_f32_16x16x32_bf16 v[84:87], v[192:195], v[20:23], v[84:87]
    v_mfma_f32_16x16x32_bf16 v[88:91], v[192:195], v[24:27], v[88:91]
    v_mfma_f32_16x16x32_bf16 v[92:95], v[20:23], v[196:199], v[92:95]
    v_mfma_f32_16x16x32_bf16 v[96:99], v[24:27], v[196:199], v[96:99]
    s_mul_i32 s5, s20, 9216
    s_add_u32 s5, s5, s24
    buffer_load_dwordx2 v[60:61], v67, s[12:15], s5 offen
    s_add_u32 s5, s5, 2048
    buffer_load_dwordx2 v[62:63], v67, s[12:15], s5 offen
    s_add_u32 s5, s5, 2048
    buffer_load_dwordx2 v[64:65], v67, s[12:15], s5 offen
    s_add_u32 s5, s5, 2048
    s_min_u32 s6, s87, 46080
    s_add_u32 m0, s6, 80896
    s_add_u32 s7, s6, s89
    buffer_load_dwordx4 v70, s[12:15], s7 offen lds
    s_add_u32 s87, s87, 7168
    ds_read_b128 v[8:11], v5 offset:6144
    ds_read_b128 v[12:15], v4 offset:12288
    ds_read_b128 v[16:19], v4 offset:12544
    ds_read_b128 v[20:23], v4 offset:12800
    ds_read_b128 v[24:27], v4 offset:13056
    s_waitcnt lgkmcnt(5)
    v_mfma_f32_16x16x32_bf16 v[72:75], v[200:203], v[28:31], v[72:75]
    v_mfma_f32_16x16x32_bf16 v[76:79], v[200:203], v[32:35], v[76:79]
    v_mfma_f32_16x16x32_bf16 v[80:83], v[200:203], v[36:39], v[80:83]
    v_mfma_f32_16x16x32_bf16 v[84:87], v[200:203], v[40:43], v[84:87]
    v_mfma_f32_16x16x32_bf16 v[88:91], v[200:203], v[44:47], v[88:91]
    v_mfma_f32_16x16x32_bf16 v[92:95], v[40:43], v[204:207], v[92:95]
    v_mfma_f32_16x16x32_bf16 v[96:99], v[44:47], v[204:207], v[96:99]
    s_min_u32 s6, s87, 46080
    s_add_u32 m0, s6, 80896
    s_add_u32 s7, s6, s89
    buffer_load_dwordx4 v70, s[12:15], s7 offen lds
    s_add_u32 s87, s87, 7168
    ds_read_b128 v[28:31], v5 offset:6656
    ds_read_b128 v[32:35], v4 offset:16384
    ds_read_b128 v[36:39], v4 offset:16640
    ds_read_b128 v[40:43], v4 offset:16896
    ds_read_b128 v[44:47], v4 offset:17152
    s_waitcnt lgkmcnt(5)
    v_mfma_f32_16x16x32_bf16 v[72:75], v[208:211], v[8:11], v[72:75]
    v_mfma_f32_16x16x32_bf16 v[76:79], v[208:211], v[12:15], v[76:79]
    v_mfma_f32_16x16x32_bf16 v[80:83], v[208:211], v[16:19], v[80:83]
    v_mfma_f32_16x16x32_bf16 v[84:87], v[208:211], v[20:23], v[84:87]
    v_mfma_f32_16x16x32_bf16 v[88:91], v[208:211], v[24:27], v[88:91]
    v_mfma_f32_16x16x32_bf16 v[92:95], v[20:23], v[212:215], v[92:95]
    v_mfma_f32_16x16x32_bf16 v[96:99], v[24:27], v[212:215], v[96:99]
    s_min_u32 s6, s87, 46080
    s_add_u32 m0, s6, 80896
    s_add_u32 s7, s6, s89
    buffer_load_dwordx4 v70, s[12:15], s7 offen lds
    s_add_u32 s87, s87, 7168
    s_waitcnt vmcnt(6)
    s_barrier
    ds_read_b128 v[8:11], v5 offset:7168
    ds_read_b128 v[12:15], v4 offset:20480
    ds_read_b128 v[16:19], v4 offset:20736
    ds_read_b128 v[20:23], v4 offset:20992
    ds_read_b128 v[24:27], v4 offset:21248
    s_waitcnt lgkmcnt(5)
    v_mfma_f32_16x16x32_bf16 v[72:75], v[216:219], v[28:31], v[72:75]
    v_mfma_f32_16x16x32_bf16 v[76:79], v[216:219], v[32:35], v[76:79]
    v_mfma_f32_16x16x32_bf16 v[80:83], v[216:219], v[36:39], v[80:83]
    v_mfma_f32_16x16x32_bf16 v[84:87], v[216:219], v[40:43], v[84:87]
    v_mfma_f32_16x16x32_bf16 v[88:91], v[216:219], v[44:47], v[88:91]
    v_mfma_f32_16x16x32_bf16 v[92:95], v[40:43], v[220:223], v[92:95]
    v_mfma_f32_16x16x32_bf16 v[96:99], v[44:47], v[220:223], v[96:99]
    s_min_u32 s6, s87, 46080
    s_add_u32 m0, s6, 80896
    s_add_u32 s7, s6, s89
    buffer_load_dwordx4 v70, s[12:15], s7 offen lds
    s_add_u32 s87, s87, 7168
    ds_read_b128 v[28:31], v5 offset:7680
    ds_read_b128 v[32:35], v4 offset:24576
    ds_read_b128 v[36:39], v4 offset:24832
    ds_read_b128 v[40:43], v4 offset:25088
    ds_read_b128 v[44:47], v4 offset:25344
    s_waitcnt lgkmcnt(5)
    v_mfma_f32_16x16x32_bf16 v[72:75], v[224:227], v[8:11], v[72:75]
    v_mfma_f32_16x16x32_bf16 v[76:79], v[224:227], v[12:15], v[76:79]
    v_mfma_f32_16x16x32_bf16 v[80:83], v[224:227], v[16:19], v[80:83]
    v_mfma_f32_16x16x32_bf16 v[84:87], v[224:227], v[20:23], v[84:87]
    v_mfma_f32_16x16x32_bf16 v[88:91], v[224:227], v[24:27], v[88:91]
    v_mfma_f32_16x16x32_bf16 v[92:95], v[20:23], v[228:231], v[92:95]
    v_mfma_f32_16x16x32_bf16 v[96:99], v[24:27], v[228:231], v[96:99]
    s_min_u32 s6, s87, 46080
    s_add_u32 m0, s6, 80896
    s_add_u32 s7, s6, s89
    buffer_load_dwordx4 v70, s[12:15], s7 offen lds
    s_add_u32 s87, s87, 7168
    ds_read_b128 v[8:11], v5 offset:8192
    ds_read_b128 v[12:15], v4 offset:28672
    ds_read_b128 v[16:19], v4 offset:28928
    ds_read_b128 v[20:23], v4 offset:29184
    ds_read_b128 v[24:27], v4 offset:29440
    s_waitcnt lgkmcnt(5)
    v_mfma_f32_16x16x32_bf16 v[72:75], v[232:235], v[28:31], v[72:75]
    v_mfma_f32_16x16x32_bf16 v[76:79], v[232:235], v[32:35], v[76:79]
    v_mfma_f32_16x16x32_bf16 v[80:83], v[232:235], v[36:39], v[80:83]
    v_mfma_f32_16x16x32_bf16 v[84:87], v[232:235], v[40:43], v[84:87]
    v_mfma_f32_16x16x32_bf16 v[88:91], v[232:235], v[44:47], v[88:91]
    v_mfma_f32_16x16x32_bf16 v[92:95], v[40:43], v[236:239], v[92:95]
    v_mfma_f32_16x16x32_bf16 v[96:99], v[44:47], v[236:239], v[96:99]
    s_min_u32 s6, s87, 46080
    s_add_u32 m0, s6, 80896
    s_add_u32 s7, s6, s89
    buffer_load_dwordx4 v70, s[12:15], s7 offen lds
    s_add_u32 s87, s87, 7168
    ds_read_b128 v[28:31], v5 offset:8704
    ds_read_b128 v[32:35], v4 offset:32768
    ds_read_b128 v[36:39], v4 offset:33024
    ds_read_b128 v[40:43], v4 offset:33280
    ds_read_b128 v[44:47], v4 offset:33536
    s_waitcnt lgkmcnt(5)
    v_mfma_f32_16x16x32_bf16 v[72:75], v[240:243], v[8:11], v[72:75]
    v_and_b32 v2, 15, v0
    v_lshrrev_b32 v3, 4, v0
    v_lshlrev_b32 v224, 2, v2
    v_lshlrev_b32 v225, 4, v3
    v_lshlrev_b32 v6, 3, v0
    v_mfma_f32_16x16x32_bf16 v[76:79], v[240:243], v[12:15], v[76:79]
    s_mul_i32 s5, s30, 2560
    s_add_u32 s5, s5, 128000
    v_add_u32 v226, s5, v6
    s_mul_i32 s5, s31, 2560
    s_add_u32 s5, s5, 128000
    v_mfma_f32_16x16x32_bf16 v[80:83], v[240:243], v[16:19], v[80:83]
    v_add_u32 v227, s5, v6
    s_and_b32 s7, s3, 1
    s_mul_i32 s7, s7, 896
    s_add_u32 s7, s7, 640
    s_add_u32 s5, s7, 352
    v_mfma_f32_16x16x32_bf16 v[84:87], v[240:243], v[20:23], v[84:87]
    v_add_u32 v232, s5, v225
    s_add_u32 s5, s7, 832
    v_add_u32 v233, s5, v224
    v_add_u32 v234, 128512, v6
    v_add_u32 v6, 256, v6
    v_mfma_f32_16x16x32_bf16 v[88:91], v[240:243], v[24:27], v[88:91]
    v_and_b32 v6, 0x1ff, v6
    v_add_u32 v235, 138752, v6
    v_lshlrev_b32 v3, 2, v3
    v_cmp_le_u32 s[80:81], v3, v2
    v_sub_u32 v6, v2, v3
    v_mfma_f32_16x16x32_bf16 v[92:95], v[20:23], v[244:247], v[92:95]
    v_mov_b32 v2, 0xf149f2ca
    s_mov_b32 s5, 8
    v_add_u32 v3, 16, v6
    v_cmp_gt_u32 s[76:77], s5, v3
    v_subrev_u32 v3, 0, v6
    v_mfma_f32_16x16x32_bf16 v[96:99], v[24:27], v[244:247], v[96:99]
    v_cmp_gt_u32 s[78:79], 8, v3
    s_nop 0
    v_cndmask_b32 v228, v2, 0, s[76:77]
    v_cndmask_b32 v236, v2, 0, s[78:79]
    v_add_u32 v3, 15, v6
    s_waitcnt lgkmcnt(0)
    v_mfma_f32_16x16x32_bf16 v[72:75], v[248:251], v[28:31], v[72:75]
    v_cmp_gt_u32 s[76:77], s5, v3
    v_subrev_u32 v3, 1, v6
    v_cmp_gt_u32 s[78:79], 8, v3
    s_nop 0
    v_cndmask_b32 v229, v2, 0, s[76:77]
    v_mfma_f32_16x16x32_bf16 v[76:79], v[248:251], v[32:35], v[76:79]
    v_cndmask_b32 v237, v2, 0, s[78:79]
    v_add_u32 v3, 14, v6
    v_cmp_gt_u32 s[76:77], s5, v3
    v_subrev_u32 v3, 2, v6
    v_cmp_gt_u32 s[78:79], 8, v3
    v_mfma_f32_16x16x32_bf16 v[80:83], v[248:251], v[36:39], v[80:83]
    s_nop 0
    v_cndmask_b32 v230, v2, 0, s[76:77]
    v_cndmask_b32 v238, v2, 0, s[78:79]
    v_add_u32 v3, 13, v6
    v_cmp_gt_u32 s[76:77], s5, v3
    v_mfma_f32_16x16x32_bf16 v[84:87], v[248:251], v[40:43], v[84:87]
    v_subrev_u32 v3, 3, v6
    v_cmp_gt_u32 s[78:79], 8, v3
    s_nop 0
    v_cndmask_b32 v231, v2, 0, s[76:77]
    v_cndmask_b32 v239, v2, 0, s[78:79]
    v_mfma_f32_16x16x32_bf16 v[88:91], v[248:251], v[44:47], v[88:91]
    v_mfma_f32_16x16x32_bf16 v[92:95], v[40:43], v[252:255], v[92:95]
    v_mfma_f32_16x16x32_bf16 v[96:99], v[44:47], v[252:255], v[96:99]
    s_setprio 0
    s_branch M_S5_epi
M_S5_loop:
    v_mov_b32 v72, 0
    v_mov_b32 v73, 0
    v_mov_b32 v74, 0
    v_mov_b32 v75, 0
    v_mov_b32 v76, 0
    v_mov_b32 v77, 0
    v_mov_b32 v78, 0
    v_mov_b32 v79, 0
    v_mov_b32 v80, 0
    v_mov_b32 v81, 0
    v_mov_b32 v82, 0
    v_mov_b32 v83, 0
    v_mov_b32 v84, 0
    v_mov_b32 v85, 0
    v_mov_b32 v86, 0
    v_mov_b32 v87, 0
    v_mov_b32 v88, 0
    v_mov_b32 v89, 0
    v_mov_b32 v90, 0
    v_mov_b32 v91, 0
    v_mov_b32 v92, 0
    v_mov_b32 v93, 0
    v_mov_b32 v94, 0
    v_mov_b32 v95, 0
    v_mov_b32 v96, 0
    v_mov_b32 v97, 0
    v_mov_b32 v98, 0
    v_mov_b32 v99, 0
    s_setprio 3
    s_add_u32 m0, s26, 0
    s_nop 0
    buffer_load_dwordx4 v70, s[12:15], s27 offen sc1 lds
    s_add_u32 s27, s27, 8192
    s_setprio 2
    s_add_u32 m0, s26, 8192
    s_nop 0
    buffer_load_dwordx4 v70, s[12:15], s27 offen sc1 lds
    s_add_u32 s27, s27, 8192
    s_lshl_b32 s5, s3, 18
    s_lshl_b32 s6, s21, 13
    s_add_u32 s5, s5, s6
    s_add_u32 s5, s5, 29360128
    v_lshrrev_b32 v2, 2, v0
    v_and_b32 v3, 3, v0
    v_lshlrev_b32 v3, 4, v3
    v_lshl_add_u32 v2, v2, 9, v3
    v_bfrev_b32 v3, 1
    s_cmp_eq_u32 s23, 0
    s_cselect_b64 vcc, -1, 0
    s_sub_u32 s5, s5, 7744
    s_nop 0
    v_cndmask_b32 v2, v2, v3, vcc
    buffer_load_dwordx4 v[100:103], v2, s[12:15], s5 offen sc1
    s_setprio 1
    s_add_u32 m0, s26, 16384
    s_nop 0
    buffer_load_dwordx4 v70, s[12:15], s27 offen sc1 lds
    s_add_u32 s27, s27, 8192
    s_setprio 0
    s_add_u32 m0, s26, 24576
    s_nop 0
    buffer_load_dwordx4 v70, s[12:15], s27 offen sc1 lds
    s_add_u32 s27, s27, 8192
    s_setprio 2
    s_waitcnt vmcnt(4)
    s_barrier
    ds_read_b128 v[8:11], v5 offset:0
    ds_read_b128 v[12:15], v1 offset:0
    ds_read_b128 v[16:19], v1 offset:256
    ds_read_b128 v[20:23], v1 offset:512
    ds_read_b128 v[24:27], v1 offset:768
    ds_read_b128 v[28:31], v5 offset:512
    ds_read_b128 v[32:35], v1 offset:4096
    ds_read_b128 v[36:39], v1 offset:4352
    ds_read_b128 v[40:43], v1 offset:4608
    ds_read_b128 v[44:47], v1 offset:4864
    s_waitcnt lgkmcnt(5)
    v_mfma_f32_16x16x32_bf16 v[72:75], v[112:115], v[8:11], v[72:75]
    v_mfma_f32_16x16x32_bf16 v[76:79], v[112:115], v[12:15], v[76:79]
    s_add_u32 m0, s26, 32768
    s_nop 0
    buffer_load_dwordx4 v70, s[12:15], s27 offen sc1 lds
    s_add_u32 s27, s27, 8192
    v_mfma_f32_16x16x32_bf16 v[80:83], v[112:115], v[16:19], v[80:83]
    v_mfma_f32_16x16x32_bf16 v[84:87], v[112:115], v[20:23], v[84:87]
    v_mfma_f32_16x16x32_bf16 v[88:91], v[112:115], v[24:27], v[88:91]
    v_mfma_f32_16x16x32_bf16 v[92:95], v[20:23], v[116:119], v[92:95]
    v_mfma_f32_16x16x32_bf16 v[96:99], v[24:27], v[116:119], v[96:99]
    s_waitcnt vmcnt(2)
    s_barrier
    ds_read_b128 v[8:11], v5 offset:1024
    ds_read_b128 v[12:15], v1 offset:8192
    ds_read_b128 v[16:19], v1 offset:8448
    ds_read_b128 v[20:23], v1 offset:8704
    ds_read_b128 v[24:27], v1 offset:8960
    s_waitcnt lgkmcnt(5)
    v_mfma_f32_16x16x32_bf16 v[72:75], v[120:123], v[28:31], v[72:75]
    v_mfma_f32_16x16x32_bf16 v[76:79], v[120:123], v[32:35], v[76:79]
    v_mfma_f32_16x16x32_bf16 v[80:83], v[120:123], v[36:39], v[80:83]
    v_mfma_f32_16x16x32_bf16 v[84:87], v[120:123], v[40:43], v[84:87]
    v_mfma_f32_16x16x32_bf16 v[88:91], v[120:123], v[44:47], v[88:91]
    v_mfma_f32_16x16x32_bf16 v[92:95], v[40:43], v[124:127], v[92:95]
    v_mfma_f32_16x16x32_bf16 v[96:99], v[44:47], v[124:127], v[96:99]
    ds_read_b128 v[28:31], v5 offset:1536
    ds_read_b128 v[32:35], v1 offset:12288
    ds_read_b128 v[36:39], v1 offset:12544
    ds_read_b128 v[40:43], v1 offset:12800
    ds_read_b128 v[44:47], v1 offset:13056
    s_waitcnt lgkmcnt(5)
    v_mfma_f32_16x16x32_bf16 v[72:75], v[128:131], v[8:11], v[72:75]
    s_nop 1
    v_add_f32_dpp v100, v100, v100 row_ror:4 row_mask:0xf bank_mask:0xf
    v_add_f32_dpp v101, v101, v101 row_ror:4 row_mask:0xf bank_mask:0xf
    v_mfma_f32_16x16x32_bf16 v[76:79], v[128:131], v[12:15], v[76:79]
    v_add_f32_dpp v102, v102, v102 row_ror:4 row_mask:0xf bank_mask:0xf
    v_add_f32_dpp v103, v103, v103 row_ror:4 row_mask:0xf bank_mask:0xf
    s_nop 1
    s_add_u32 m0, s26, 40960
    s_nop 0
    buffer_load_dwordx4 v70, s[12:15], s27 offen sc1 lds
    s_add_u32 s27, s27, 8192
    v_mfma_f32_16x16x32_bf16 v[80:83], v[128:131], v[16:19], v[80:83]
    v_add_f32_dpp v100, v100, v100 row_ror:8 row_mask:0xf bank_mask:0xf
    v_add_f32_dpp v101, v101, v101 row_ror:8 row_mask:0xf bank_mask:0xf
    v_add_f32_dpp v102, v102, v102 row_ror:8 row_mask:0xf bank_mask:0xf
    v_mfma_f32_16x16x32_bf16 v[84:87], v[128:131], v[20:23], v[84:87]
    v_add_f32_dpp v103, v103, v103 row_ror:8 row_mask:0xf bank_mask:0xf
    v_mov_b32 v104, v100
    v_mov_b32 v105, v101
    v_mfma_f32_16x16x32_bf16 v[88:91], v[128:131], v[24:27], v[88:91]
    v_mov_b32 v106, v102
    v_mov_b32 v107, v103
    s_nop 1
    v_mfma_f32_16x16x32_bf16 v[92:95], v[20:23], v[132:135], v[92:95]
    v_permlane16_swap_b32 v100, v104
    v_permlane16_swap_b32 v101, v105
    v_permlane16_swap_b32 v102, v106
    v_mfma_f32_16x16x32_bf16 v[96:99], v[24:27], v[132:135], v[96:99]
    v_permlane16_swap_b32 v103, v107
    v_add_f32 v100, v100, v104
    v_add_f32 v101, v101, v105
    ds_read_b128 v[8:11], v5 offset:2048
    ds_read_b128 v[12:15], v1 offset:16384
    ds_read_b128 v[16:19], v1 offset:16640
    ds_read_b128 v[20:23], v1 offset:16896
    ds_read_b128 v[24:27], v1 offset:17152
    s_waitcnt lgkmcnt(5)
    v_mfma_f32_16x16x32_bf16 v[72:75], v[136:139], v[28:31], v[72:75]
    v_add_f32 v102, v102, v106
    v_add_f32 v103, v103, v107
    v_mov_b32 v104, v100
    v_mfma_f32_16x16x32_bf16 v[76:79], v[136:139], v[32:35], v[76:79]
    v_mov_b32 v105, v101
    v_mov_b32 v106, v102
    v_mov_b32 v107, v103
    v_mfma_f32_16x16x32_bf16 v[80:83], v[136:139], v[36:39], v[80:83]
    s_nop 1
    v_permlane32_swap_b32 v100, v104
    v_permlane32_swap_b32 v101, v105
    v_mfma_f32_16x16x32_bf16 v[84:87], v[136:139], v[40:43], v[84:87]
    v_permlane32_swap_b32 v102, v106
    v_permlane32_swap_b32 v103, v107
    v_add_f32 v100, v100, v104
    v_mfma_f32_16x16x32_bf16 v[88:91], v[136:139], v[44:47], v[88:91]
    v_add_f32 v101, v101, v105
    v_add_f32 v102, v102, v106
    v_add_f32 v103, v103, v107
    v_mfma_f32_16x16x32_bf16 v[92:95], v[40:43], v[140:143], v[92:95]
    s_mov_b32 s64, 0x3ae38e39
    s_mov_b32 s65, 0x3727c5ac
    v_mul_f32 v100, s64, v100
    v_mfma_f32_16x16x32_bf16 v[96:99], v[44:47], v[140:143], v[96:99]
    v_mul_f32 v101, s64, v101
    v_fma_f32 v101, -v100, v100, v101
    v_max_f32 v101, 0, v101
    ds_read_b128 v[28:31], v5 offset:2560
    ds_read_b128 v[32:35], v1 offset:20480
    ds_read_b128 v[36:39], v1 offset:20736
    ds_read_b128 v[40:43], v1 offset:20992
    ds_read_b128 v[44:47], v1 offset:21248
    s_waitcnt lgkmcnt(5)
    v_mfma_f32_16x16x32_bf16 v[72:75], v[144:147], v[8:11], v[72:75]
    v_add_f32 v101, s65, v101
    v_rsq_f32 v101, v101
    v_mul_f32 v102, s64, v102
    v_mfma_f32_16x16x32_bf16 v[76:79], v[144:147], v[12:15], v[76:79]
    v_mul_f32 v103, s64, v103
    v_fma_f32 v103, -v102, v102, v103
    v_max_f32 v103, 0, v103
    s_add_u32 m0, s26, 49152
    s_nop 0
    buffer_load_dwordx4 v70, s[12:15], s27 offen sc1 lds
    s_add_u32 s27, s27, 8192
    v_mfma_f32_16x16x32_bf16 v[80:83], v[144:147], v[16:19], v[80:83]
    v_add_f32 v103, s65, v103
    v_rsq_f32 v103, v103
    s_nop 0
    v_mfma_f32_16x16x32_bf16 v[84:87], v[144:147], v[20:23], v[84:87]
    v_mul_f32 v100, v100, v101
    v_mul_f32 v102, v102, v103
    v_lshlrev_b32 v104, 3, v0
    v_mfma_f32_16x16x32_bf16 v[88:91], v[144:147], v[24:27], v[88:91]
    s_mov_b64 exec, 0xff
    ds_write2_b32 v104, v101, v103 offset0:0 offset1:1
    ds_write2_b32 v104, v100, v102 offset0:80 offset1:81
    s_mov_b64 exec, -1
    v_mfma_f32_16x16x32_bf16 v[92:95], v[20:23], v[148:151], v[92:95]
    v_mfma_f32_16x16x32_bf16 v[96:99], v[24:27], v[148:151], v[96:99]
    s_add_u32 s84, s28, 0
    buffer_load_dwordx4 v[112:115], v58, s[16:19], s84 offen
    s_add_u32 s84, s28, 0
    buffer_load_dwordx4 v[116:119], v59, s[16:19], s84 offen
    s_waitcnt vmcnt(4)
    s_barrier
    ds_read_b128 v[8:11], v5 offset:3072
    ds_read_b128 v[12:15], v1 offset:24576
    ds_read_b128 v[16:19], v1 offset:24832
    ds_read_b128 v[20:23], v1 offset:25088
    ds_read_b128 v[24:27], v1 offset:25344
    s_waitcnt lgkmcnt(5)
    v_mfma_f32_16x16x32_bf16 v[72:75], v[152:155], v[28:31], v[72:75]
    v_mfma_f32_16x16x32_bf16 v[76:79], v[152:155], v[32:35], v[76:79]
    v_mfma_f32_16x16x32_bf16 v[80:83], v[152:155], v[36:39], v[80:83]
    v_mfma_f32_16x16x32_bf16 v[84:87], v[152:155], v[40:43], v[84:87]
    v_mfma_f32_16x16x32_bf16 v[88:91], v[152:155], v[44:47], v[88:91]
    v_mfma_f32_16x16x32_bf16 v[92:95], v[40:43], v[156:159], v[92:95]
    v_mfma_f32_16x16x32_bf16 v[96:99], v[44:47], v[156:159], v[96:99]
    s_add_u32 s84, s28, 13824
    buffer_load_dwordx4 v[120:123], v58, s[16:19], s84 offen
    s_add_u32 s84, s28, 13824
    buffer_load_dwordx4 v[124:127], v59, s[16:19], s84 offen
    ds_read_b128 v[28:31], v5 offset:3584
    ds_read_b128 v[32:35], v1 offset:28672
    ds_read_b128 v[36:39], v1 offset:28928
    ds_read_b128 v[40:43], v1 offset:29184
    ds_read_b128 v[44:47], v1 offset:29440
    s_waitcnt lgkmcnt(5)
    v_mfma_f32_16x16x32_bf16 v[72:75], v[160:163], v[8:11], v[72:75]
    v_mfma_f32_16x16x32_bf16 v[76:79], v[160:163], v[12:15], v[76:79]
    s_add_u32 m0, s26, 57344
    s_nop 0
    buffer_load_dwordx4 v70, s[12:15], s27 offen sc1 lds
    s_add_u32 s27, s27, 8192
    v_mfma_f32_16x16x32_bf16 v[80:83], v[160:163], v[16:19], v[80:83]
    v_mfma_f32_16x16x32_bf16 v[84:87], v[160:163], v[20:23], v[84:87]
    v_mfma_f32_16x16x32_bf16 v[88:91], v[160:163], v[24:27], v[88:91]
    v_mfma_f32_16x16x32_bf16 v[92:95], v[20:23], v[164:167], v[92:95]
    v_mfma_f32_16x16x32_bf16 v[96:99], v[24:27], v[164:167], v[96:99]
    s_add_u32 s84, s28, 27648
    buffer_load_dwordx4 v[128:131], v58, s[16:19], s84 offen
    s_add_u32 s84, s28, 27648
    buffer_load_dwordx4 v[132:135], v59, s[16:19], s84 offen
    ds_read_b128 v[8:11], v5 offset:4096
    ds_read_b128 v[12:15], v1 offset:32768
    ds_read_b128 v[16:19], v1 offset:33024
    ds_read_b128 v[20:23], v1 offset:33280
    ds_read_b128 v[24:27], v1 offset:33536
    s_waitcnt lgkmcnt(5)
    v_mfma_f32_16x16x32_bf16 v[72:75], v[168:171], v[28:31], v[72:75]
    v_mfma_f32_16x16x32_bf16 v[76:79], v[168:171], v[32:35], v[76:79]
    v_mfma_f32_16x16x32_bf16 v[80:83], v[168:171], v[36:39], v[80:83]
    v_mfma_f32_16x16x32_bf16 v[84:87], v[168:171], v[40:43], v[84:87]
    v_mfma_f32_16x16x32_bf16 v[88:91], v[168:171], v[44:47], v[88:91]
    v_mfma_f32_16x16x32_bf16 v[92:95], v[40:43], v[172:175], v[92:95]
    v_mfma_f32_16x16x32_bf16 v[96:99], v[44:47], v[172:175], v[96:99]
    s_add_u32 s84, s28, 41472
    buffer_load_dwordx4 v[136:139], v58, s[16:19], s84 offen
    s_add_u32 s84, s28, 41472
    buffer_load_dwordx4 v[140:143], v59, s[16:19], s84 offen
    ds_read_b128 v[28:31], v5 offset:4608
    ds_read_b128 v[32:35], v4 offset:0
    ds_read_b128 v[36:39], v4 offset:256
    ds_read_b128 v[40:43], v4 offset:512
    ds_read_b128 v[44:47], v4 offset:768
    s_waitcnt lgkmcnt(5)
    v_mfma_f32_16x16x32_bf16 v[72:75], v[176:179], v[8:11], v[72:75]
    v_mfma_f32_16x16x32_bf16 v[76:79], v[176:179], v[12:15], v[76:79]
    s_add_u32 m0, s26, 65536
    s_nop 0
    buffer_load_dwordx4 v70, s[12:15], s27 offen sc1 lds
    s_add_u32 s27, s27, 8192
    v_mfma_f32_16x16x32_bf16 v[80:83], v[176:179], v[16:19], v[80:83]
    v_mfma_f32_16x16x32_bf16 v[84:87], v[176:179], v[20:23], v[84:87]
    v_mfma_f32_16x16x32_bf16 v[88:91], v[176:179], v[24:27], v[88:91]
    v_mfma_f32_16x16x32_bf16 v[92:95], v[20:23], v[180:183], v[92:95]
    v_mfma_f32_16x16x32_bf16 v[96:99], v[24:27], v[180:183], v[96:99]
    s_add_u32 s84, s28, 55296
    buffer_load_dwordx4 v[144:147], v58, s[16:19], s84 offen
    s_add_u32 s84, s28, 55296
    buffer_load_dwordx4 v[148:151], v59, s[16:19], s84 offen
    s_waitcnt vmcnt(12)
    s_barrier
    ds_read_b128 v[8:11], v5 offset:5120
    ds_read_b128 v[12:15], v4 offset:4096
    ds_read_b128 v[16:19], v4 offset:4352
    ds_read_b128 v[20:23], v4 offset:4608
    ds_read_b128 v[24:27], v4 offset:4864
    s_waitcnt lgkmcnt(5)
    v_mfma_f32_16x16x32_bf16 v[72:75], v[184:187], v[28:31], v[72:75]
    v_mfma_f32_16x16x32_bf16 v[76:79], v[184:187], v[32:35], v[76:79]
    v_mfma_f32_16x16x32_bf16 v[80:83], v[184:187], v[36:39], v[80:83]
    v_mfma_f32_16x16x32_bf16 v[84:87], v[184:187], v[40:43], v[84:87]
    v_mfma_f32_16x16x32_bf16 v[88:91], v[184:187], v[44:47], v[88:91]
    v_mfma_f32_16x16x32_bf16 v[92:95], v[40:43], v[188:191], v[92:95]
    v_mfma_f32_16x16x32_bf16 v[96:99], v[44:47], v[188:191], v[96:99]
    s_add_u32 s84, s28, 69120
    buffer_load_dwordx4 v[152:155], v58, s[16:19], s84 offen
    s_add_u32 s84, s28, 69120
    buffer_load_dwordx4 v[156:159], v59, s[16:19], s84 offen
    ds_read_b128 v[28:31], v5 offset:5632
    ds_read_b128 v[32:35], v4 offset:8192
    ds_read_b128 v[36:39], v4 offset:8448
    ds_read_b128 v[40:43], v4 offset:8704
    ds_read_b128 v[44:47], v4 offset:8960
    s_waitcnt lgkmcnt(5)
    v_mfma_f32_16x16x32_bf16 v[72:75], v[192:195], v[8:11], v[72:75]
    v_mfma_f32_16x16x32_bf16 v[76:79], v[192:195], v[12:15], v[76:79]
    v_mfma_f32_16x16x32_bf16 v[80:83], v[192:195], v[16:19], v[80:83]
    v_mfma_f32_16x16x32_bf16 v[84:87], v[192:195], v[20:23], v[84:87]
    v_mfma_f32_16x16x32_bf16 v[88:91], v[192:195], v[24:27], v[88:91]
    v_mfma_f32_16x16x32_bf16 v[92:95], v[20:23], v[196:199], v[92:95]
    v_mfma_f32_16x16x32_bf16 v[96:99], v[24:27], v[196:199], v[96:99]
    s_add_u32 s84, s28, 82944
    buffer_load_dwordx4 v[160:163], v58, s[16:19], s84 offen
    s_add_u32 s84, s28, 82944
    buffer_load_dwordx4 v[164:167], v59, s[16:19], s84 offen
    ds_read_b128 v[8:11], v5 offset:6144
    ds_read_b128 v[12:15], v4 offset:12288
    ds_read_b128 v[16:19], v4 offset:12544
    ds_read_b128 v[20:23], v4 offset:12800
    ds_read_b128 v[24:27], v4 offset:13056
    s_waitcnt lgkmcnt(5)
    v_mfma_f32_16x16x32_bf16 v[72:75], v[200:203], v[28:31], v[72:75]
    v_mfma_f32_16x16x32_bf16 v[76:79], v[200:203], v[32:35], v[76:79]
    v_mfma_f32_16x16x32_bf16 v[80:83], v[200:203], v[36:39], v[80:83]
    v_mfma_f32_16x16x32_bf16 v[84:87], v[200:203], v[40:43], v[84:87]
    v_mfma_f32_16x16x32_bf16 v[88:91], v[200:203], v[44:47], v[88:91]
    v_mfma_f32_16x16x32_bf16 v[92:95], v[40:43], v[204:207], v[92:95]
    v_mfma_f32_16x16x32_bf16 v[96:99], v[44:47], v[204:207], v[96:99]
    s_add_u32 s84, s28, 96768
    buffer_load_dwordx4 v[168:171], v58, s[16:19], s84 offen
    s_add_u32 s84, s28, 96768
    buffer_load_dwordx4 v[172:175], v59, s[16:19], s84 offen
    ds_read_b128 v[28:31], v5 offset:6656
    ds_read_b128 v[32:35], v4 offset:16384
    ds_read_b128 v[36:39], v4 offset:16640
    ds_read_b128 v[40:43], v4 offset:16896
    ds_read_b128 v[44:47], v4 offset:17152
    s_waitcnt lgkmcnt(5)
    v_mfma_f32_16x16x32_bf16 v[72:75], v[208:211], v[8:11], v[72:75]
    v_mfma_f32_16x16x32_bf16 v[76:79], v[208:211], v[12:15], v[76:79]
    v_mfma_f32_16x16x32_bf16 v[80:83], v[208:211], v[16:19], v[80:83]
    v_mfma_f32_16x16x32_bf16 v[84:87], v[208:211], v[20:23], v[84:87]
    v_mfma_f32_16x16x32_bf16 v[88:91], v[208:211], v[24:27], v[88:91]
    v_mfma_f32_16x16x32_bf16 v[92:95], v[20:23], v[212:215], v[92:95]
    v_mfma_f32_16x16x32_bf16 v[96:99], v[24:27], v[212:215], v[96:99]
    s_add_u32 s84, s28, 110592
    buffer_load_dwordx4 v[176:179], v58, s[16:19], s84 offen
    s_add_u32 s84, s28, 110592
    buffer_load_dwordx4 v[180:183], v59, s[16:19], s84 offen
    s_waitcnt vmcnt(10)
    s_barrier
    ds_read_b128 v[8:11], v5 offset:7168
    ds_read_b128 v[12:15], v4 offset:20480
    ds_read_b128 v[16:19], v4 offset:20736
    ds_read_b128 v[20:23], v4 offset:20992
    ds_read_b128 v[24:27], v4 offset:21248
    s_waitcnt lgkmcnt(5)
    v_mfma_f32_16x16x32_bf16 v[72:75], v[216:219], v[28:31], v[72:75]
    v_mfma_f32_16x16x32_bf16 v[76:79], v[216:219], v[32:35], v[76:79]
    v_mfma_f32_16x16x32_bf16 v[80:83], v[216:219], v[36:39], v[80:83]
    v_mfma_f32_16x16x32_bf16 v[84:87], v[216:219], v[40:43], v[84:87]
    v_mfma_f32_16x16x32_bf16 v[88:91], v[216:219], v[44:47], v[88:91]
    v_mfma_f32_16x16x32_bf16 v[92:95], v[40:43], v[220:223], v[92:95]
    v_mfma_f32_16x16x32_bf16 v[96:99], v[44:47], v[220:223], v[96:99]
    s_add_u32 s84, s28, 124416
    buffer_load_dwordx4 v[184:187], v58, s[16:19], s84 offen
    s_add_u32 s84, s28, 124416
    buffer_load_dwordx4 v[188:191], v59, s[16:19], s84 offen
    ds_read_b128 v[28:31], v5 offset:7680
    ds_read_b128 v[32:35], v4 offset:24576
    ds_read_b128 v[36:39], v4 offset:24832
    ds_read_b128 v[40:43], v4 offset:25088
    ds_read_b128 v[44:47], v4 offset:25344
    s_waitcnt lgkmcnt(5)
    v_mfma_f32_16x16x32_bf16 v[72:75], v[224:227], v[8:11], v[72:75]
    v_mfma_f32_16x16x32_bf16 v[76:79], v[224:227], v[12:15], v[76:79]
    v_mfma_f32_16x16x32_bf16 v[80:83], v[224:227], v[16:19], v[80:83]
    v_mfma_f32_16x16x32_bf16 v[84:87], v[224:227], v[20:23], v[84:87]
    v_mfma_f32_16x16x32_bf16 v[88:91], v[224:227], v[24:27], v[88:91]
    v_mfma_f32_16x16x32_bf16 v[92:95], v[20:23], v[228:231], v[92:95]
    v_mfma_f32_16x16x32_bf16 v[96:99], v[24:27], v[228:231], v[96:99]
    s_add_u32 s84, s28, 138240
    buffer_load_dwordx4 v[192:195], v58, s[16:19], s84 offen
    s_add_u32 s84, s28, 138240
    buffer_load_dwordx4 v[196:199], v59, s[16:19], s84 offen
    ds_read_b128 v[8:11], v5 offset:8192
    ds_read_b128 v[12:15], v4 offset:28672
    ds_read_b128 v[16:19], v4 offset:28928
    ds_read_b128 v[20:23], v4 offset:29184
    ds_read_b128 v[24:27], v4 offset:29440
    s_waitcnt lgkmcnt(5)
    v_mfma_f32_16x16x32_bf16 v[72:75], v[232:235], v[28:31], v[72:75]
    v_mfma_f32_16x16x32_bf16 v[76:79], v[232:235], v[32:35], v[76:79]
    v_mfma_f32_16x16x32_bf16 v[80:83], v[232:235], v[36:39], v[80:83]
    v_mfma_f32_16x16x32_bf16 v[84:87], v[232:235], v[40:43], v[84:87]
    v_mfma_f32_16x16x32_bf16 v[88:91], v[232:235], v[44:47], v[88:91]
    v_mfma_f32_16x16x32_bf16 v[92:95], v[40:43], v[236:239], v[92:95]
    v_mfma_f32_16x16x32_bf16 v[96:99], v[44:47], v[236:239], v[96:99]
    s_add_u32 s84, s28, 152064
    buffer_load_dwordx4 v[200:203], v58, s[16:19], s84 offen
    s_add_u32 s84, s28, 152064
    buffer_load_dwordx4 v[204:207], v59, s[16:19], s84 offen
    ds_read_b128 v[28:31], v5 offset:8704
    ds_read_b128 v[32:35], v4 offset:32768
    ds_read_b128 v[36:39], v4 offset:33024
    ds_read_b128 v[40:43], v4 offset:33280
    ds_read_b128 v[44:47], v4 offset:33536
    s_waitcnt lgkmcnt(5)
    v_mfma_f32_16x16x32_bf16 v[72:75], v[240:243], v[8:11], v[72:75]
    v_and_b32 v2, 15, v0
    v_lshrrev_b32 v3, 4, v0
    v_lshlrev_b32 v224, 2, v2
    v_lshlrev_b32 v225, 4, v3
    v_lshlrev_b32 v6, 3, v0
    v_mfma_f32_16x16x32_bf16 v[76:79], v[240:243], v[12:15], v[76:79]
    s_mul_i32 s5, s30, 2560
    s_add_u32 s5, s5, 128000
    v_add_u32 v226, s5, v6
    s_mul_i32 s5, s31, 2560
    s_add_u32 s5, s5, 128000
    v_mfma_f32_16x16x32_bf16 v[80:83], v[240:243], v[16:19], v[80:83]
    v_add_u32 v227, s5, v6
    s_and_b32 s7, s3, 1
    s_mul_i32 s7, s7, 896
    s_add_u32 s7, s7, 640
    s_add_u32 s5, s7, 352
    v_mfma_f32_16x16x32_bf16 v[84:87], v[240:243], v[20:23], v[84:87]
    v_add_u32 v232, s5, v225
    s_add_u32 s5, s7, 832
    v_add_u32 v233, s5, v224
    v_add_u32 v234, 128512, v6
    v_add_u32 v6, 256, v6
    v_mfma_f32_16x16x32_bf16 v[88:91], v[240:243], v[24:27], v[88:91]
    v_and_b32 v6, 0x1ff, v6
    v_add_u32 v235, 138752, v6
    v_lshlrev_b32 v3, 2, v3
    v_cmp_le_u32 s[80:81], v3, v2
    v_sub_u32 v6, v2, v3
    v_mfma_f32_16x16x32_bf16 v[92:95], v[20:23], v[244:247], v[92:95]
    v_mov_b32 v2, 0xf149f2ca
    s_mov_b32 s5, 8
    v_add_u32 v3, 16, v6
    v_cmp_gt_u32 s[76:77], s5, v3
    v_subrev_u32 v3, 0, v6
    v_mfma_f32_16x16x32_bf16 v[96:99], v[24:27], v[244:247], v[96:99]
    v_cmp_gt_u32 s[78:79], 8, v3
    s_nop 0
    v_cndmask_b32 v228, v2, 0, s[76:77]
    v_cndmask_b32 v236, v2, 0, s[78:79]
    v_add_u32 v3, 15, v6
    s_waitcnt lgkmcnt(0)
    v_mfma_f32_16x16x32_bf16 v[72:75], v[248:251], v[28:31], v[72:75]
    v_cmp_gt_u32 s[76:77], s5, v3
    v_subrev_u32 v3, 1, v6
    v_cmp_gt_u32 s[78:79], 8, v3
    s_nop 0
    v_cndmask_b32 v229, v2, 0, s[76:77]
    v_mfma_f32_16x16x32_bf16 v[76:79], v[248:251], v[32:35], v[76:79]
    v_cndmask_b32 v237, v2, 0, s[78:79]
    v_add_u32 v3, 14, v6
    v_cmp_gt_u32 s[76:77], s5, v3
    v_subrev_u32 v3, 2, v6
    v_cmp_gt_u32 s[78:79], 8, v3
    v_mfma_f32_16x16x32_bf16 v[80:83], v[248:251], v[36:39], v[80:83]
    s_nop 0
    v_cndmask_b32 v230, v2, 0, s[76:77]
    v_cndmask_b32 v238, v2, 0, s[78:79]
    v_add_u32 v3, 13, v6
    v_cmp_gt_u32 s[76:77], s5, v3
    v_mfma_f32_16x16x32_bf16 v[84:87], v[248:251], v[40:43], v[84:87]
    v_subrev_u32 v3, 3, v6
    v_cmp_gt_u32 s[78:79], 8, v3
    s_nop 0
    v_cndmask_b32 v231, v2, 0, s[76:77]
    v_cndmask_b32 v239, v2, 0, s[78:79]
    v_mfma_f32_16x16x32_bf16 v[88:91], v[248:251], v[44:47], v[88:91]
    v_mfma_f32_16x16x32_bf16 v[92:95], v[40:43], v[252:255], v[92:95]
    v_mfma_f32_16x16x32_bf16 v[96:99], v[44:47], v[252:255], v[96:99]
    s_setprio 0
M_S5_epi:
    ds_read_b128 v[48:51], v232
    ds_read_b32 v52, v233
    ds_read2_b32 v[8:9], v224 offset0:0 offset1:80
    ds_read2_b32 v[10:11], v224 offset0:16 offset1:96
    ds_read2_b32 v[12:13], v224 offset0:32 offset1:112
    ds_read2_b32 v[14:15], v224 offset0:48 offset1:128
    ds_read2_b32 v[16:17], v224 offset0:64 offset1:144
    ds_read_b128 v[18:21], v225 offset:192
    ds_read_b128 v[22:25], v225 offset:512
    ds_read_b128 v[26:29], v225 offset:256
    ds_read_b128 v[30:33], v225 offset:576
    s_waitcnt lgkmcnt(0)
    v_mul_f32 v72, v72, v8
    v_mul_f32 v73, v73, v8
    v_mul_f32 v74, v74, v8
    v_mul_f32 v75, v75, v8
    v_mul_f32 v76, v76, v10
    v_mul_f32 v77, v77, v10
    v_mul_f32 v78, v78, v10
    v_mul_f32 v79, v79, v10
    v_mul_f32 v80, v80, v12
    v_mul_f32 v81, v81, v12
    v_mul_f32 v82, v82, v12
    v_mul_f32 v83, v83, v12
    v_mul_f32 v84, v84, v14
    v_mul_f32 v85, v85, v14
    v_mul_f32 v86, v86, v14
    v_mul_f32 v87, v87, v14
    v_mul_f32 v88, v88, v16
    v_mul_f32 v89, v89, v16
    v_mul_f32 v90, v90, v16
    v_mul_f32 v91, v91, v16
    v_fma_f32 v72, -v9, v48, v72
    v_fma_f32 v73, -v9, v49, v73
    v_fma_f32 v74, -v9, v50, v74
    v_fma_f32 v75, -v9, v51, v75
    v_fma_f32 v76, -v11, v48, v76
    v_fma_f32 v77, -v11, v49, v77
    v_fma_f32 v78, -v11, v50, v78
    v_fma_f32 v79, -v11, v51, v79
    v_fma_f32 v80, -v13, v48, v80
    v_fma_f32 v81, -v13, v49, v81
    v_fma_f32 v82, -v13, v50, v82
    v_fma_f32 v83, -v13, v51, v83
    v_fma_f32 v84, -v15, v48, v84
    v_fma_f32 v85, -v15, v49, v85
    v_fma_f32 v86, -v15, v50, v86
    v_fma_f32 v87, -v15, v51, v87
    v_fma_f32 v88, -v17, v48, v88
    v_fma_f32 v89, -v17, v49, v89
    v_fma_f32 v90, -v17, v50, v90
    v_fma_f32 v91, -v17, v51, v91
    v_cvt_pk_bf16_f32 v72, v72, v73
    v_cvt_pk_bf16_f32 v73, v74, v75
    ds_write_b64 v226, v[72:73] offset:0
    v_cvt_pk_bf16_f32 v76, v76, v77
    v_cvt_pk_bf16_f32 v77, v78, v79
    ds_write_b64 v226, v[76:77] offset:512
    v_cvt_pk_bf16_f32 v80, v80, v81
    v_cvt_pk_bf16_f32 v81, v82, v83
    ds_write_b64 v226, v[80:81] offset:1024
    v_cvt_pk_bf16_f32 v84, v84, v85
    v_cvt_pk_bf16_f32 v85, v86, v87
    ds_write_b64 v226, v[84:85] offset:1536
    v_cvt_pk_bf16_f32 v88, v88, v89
    v_cvt_pk_bf16_f32 v89, v90, v91
    ds_write_b64 v226, v[88:89] offset:2048
    v_mul_f32 v92, v92, v18
    v_mul_f32 v93, v93, v19
    v_mul_f32 v94, v94, v20
    v_mul_f32 v95, v95, v21
    v_mul_f32 v96, v96, v26
    v_mul_f32 v97, v97, v27
    v_mul_f32 v98, v98, v28
    v_mul_f32 v99, v99, v29
    v_fma_f32 v92, -v22, v52, v92
    v_fma_f32 v93, -v23, v52, v93
    v_fma_f32 v94, -v24, v52, v94
    v_fma_f32 v95, -v25, v52, v95
    v_fma_f32 v96, -v30, v52, v96
    v_fma_f32 v97, -v31, v52, v97
    v_fma_f32 v98, -v32, v52, v98
    v_fma_f32 v99, -v33, v52, v99
    v_cvt_pk_bf16_f32 v92, v92, v93
    v_cvt_pk_bf16_f32 v93, v94, v95
    ds_write_b64 v227, v[92:93] offset:1536
    v_cvt_pk_bf16_f32 v96, v96, v97
    v_cvt_pk_bf16_f32 v97, v98, v99
    ds_write_b64 v227, v[96:97] offset:2048
    s_branch M_att
M_S6:
    v_mov_b32 v72, 0
    v_mov_b32 v73, 0
    v_mov_b32 v74, 0
    v_mov_b32 v75, 0
    v_mov_b32 v76, 0
    v_mov_b32 v77, 0
    v_mov_b32 v78, 0
    v_mov_b32 v79, 0
    v_mov_b32 v80, 0
    v_mov_b32 v81, 0
    v_mov_b32 v82, 0
    v_mov_b32 v83, 0
    v_mov_b32 v84, 0
    v_mov_b32 v85, 0
    v_mov_b32 v86, 0
    v_mov_b32 v87, 0
    v_mov_b32 v88, 0
    v_mov_b32 v89, 0
    v_mov_b32 v90, 0
    v_mov_b32 v91, 0
    v_mov_b32 v92, 0
    v_mov_b32 v93, 0
    v_mov_b32 v94, 0
    v_mov_b32 v95, 0
    v_mov_b32 v96, 0
    v_mov_b32 v97, 0
    v_mov_b32 v98, 0
    v_mov_b32 v99, 0
    v_mov_b32 v100, 0
    v_mov_b32 v101, 0
    v_mov_b32 v102, 0
    v_mov_b32 v103, 0
    s_setprio 3
    s_add_u32 m0, s26, 0
    s_nop 0
    buffer_load_dwordx4 v70, s[12:15], s27 offen sc1 lds
    s_add_u32 s27, s27, 8192
    buffer_load_dwordx4 v[112:115], v58, s[16:19], s86 offen
    buffer_load_dwordx4 v[116:119], v59, s[16:19], s86 offen
    s_add_u32 s86, s86, 13824
    buffer_load_dwordx4 v[120:123], v58, s[16:19], s86 offen
    buffer_load_dwordx4 v[124:127], v59, s[16:19], s86 offen
    s_add_u32 s86, s86, 13824
    s_setprio 2
    s_add_u32 m0, s26, 8192
    s_nop 0
    buffer_load_dwordx4 v70, s[12:15], s27 offen sc1 lds
    s_add_u32 s27, s27, 8192
    buffer_load_dwordx4 v[128:131], v58, s[16:19], s86 offen
    buffer_load_dwordx4 v[132:135], v59, s[16:19], s86 offen
    s_add_u32 s86, s86, 13824
    buffer_load_dwordx4 v[136:139], v58, s[16:19], s86 offen
    buffer_load_dwordx4 v[140:143], v59, s[16:19], s86 offen
    s_add_u32 s86, s86, 13824
    s_setprio 1
    s_add_u32 m0, s26, 16384
    s_nop 0
    buffer_load_dwordx4 v70, s[12:15], s27 offen sc1 lds
    s_add_u32 s27, s27, 8192
    buffer_load_dwordx4 v[144:147], v58, s[16:19], s86 offen
    buffer_load_dwordx4 v[148:151], v59, s[16:19], s86 offen
    s_add_u32 s86, s86, 13824
    buffer_load_dwordx4 v[152:155], v58, s[16:19], s86 offen
    buffer_load_dwordx4 v[156:159], v59, s[16:19], s86 offen
    s_add_u32 s86, s86, 13824
    s_setprio 0
    s_add_u32 m0, s26, 24576
    s_nop 0
    buffer_load_dwordx4 v70, s[12:15], s27 offen sc1 lds
    s_add_u32 s27, s27, 8192
    buffer_load_dwordx4 v[160:163], v58, s[16:19], s86 offen
    buffer_load_dwordx4 v[164:167], v59, s[16:19], s86 offen
    s_add_u32 s86, s86, 13824
    buffer_load_dwordx4 v[168:171], v58, s[16:19], s86 offen
    buffer_load_dwordx4 v[172:175], v59, s[16:19], s86 offen
    s_add_u32 s86, s86, 13824
    s_setprio 0
    buffer_load_dwordx4 v[176:179], v58, s[16:19], s86 offen
    buffer_load_dwordx4 v[180:183], v59, s[16:19], s86 offen
    s_add_u32 s86, s86, 13824
    buffer_load_dwordx4 v[184:187], v58, s[16:19], s86 offen
    buffer_load_dwordx4 v[188:191], v59, s[16:19], s86 offen
    s_add_u32 s86, s86, 13824
    v_mul_u32_u24 v2, 3641, v0
    v_lshrrev_b32 v2, 16, v2
    v_mul_u32_u24 v3, 2016, v2
    v_lshl_add_u32 v6, v0, 4, v3
    s_lshl_b32 s5, s25, 1
    s_add_u32 s5, s5, 28377088
    buffer_load_dwordx4 v[104:107], v6, s[12:15], s5 offen
    s_setprio 2
    s_waitcnt vmcnt(24)
    s_barrier
    ds_read_b128 v[8:11], v5 offset:0
    ds_read_b128 v[12:15], v1 offset:0
    ds_read_b128 v[16:19], v1 offset:256
    ds_read_b128 v[20:23], v1 offset:512
    ds_read_b128 v[24:27], v1 offset:768
    ds_read_b128 v[28:31], v5 offset:512
    ds_read_b128 v[32:35], v1 offset:4096
    ds_read_b128 v[36:39], v1 offset:4352
    ds_read_b128 v[40:43], v1 offset:4608
    ds_read_b128 v[44:47], v1 offset:4864
    s_waitcnt lgkmcnt(5)
    s_waitcnt vmcnt(22)
    v_mfma_f32_16x16x32_bf16 v[72:75], v[112:115], v[8:11], v[72:75]
    v_mfma_f32_16x16x32_bf16 v[76:79], v[112:115], v[12:15], v[76:79]
    s_add_u32 m0, s26, 32768
    s_nop 0
    buffer_load_dwordx4 v70, s[12:15], s27 offen sc1 lds
    s_add_u32 s27, s27, 8192
    buffer_load_dwordx4 v[192:195], v58, s[16:19], s86 offen
    buffer_load_dwordx4 v[196:199], v59, s[16:19], s86 offen
    s_add_u32 s86, s86, 13824
    v_mfma_f32_16x16x32_bf16 v[80:83], v[112:115], v[16:19], v[80:83]
    v_mfma_f32_16x16x32_bf16 v[84:87], v[112:115], v[20:23], v[84:87]
    v_mfma_f32_16x16x32_bf16 v[88:91], v[112:115], v[24:27], v[88:91]
    v_mfma_f32_16x16x32_bf16 v[92:95], v[116:119], v[8:11], v[92:95]
    v_mfma_f32_16x16x32_bf16 v[96:99], v[116:119], v[12:15], v[96:99]
    v_mfma_f32_16x16x32_bf16 v[100:103], v[116:119], v[16:19], v[100:103]
    s_waitcnt vmcnt(17)
    s_barrier
    ds_read_b128 v[8:11], v5 offset:1024
    ds_read_b128 v[12:15], v1 offset:8192
    ds_read_b128 v[16:19], v1 offset:8448
    ds_read_b128 v[20:23], v1 offset:8704
    ds_read_b128 v[24:27], v1 offset:8960
    s_waitcnt lgkmcnt(5)
    v_mfma_f32_16x16x32_bf16 v[72:75], v[120:123], v[28:31], v[72:75]
    v_mfma_f32_16x16x32_bf16 v[76:79], v[120:123], v[32:35], v[76:79]
    buffer_load_dwordx4 v[200:203], v58, s[16:19], s86 offen
    buffer_load_dwordx4 v[204:207], v59, s[16:19], s86 offen
    s_add_u32 s86, s86, 13824
    v_mfma_f32_16x16x32_bf16 v[80:83], v[120:123], v[36:39], v[80:83]
    v_mfma_f32_16x16x32_bf16 v[84:87], v[120:123], v[40:43], v[84:87]
    v_mfma_f32_16x16x32_bf16 v[88:91], v[120:123], v[44:47], v[88:91]
    v_mfma_f32_16x16x32_bf16 v[92:95], v[124:127], v[28:31], v[92:95]
    v_mfma_f32_16x16x32_bf16 v[96:99], v[124:127], v[32:35], v[96:99]
    v_mfma_f32_16x16x32_bf16 v[100:103], v[124:127], v[36:39], v[100:103]
    ds_read_b128 v[28:31], v5 offset:1536
    ds_read_b128 v[32:35], v1 offset:12288
    ds_read_b128 v[36:39], v1 offset:12544
    ds_read_b128 v[40:43], v1 offset:12800
    ds_read_b128 v[44:47], v1 offset:13056
    s_waitcnt lgkmcnt(5)
    v_mfma_f32_16x16x32_bf16 v[72:75], v[128:131], v[8:11], v[72:75]
    v_mfma_f32_16x16x32_bf16 v[76:79], v[128:131], v[12:15], v[76:79]
    s_add_u32 m0, s26, 40960
    s_nop 0
    buffer_load_dwordx4 v70, s[12:15], s27 offen sc1 lds
    s_add_u32 s27, s27, 8192
    buffer_load_dwordx4 v[208:211], v58, s[16:19], s86 offen
    buffer_load_dwordx4 v[212:215], v59, s[16:19], s86 offen
    s_add_u32 s86, s86, 13824
    v_mfma_f32_16x16x32_bf16 v[80:83], v[128:131], v[16:19], v[80:83]
    v_mfma_f32_16x16x32_bf16 v[84:87], v[128:131], v[20:23], v[84:87]
    v_mfma_f32_16x16x32_bf16 v[88:91], v[128:131], v[24:27], v[88:91]
    v_mfma_f32_16x16x32_bf16 v[92:95], v[132:135], v[8:11], v[92:95]
    v_mfma_f32_16x16x32_bf16 v[96:99], v[132:135], v[12:15], v[96:99]
    v_mfma_f32_16x16x32_bf16 v[100:103], v[132:135], v[16:19], v[100:103]
    ds_read_b128 v[8:11], v5 offset:2048
    ds_read_b128 v[12:15], v1 offset:16384
    ds_read_b128 v[16:19], v1 offset:16640
    ds_read_b128 v[20:23], v1 offset:16896
    ds_read_b128 v[24:27], v1 offset:17152
    s_waitcnt lgkmcnt(5)
    v_mfma_f32_16x16x32_bf16 v[72:75], v[136:139], v[28:31], v[72:75]
    v_mfma_f32_16x16x32_bf16 v[76:79], v[136:139], v[32:35], v[76:79]
    buffer_load_dwordx4 v[216:219], v58, s[16:19], s86 offen
    buffer_load_dwordx4 v[220:223], v59, s[16:19], s86 offen
    s_add_u32 s86, s86, 13824
    v_mfma_f32_16x16x32_bf16 v[80:83], v[136:139], v[36:39], v[80:83]
    v_mfma_f32_16x16x32_bf16 v[84:87], v[136:139], v[40:43], v[84:87]
    v_mfma_f32_16x16x32_bf16 v[88:91], v[136:139], v[44:47], v[88:91]
    v_mfma_f32_16x16x32_bf16 v[92:95], v[140:143], v[28:31], v[92:95]
    v_mfma_f32_16x16x32_bf16 v[96:99], v[140:143], v[32:35], v[96:99]
    v_mfma_f32_16x16x32_bf16 v[100:103], v[140:143], v[36:39], v[100:103]
    ds_read_b128 v[28:31], v5 offset:2560
    ds_read_b128 v[32:35], v1 offset:20480
    ds_read_b128 v[36:39], v1 offset:20736
    ds_read_b128 v[40:43], v1 offset:20992
    ds_read_b128 v[44:47], v1 offset:21248
    s_waitcnt lgkmcnt(5)
    s_waitcnt vmcnt(22)
    v_mfma_f32_16x16x32_bf16 v[72:75], v[144:147], v[8:11], v[72:75]
    v_mfma_f32_16x16x32_bf16 v[76:79], v[144:147], v[12:15], v[76:79]
    s_add_u32 m0, s26, 49152
    s_nop 0
    buffer_load_dwordx4 v70, s[12:15], s27 offen sc1 lds
    s_add_u32 s27, s27, 8192
    buffer_load_dwordx4 v[224:227], v58, s[16:19], s86 offen
    buffer_load_dwordx4 v[228:231], v59, s[16:19], s86 offen
    s_add_u32 s86, s86, 13824
    v_mfma_f32_16x16x32_bf16 v[80:83], v[144:147], v[16:19], v[80:83]
    v_mfma_f32_16x16x32_bf16 v[84:87], v[144:147], v[20:23], v[84:87]
    v_mfma_f32_16x16x32_bf16 v[88:91], v[144:147], v[24:27], v[88:91]
    v_mfma_f32_16x16x32_bf16 v[92:95], v[148:151], v[8:11], v[92:95]
    v_mfma_f32_16x16x32_bf16 v[96:99], v[148:151], v[12:15], v[96:99]
    v_mfma_f32_16x16x32_bf16 v[100:103], v[148:151], v[16:19], v[100:103]
    s_waitcnt vmcnt(12)
    s_barrier
    ds_read_b128 v[8:11], v5 offset:3072
    ds_read_b128 v[12:15], v1 offset:24576
    ds_read_b128 v[16:19], v1 offset:24832
    ds_read_b128 v[20:23], v1 offset:25088
    ds_read_b128 v[24:27], v1 offset:25344
    s_waitcnt lgkmcnt(5)
    v_mfma_f32_16x16x32_bf16 v[72:75], v[152:155], v[28:31], v[72:75]
    v_mfma_f32_16x16x32_bf16 v[76:79], v[152:155], v[32:35], v[76:79]
    buffer_load_dwordx4 v[232:235], v58, s[16:19], s86 offen
    buffer_load_dwordx4 v[236:239], v59, s[16:19], s86 offen
    s_add_u32 s86, s86, 13824
    v_mfma_f32_16x16x32_bf16 v[80:83], v[152:155], v[36:39], v[80:83]
    v_mfma_f32_16x16x32_bf16 v[84:87], v[152:155], v[40:43], v[84:87]
    v_mfma_f32_16x16x32_bf16 v[88:91], v[152:155], v[44:47], v[88:91]
    v_mfma_f32_16x16x32_bf16 v[92:95], v[156:159], v[28:31], v[92:95]
    v_mfma_f32_16x16x32_bf16 v[96:99], v[156:159], v[32:35], v[96:99]
    v_mfma_f32_16x16x32_bf16 v[100:103], v[156:159], v[36:39], v[100:103]
    ds_read_b128 v[28:31], v5 offset:3584
    ds_read_b128 v[32:35], v1 offset:28672
    ds_read_b128 v[36:39], v1 offset:28928
    ds_read_b128 v[40:43], v1 offset:29184
    ds_read_b128 v[44:47], v1 offset:29440
    s_waitcnt lgkmcnt(5)
    v_mfma_f32_16x16x32_bf16 v[72:75], v[160:163], v[8:11], v[72:75]
    v_mfma_f32_16x16x32_bf16 v[76:79], v[160:163], v[12:15], v[76:79]
    s_add_u32 m0, s26, 57344
    s_nop 0
    buffer_load_dwordx4 v70, s[12:15], s27 offen sc1 lds
    s_add_u32 s27, s27, 8192
    buffer_load_dwordx4 v[240:243], v58, s[16:19], s86 offen
    buffer_load_dwordx4 v[244:247], v59, s[16:19], s86 offen
    s_add_u32 s86, s86, 13824
    v_mfma_f32_16x16x32_bf16 v[80:83], v[160:163], v[16:19], v[80:83]
    v_mfma_f32_16x16x32_bf16 v[84:87], v[160:163], v[20:23], v[84:87]
    v_mfma_f32_16x16x32_bf16 v[88:91], v[160:163], v[24:27], v[88:91]
    v_mfma_f32_16x16x32_bf16 v[92:95], v[164:167], v[8:11], v[92:95]
    v_mfma_f32_16x16x32_bf16 v[96:99], v[164:167], v[12:15], v[96:99]
    v_mfma_f32_16x16x32_bf16 v[100:103], v[164:167], v[16:19], v[100:103]
    ds_read_b128 v[8:11], v5 offset:4096
    ds_read_b128 v[12:15], v1 offset:32768
    ds_read_b128 v[16:19], v1 offset:33024
    ds_read_b128 v[20:23], v1 offset:33280
    ds_read_b128 v[24:27], v1 offset:33536
    s_waitcnt lgkmcnt(5)
    v_mfma_f32_16x16x32_bf16 v[72:75], v[168:171], v[28:31], v[72:75]
    v_mfma_f32_16x16x32_bf16 v[76:79], v[168:171], v[32:35], v[76:79]
    buffer_load_dwordx4 v[248:251], v58, s[16:19], s86 offen
    buffer_load_dwordx4 v[252:255], v59, s[16:19], s86 offen
    s_add_u32 s86, s86, 13824
    v_mfma_f32_16x16x32_bf16 v[80:83], v[168:171], v[36:39], v[80:83]
    v_mfma_f32_16x16x32_bf16 v[84:87], v[168:171], v[40:43], v[84:87]
    v_mfma_f32_16x16x32_bf16 v[88:91], v[168:171], v[44:47], v[88:91]
    v_mfma_f32_16x16x32_bf16 v[92:95], v[172:175], v[28:31], v[92:95]
    v_mfma_f32_16x16x32_bf16 v[96:99], v[172:175], v[32:35], v[96:99]
    v_mfma_f32_16x16x32_bf16 v[100:103], v[172:175], v[36:39], v[100:103]
    ds_read_b128 v[28:31], v5 offset:4608
    ds_read_b128 v[32:35], v4 offset:0
    ds_read_b128 v[36:39], v4 offset:256
    ds_read_b128 v[40:43], v4 offset:512
    ds_read_b128 v[44:47], v4 offset:768
    s_waitcnt lgkmcnt(5)
    v_mfma_f32_16x16x32_bf16 v[72:75], v[176:179], v[8:11], v[72:75]
    v_mfma_f32_16x16x32_bf16 v[76:79], v[176:179], v[12:15], v[76:79]
    s_add_u32 m0, s26, 65536
    s_nop 0
    buffer_load_dwordx4 v70, s[12:15], s27 offen sc1 lds
    s_add_u32 s27, s27, 8192
    v_mfma_f32_16x16x32_bf16 v[80:83], v[176:179], v[16:19], v[80:83]
    v_mfma_f32_16x16x32_bf16 v[84:87], v[176:179], v[20:23], v[84:87]
    v_mfma_f32_16x16x32_bf16 v[88:91], v[176:179], v[24:27], v[88:91]
    v_mfma_f32_16x16x32_bf16 v[92:95], v[180:183], v[8:11], v[92:95]
    v_mfma_f32_16x16x32_bf16 v[96:99], v[180:183], v[12:15], v[96:99]
    v_mfma_f32_16x16x32_bf16 v[100:103], v[180:183], v[16:19], v[100:103]
    s_waitcnt vmcnt(10)
    s_barrier
    ds_read_b128 v[8:11], v5 offset:5120
    ds_read_b128 v[12:15], v4 offset:4096
    ds_read_b128 v[16:19], v4 offset:4352
    ds_read_b128 v[20:23], v4 offset:4608
    ds_read_b128 v[24:27], v4 offset:4864
    s_waitcnt lgkmcnt(5)
    v_mfma_f32_16x16x32_bf16 v[72:75], v[184:187], v[28:31], v[72:75]
    v_mfma_f32_16x16x32_bf16 v[76:79], v[184:187], v[32:35], v[76:79]
    v_mfma_f32_16x16x32_bf16 v[80:83], v[184:187], v[36:39], v[80:83]
    v_mfma_f32_16x16x32_bf16 v[84:87], v[184:187], v[40:43], v[84:87]
    v_mfma_f32_16x16x32_bf16 v[88:91], v[184:187], v[44:47], v[88:91]
    v_mfma_f32_16x16x32_bf16 v[92:95], v[188:191], v[28:31], v[92:95]
    v_mfma_f32_16x16x32_bf16 v[96:99], v[188:191], v[32:35], v[96:99]
    v_mfma_f32_16x16x32_bf16 v[100:103], v[188:191], v[36:39], v[100:103]
    ds_read_b128 v[28:31], v5 offset:5632
    ds_read_b128 v[32:35], v4 offset:8192
    ds_read_b128 v[36:39], v4 offset:8448
    ds_read_b128 v[40:43], v4 offset:8704
    ds_read_b128 v[44:47], v4 offset:8960
    s_waitcnt lgkmcnt(5)
    v_mfma_f32_16x16x32_bf16 v[72:75], v[192:195], v[8:11], v[72:75]
    v_mfma_f32_16x16x32_bf16 v[76:79], v[192:195], v[12:15], v[76:79]
    v_mfma_f32_16x16x32_bf16 v[80:83], v[192:195], v[16:19], v[80:83]
    v_mfma_f32_16x16x32_bf16 v[84:87], v[192:195], v[20:23], v[84:87]
    v_mfma_f32_16x16x32_bf16 v[88:91], v[192:195], v[24:27], v[88:91]
    v_mfma_f32_16x16x32_bf16 v[92:95], v[196:199], v[8:11], v[92:95]
    v_mfma_f32_16x16x32_bf16 v[96:99], v[196:199], v[12:15], v[96:99]
    v_mfma_f32_16x16x32_bf16 v[100:103], v[196:199], v[16:19], v[100:103]
    s_mov_b32 exec_hi, 0x3fffff
    ds_write_b128 v70, v[104:107] offset:1536
    s_mov_b64 exec, -1
    s_mul_i32 s5, s20, 9216
    s_add_u32 s5, s5, s24
    buffer_load_dwordx2 v[60:61], v67, s[12:15], s5 offen
    s_add_u32 s5, s5, 2048
    buffer_load_dwordx2 v[62:63], v67, s[12:15], s5 offen
    s_add_u32 s5, s5, 2048
    buffer_load_dwordx2 v[64:65], v67, s[12:15], s5 offen
    s_add_u32 s5, s5, 2048
    s_min_u32 s6, s87, 46080
    s_add_u32 m0, s6, 80896
    s_add_u32 s7, s6, s89
    buffer_load_dwordx4 v70, s[12:15], s7 offen lds
    s_add_u32 s87, s87, 7168
    ds_read_b128 v[8:11], v5 offset:6144
    ds_read_b128 v[12:15], v4 offset:12288
    ds_read_b128 v[16:19], v4 offset:12544
    ds_read_b128 v[20:23], v4 offset:12800
    ds_read_b128 v[24:27], v4 offset:13056
    s_waitcnt lgkmcnt(5)
    v_mfma_f32_16x16x32_bf16 v[72:75], v[200:203], v[28:31], v[72:75]
    v_mfma_f32_16x16x32_bf16 v[76:79], v[200:203], v[32:35], v[76:79]
    v_mfma_f32_16x16x32_bf16 v[80:83], v[200:203], v[36:39], v[80:83]
    v_mfma_f32_16x16x32_bf16 v[84:87], v[200:203], v[40:43], v[84:87]
    v_mfma_f32_16x16x32_bf16 v[88:91], v[200:203], v[44:47], v[88:91]
    v_mfma_f32_16x16x32_bf16 v[92:95], v[204:207], v[28:31], v[92:95]
    v_mfma_f32_16x16x32_bf16 v[96:99], v[204:207], v[32:35], v[96:99]
    v_mfma_f32_16x16x32_bf16 v[100:103], v[204:207], v[36:39], v[100:103]
    s_min_u32 s6, s87, 46080
    s_add_u32 m0, s6, 80896
    s_add_u32 s7, s6, s89
    buffer_load_dwordx4 v70, s[12:15], s7 offen lds
    s_add_u32 s87, s87, 7168
    ds_read_b128 v[28:31], v5 offset:6656
    ds_read_b128 v[32:35], v4 offset:16384
    ds_read_b128 v[36:39], v4 offset:16640
    ds_read_b128 v[40:43], v4 offset:16896
    ds_read_b128 v[44:47], v4 offset:17152
    s_waitcnt lgkmcnt(5)
    v_mfma_f32_16x16x32_bf16 v[72:75], v[208:211], v[8:11], v[72:75]
    v_mfma_f32_16x16x32_bf16 v[76:79], v[208:211], v[12:15], v[76:79]
    v_mfma_f32_16x16x32_bf16 v[80:83], v[208:211], v[16:19], v[80:83]
    v_mfma_f32_16x16x32_bf16 v[84:87], v[208:211], v[20:23], v[84:87]
    v_mfma_f32_16x16x32_bf16 v[88:91], v[208:211], v[24:27], v[88:91]
    v_mfma_f32_16x16x32_bf16 v[92:95], v[212:215], v[8:11], v[92:95]
    v_mfma_f32_16x16x32_bf16 v[96:99], v[212:215], v[12:15], v[96:99]
    v_mfma_f32_16x16x32_bf16 v[100:103], v[212:215], v[16:19], v[100:103]
    s_min_u32 s6, s87, 46080
    s_add_u32 m0, s6, 80896
    s_add_u32 s7, s6, s89
    buffer_load_dwordx4 v70, s[12:15], s7 offen lds
    s_add_u32 s87, s87, 7168
    s_waitcnt vmcnt(6)
    s_barrier
    ds_read_b128 v[8:11], v5 offset:7168
    ds_read_b128 v[12:15], v4 offset:20480
    ds_read_b128 v[16:19], v4 offset:20736
    ds_read_b128 v[20:23], v4 offset:20992
    ds_read_b128 v[24:27], v4 offset:21248
    s_waitcnt lgkmcnt(5)
    v_mfma_f32_16x16x32_bf16 v[72:75], v[216:219], v[28:31], v[72:75]
    v_mfma_f32_16x16x32_bf16 v[76:79], v[216:219], v[32:35], v[76:79]
    v_mfma_f32_16x16x32_bf16 v[80:83], v[216:219], v[36:39], v[80:83]
    v_mfma_f32_16x16x32_bf16 v[84:87], v[216:219], v[40:43], v[84:87]
    v_mfma_f32_16x16x32_bf16 v[88:91], v[216:219], v[44:47], v[88:91]
    v_mfma_f32_16x16x32_bf16 v[92:95], v[220:223], v[28:31], v[92:95]
    v_mfma_f32_16x16x32_bf16 v[96:99], v[220:223], v[32:35], v[96:99]
    v_mfma_f32_16x16x32_bf16 v[100:103], v[220:223], v[36:39], v[100:103]
    s_min_u32 s6, s87, 46080
    s_add_u32 m0, s6, 80896
    s_add_u32 s7, s6, s89
    buffer_load_dwordx4 v70, s[12:15], s7 offen lds
    s_add_u32 s87, s87, 7168
    ds_read_b128 v[28:31], v5 offset:7680
    ds_read_b128 v[32:35], v4 offset:24576
    ds_read_b128 v[36:39], v4 offset:24832
    ds_read_b128 v[40:43], v4 offset:25088
    ds_read_b128 v[44:47], v4 offset:25344
    s_waitcnt lgkmcnt(5)
    v_mfma_f32_16x16x32_bf16 v[72:75], v[224:227], v[8:11], v[72:75]
    v_mfma_f32_16x16x32_bf16 v[76:79], v[224:227], v[12:15], v[76:79]
    v_mfma_f32_16x16x32_bf16 v[80:83], v[224:227], v[16:19], v[80:83]
    v_mfma_f32_16x16x32_bf16 v[84:87], v[224:227], v[20:23], v[84:87]
    v_mfma_f32_16x16x32_bf16 v[88:91], v[224:227], v[24:27], v[88:91]
    v_mfma_f32_16x16x32_bf16 v[92:95], v[228:231], v[8:11], v[92:95]
    v_mfma_f32_16x16x32_bf16 v[96:99], v[228:231], v[12:15], v[96:99]
    v_mfma_f32_16x16x32_bf16 v[100:103], v[228:231], v[16:19], v[100:103]
    s_min_u32 s6, s87, 46080
    s_add_u32 m0, s6, 80896
    s_add_u32 s7, s6, s89
    buffer_load_dwordx4 v70, s[12:15], s7 offen lds
    s_add_u32 s87, s87, 7168
    ds_read_b128 v[8:11], v5 offset:8192
    ds_read_b128 v[12:15], v4 offset:28672
    ds_read_b128 v[16:19], v4 offset:28928
    ds_read_b128 v[20:23], v4 offset:29184
    ds_read_b128 v[24:27], v4 offset:29440
    s_waitcnt lgkmcnt(5)
    v_mfma_f32_16x16x32_bf16 v[72:75], v[232:235], v[28:31], v[72:75]
    v_mfma_f32_16x16x32_bf16 v[76:79], v[232:235], v[32:35], v[76:79]
    v_mfma_f32_16x16x32_bf16 v[80:83], v[232:235], v[36:39], v[80:83]
    v_mfma_f32_16x16x32_bf16 v[84:87], v[232:235], v[40:43], v[84:87]
    v_mfma_f32_16x16x32_bf16 v[88:91], v[232:235], v[44:47], v[88:91]
    v_mfma_f32_16x16x32_bf16 v[92:95], v[236:239], v[28:31], v[92:95]
    v_mfma_f32_16x16x32_bf16 v[96:99], v[236:239], v[32:35], v[96:99]
    v_mfma_f32_16x16x32_bf16 v[100:103], v[236:239], v[36:39], v[100:103]
    s_min_u32 s6, s87, 46080
    s_add_u32 m0, s6, 80896
    s_add_u32 s7, s6, s89
    buffer_load_dwordx4 v70, s[12:15], s7 offen lds
    s_add_u32 s87, s87, 7168
    ds_read_b128 v[28:31], v5 offset:8704
    ds_read_b128 v[32:35], v4 offset:32768
    ds_read_b128 v[36:39], v4 offset:33024
    ds_read_b128 v[40:43], v4 offset:33280
    ds_read_b128 v[44:47], v4 offset:33536
    s_waitcnt lgkmcnt(5)
    v_mfma_f32_16x16x32_bf16 v[72:75], v[240:243], v[8:11], v[72:75]
    v_and_b32 v2, 15, v0
    v_lshrrev_b32 v3, 4, v0
    v_lshlrev_b32 v224, 2, v2
    v_lshlrev_b32 v225, 4, v3
    v_lshlrev_b32 v6, 3, v0
    v_mfma_f32_16x16x32_bf16 v[76:79], v[240:243], v[12:15], v[76:79]
    s_mul_i32 s5, s30, 2560
    s_add_u32 s5, s5, 128000
    v_add_u32 v226, s5, v6
    s_mul_i32 s5, s31, 2560
    s_add_u32 s5, s5, 128000
    v_mfma_f32_16x16x32_bf16 v[80:83], v[240:243], v[16:19], v[80:83]
    v_add_u32 v227, s5, v6
    s_and_b32 s7, s3, 1
    s_mul_i32 s7, s7, 896
    s_add_u32 s7, s7, 640
    s_add_u32 s5, s7, 416
    v_mfma_f32_16x16x32_bf16 v[84:87], v[240:243], v[20:23], v[84:87]
    v_add_u32 v232, s5, v225
    v_lshrrev_b32 v233, 1, v3
    v_lshlrev_b32 v233, 8, v233
    s_add_u32 s5, s7, 256
    v_add3_u32 v233, v233, v225, s5
    v_mfma_f32_16x16x32_bf16 v[88:91], v[240:243], v[24:27], v[88:91]
    v_add_u32 v234, 129024, v6
    v_add_u32 v6, 256, v6
    v_and_b32 v6, 0x1ff, v6
    v_add_u32 v235, 139264, v6
    v_lshlrev_b32 v3, 2, v3
    v_mfma_f32_16x16x32_bf16 v[92:95], v[244:247], v[8:11], v[92:95]
    v_cmp_le_u32 s[80:81], v3, v2
    v_sub_u32 v6, v2, v3
    v_mov_b32 v2, 0xf149f2ca
    s_mov_b32 s5, 8
    v_add_u32 v3, 16, v6
    v_mfma_f32_16x16x32_bf16 v[96:99], v[244:247], v[12:15], v[96:99]
    v_cmp_gt_u32 s[76:77], s5, v3
    v_subrev_u32 v3, 0, v6
    v_cmp_gt_u32 s[78:79], 8, v3
    s_nop 0
    v_cndmask_b32 v228, v2, 0, s[76:77]
    v_mfma_f32_16x16x32_bf16 v[100:103], v[244:247], v[16:19], v[100:103]
    v_cndmask_b32 v236, v2, 0, s[78:79]
    v_add_u32 v3, 15, v6
    v_cmp_gt_u32 s[76:77], s5, v3
    v_subrev_u32 v3, 1, v6
    v_cmp_gt_u32 s[78:79], 8, v3
    s_waitcnt lgkmcnt(0)
    v_mfma_f32_16x16x32_bf16 v[72:75], v[248:251], v[28:31], v[72:75]
    s_nop 0
    v_cndmask_b32 v229, v2, 0, s[76:77]
    v_cndmask_b32 v237, v2, 0, s[78:79]
    v_add_u32 v3, 14, v6
    v_cmp_gt_u32 s[76:77], s5, v3
    v_mfma_f32_16x16x32_bf16 v[76:79], v[248:251], v[32:35], v[76:79]
    v_subrev_u32 v3, 2, v6
    v_cmp_gt_u32 s[78:79], 8, v3
    s_nop 0
    v_cndmask_b32 v230, v2, 0, s[76:77]
    v_cndmask_b32 v238, v2, 0, s[78:79]
    v_mfma_f32_16x16x32_bf16 v[80:83], v[248:251], v[36:39], v[80:83]
    v_add_u32 v3, 13, v6
    v_cmp_gt_u32 s[76:77], s5, v3
    v_subrev_u32 v3, 3, v6
    v_cmp_gt_u32 s[78:79], 8, v3
    s_nop 0
    v_mfma_f32_16x16x32_bf16 v[84:87], v[248:251], v[40:43], v[84:87]
    v_cndmask_b32 v231, v2, 0, s[76:77]
    v_cndmask_b32 v239, v2, 0, s[78:79]
    v_mfma_f32_16x16x32_bf16 v[88:91], v[248:251], v[44:47], v[88:91]
    v_mfma_f32_16x16x32_bf16 v[92:95], v[252:255], v[28:31], v[92:95]
    v_mfma_f32_16x16x32_bf16 v[96:99], v[252:255], v[32:35], v[96:99]
    v_mfma_f32_16x16x32_bf16 v[100:103], v[252:255], v[36:39], v[100:103]
    s_setprio 0
    s_branch M_S6_epi
M_S6_loop:
    v_mov_b32 v72, 0
    v_mov_b32 v73, 0
    v_mov_b32 v74, 0
    v_mov_b32 v75, 0
    v_mov_b32 v76, 0
    v_mov_b32 v77, 0
    v_mov_b32 v78, 0
    v_mov_b32 v79, 0
    v_mov_b32 v80, 0
    v_mov_b32 v81, 0
    v_mov_b32 v82, 0
    v_mov_b32 v83, 0
    v_mov_b32 v84, 0
    v_mov_b32 v85, 0
    v_mov_b32 v86, 0
    v_mov_b32 v87, 0
    v_mov_b32 v88, 0
    v_mov_b32 v89, 0
    v_mov_b32 v90, 0
    v_mov_b32 v91, 0
    v_mov_b32 v92, 0
    v_mov_b32 v93, 0
    v_mov_b32 v94, 0
    v_mov_b32 v95, 0
    v_mov_b32 v96, 0
    v_mov_b32 v97, 0
    v_mov_b32 v98, 0
    v_mov_b32 v99, 0
    v_mov_b32 v100, 0
    v_mov_b32 v101, 0
    v_mov_b32 v102, 0
    v_mov_b32 v103, 0
    s_setprio 3
    s_add_u32 m0, s26, 0
    s_nop 0
    buffer_load_dwordx4 v70, s[12:15], s27 offen sc1 lds
    s_add_u32 s27, s27, 8192
    s_setprio 2
    s_add_u32 m0, s26, 8192
    s_nop 0
    buffer_load_dwordx4 v70, s[12:15], s27 offen sc1 lds
    s_add_u32 s27, s27, 8192
    s_setprio 1
    s_add_u32 m0, s26, 16384
    s_nop 0
    buffer_load_dwordx4 v70, s[12:15], s27 offen sc1 lds
    s_add_u32 s27, s27, 8192
    s_setprio 0
    s_add_u32 m0, s26, 24576
    s_nop 0
    buffer_load_dwordx4 v70, s[12:15], s27 offen sc1 lds
    s_add_u32 s27, s27, 8192
    s_setprio 2
    s_waitcnt vmcnt(3)
    s_barrier
    ds_read_b128 v[8:11], v5 offset:0
    ds_read_b128 v[12:15], v1 offset:0
    ds_read_b128 v[16:19], v1 offset:256
    ds_read_b128 v[20:23], v1 offset:512
    ds_read_b128 v[24:27], v1 offset:768
    ds_read_b128 v[28:31], v5 offset:512
    ds_read_b128 v[32:35], v1 offset:4096
    ds_read_b128 v[36:39], v1 offset:4352
    ds_read_b128 v[40:43], v1 offset:4608
    ds_read_b128 v[44:47], v1 offset:4864
    s_waitcnt lgkmcnt(5)
    v_mfma_f32_16x16x32_bf16 v[72:75], v[112:115], v[8:11], v[72:75]
    v_mfma_f32_16x16x32_bf16 v[76:79], v[112:115], v[12:15], v[76:79]
    s_add_u32 m0, s26, 32768
    s_nop 0
    buffer_load_dwordx4 v70, s[12:15], s27 offen sc1 lds
    s_add_u32 s27, s27, 8192
    v_mfma_f32_16x16x32_bf16 v[80:83], v[112:115], v[16:19], v[80:83]
    v_mfma_f32_16x16x32_bf16 v[84:87], v[112:115], v[20:23], v[84:87]
    v_mfma_f32_16x16x32_bf16 v[88:91], v[112:115], v[24:27], v[88:91]
    v_mfma_f32_16x16x32_bf16 v[92:95], v[116:119], v[8:11], v[92:95]
    v_mfma_f32_16x16x32_bf16 v[96:99], v[116:119], v[12:15], v[96:99]
    v_mfma_f32_16x16x32_bf16 v[100:103], v[116:119], v[16:19], v[100:103]
    s_waitcnt vmcnt(2)
    s_barrier
    ds_read_b128 v[8:11], v5 offset:1024
    ds_read_b128 v[12:15], v1 offset:8192
    ds_read_b128 v[16:19], v1 offset:8448
    ds_read_b128 v[20:23], v1 offset:8704
    ds_read_b128 v[24:27], v1 offset:8960
    s_waitcnt lgkmcnt(5)
    v_mfma_f32_16x16x32_bf16 v[72:75], v[120:123], v[28:31], v[72:75]
    v_mfma_f32_16x16x32_bf16 v[76:79], v[120:123], v[32:35], v[76:79]
    v_mfma_f32_16x16x32_bf16 v[80:83], v[120:123], v[36:39], v[80:83]
    v_mfma_f32_16x16x32_bf16 v[84:87], v[120:123], v[40:43], v[84:87]
    v_mfma_f32_16x16x32_bf16 v[88:91], v[120:123], v[44:47], v[88:91]
    v_mfma_f32_16x16x32_bf16 v[92:95], v[124:127], v[28:31], v[92:95]
    v_mfma_f32_16x16x32_bf16 v[96:99], v[124:127], v[32:35], v[96:99]
    v_mfma_f32_16x16x32_bf16 v[100:103], v[124:127], v[36:39], v[100:103]
    ds_read_b128 v[28:31], v5 offset:1536
    ds_read_b128 v[32:35], v1 offset:12288
    ds_read_b128 v[36:39], v1 offset:12544
    ds_read_b128 v[40:43], v1 offset:12800
    ds_read_b128 v[44:47], v1 offset:13056
    s_waitcnt lgkmcnt(5)
    v_mfma_f32_16x16x32_bf16 v[72:75], v[128:131], v[8:11], v[72:75]
    v_mfma_f32_16x16x32_bf16 v[76:79], v[128:131], v[12:15], v[76:79]
    s_add_u32 m0, s26, 40960
    s_nop 0
    buffer_load_dwordx4 v70, s[12:15], s27 offen sc1 lds
    s_add_u32 s27, s27, 8192
    v_mfma_f32_16x16x32_bf16 v[80:83], v[128:131], v[16:19], v[80:83]
    v_mfma_f32_16x16x32_bf16 v[84:87], v[128:131], v[20:23], v[84:87]
    v_mfma_f32_16x16x32_bf16 v[88:91], v[128:131], v[24:27], v[88:91]
    v_mfma_f32_16x16x32_bf16 v[92:95], v[132:135], v[8:11], v[92:95]
    v_mfma_f32_16x16x32_bf16 v[96:99], v[132:135], v[12:15], v[96:99]
    v_mfma_f32_16x16x32_bf16 v[100:103], v[132:135], v[16:19], v[100:103]
    ds_read_b128 v[8:11], v5 offset:2048
    ds_read_b128 v[12:15], v1 offset:16384
    ds_read_b128 v[16:19], v1 offset:16640
    ds_read_b128 v[20:23], v1 offset:16896
    ds_read_b128 v[24:27], v1 offset:17152
    s_waitcnt lgkmcnt(5)
    v_mfma_f32_16x16x32_bf16 v[72:75], v[136:139], v[28:31], v[72:75]
    v_mfma_f32_16x16x32_bf16 v[76:79], v[136:139], v[32:35], v[76:79]
    v_mfma_f32_16x16x32_bf16 v[80:83], v[136:139], v[36:39], v[80:83]
    v_mfma_f32_16x16x32_bf16 v[84:87], v[136:139], v[40:43], v[84:87]
    v_mfma_f32_16x16x32_bf16 v[88:91], v[136:139], v[44:47], v[88:91]
    v_mfma_f32_16x16x32_bf16 v[92:95], v[140:143], v[28:31], v[92:95]
    v_mfma_f32_16x16x32_bf16 v[96:99], v[140:143], v[32:35], v[96:99]
    v_mfma_f32_16x16x32_bf16 v[100:103], v[140:143], v[36:39], v[100:103]
    ds_read_b128 v[28:31], v5 offset:2560
    ds_read_b128 v[32:35], v1 offset:20480
    ds_read_b128 v[36:39], v1 offset:20736
    ds_read_b128 v[40:43], v1 offset:20992
    ds_read_b128 v[44:47], v1 offset:21248
    s_waitcnt lgkmcnt(5)
    v_mfma_f32_16x16x32_bf16 v[72:75], v[144:147], v[8:11], v[72:75]
    v_mfma_f32_16x16x32_bf16 v[76:79], v[144:147], v[12:15], v[76:79]
    s_add_u32 m0, s26, 49152
    s_nop 0
    buffer_load_dwordx4 v70, s[12:15], s27 offen sc1 lds
    s_add_u32 s27, s27, 8192
    v_mfma_f32_16x16x32_bf16 v[80:83], v[144:147], v[16:19], v[80:83]
    v_mfma_f32_16x16x32_bf16 v[84:87], v[144:147], v[20:23], v[84:87]
    v_mfma_f32_16x16x32_bf16 v[88:91], v[144:147], v[24:27], v[88:91]
    v_mfma_f32_16x16x32_bf16 v[92:95], v[148:151], v[8:11], v[92:95]
    v_mfma_f32_16x16x32_bf16 v[96:99], v[148:151], v[12:15], v[96:99]
    v_mfma_f32_16x16x32_bf16 v[100:103], v[148:151], v[16:19], v[100:103]
    s_add_u32 s84, s28, 0
    buffer_load_dwordx4 v[112:115], v58, s[16:19], s84 offen
    s_add_u32 s84, s28, 0
    buffer_load_dwordx4 v[116:119], v59, s[16:19], s84 offen
    s_waitcnt vmcnt(4)
    s_barrier
    ds_read_b128 v[8:11], v5 offset:3072
    ds_read_b128 v[12:15], v1 offset:24576
    ds_read_b128 v[16:19], v1 offset:24832
    ds_read_b128 v[20:23], v1 offset:25088
    ds_read_b128 v[24:27], v1 offset:25344
    s_waitcnt lgkmcnt(5)
    v_mfma_f32_16x16x32_bf16 v[72:75], v[152:155], v[28:31], v[72:75]
    v_mfma_f32_16x16x32_bf16 v[76:79], v[152:155], v[32:35], v[76:79]
    v_mfma_f32_16x16x32_bf16 v[80:83], v[152:155], v[36:39], v[80:83]
    v_mfma_f32_16x16x32_bf16 v[84:87], v[152:155], v[40:43], v[84:87]
    v_mfma_f32_16x16x32_bf16 v[88:91], v[152:155], v[44:47], v[88:91]
    v_mfma_f32_16x16x32_bf16 v[92:95], v[156:159], v[28:31], v[92:95]
    v_mfma_f32_16x16x32_bf16 v[96:99], v[156:159], v[32:35], v[96:99]
    v_mfma_f32_16x16x32_bf16 v[100:103], v[156:159], v[36:39], v[100:103]
    s_add_u32 s84, s28, 13824
    buffer_load_dwordx4 v[120:123], v58, s[16:19], s84 offen
    s_add_u32 s84, s28, 13824
    buffer_load_dwordx4 v[124:127], v59, s[16:19], s84 offen
    ds_read_b128 v[28:31], v5 offset:3584
    ds_read_b128 v[32:35], v1 offset:28672
    ds_read_b128 v[36:39], v1 offset:28928
    ds_read_b128 v[40:43], v1 offset:29184
    ds_read_b128 v[44:47], v1 offset:29440
    s_waitcnt lgkmcnt(5)
    v_mfma_f32_16x16x32_bf16 v[72:75], v[160:163], v[8:11], v[72:75]
    v_mfma_f32_16x16x32_bf16 v[76:79], v[160:163], v[12:15], v[76:79]
    s_add_u32 m0, s26, 57344
    s_nop 0
    buffer_load_dwordx4 v70, s[12:15], s27 offen sc1 lds
    s_add_u32 s27, s27, 8192
    v_mfma_f32_16x16x32_bf16 v[80:83], v[160:163], v[16:19], v[80:83]
    v_mfma_f32_16x16x32_bf16 v[84:87], v[160:163], v[20:23], v[84:87]
    v_mfma_f32_16x16x32_bf16 v[88:91], v[160:163], v[24:27], v[88:91]
    v_mfma_f32_16x16x32_bf16 v[92:95], v[164:167], v[8:11], v[92:95]
    v_mfma_f32_16x16x32_bf16 v[96:99], v[164:167], v[12:15], v[96:99]
    v_mfma_f32_16x16x32_bf16 v[100:103], v[164:167], v[16:19], v[100:103]
    s_add_u32 s84, s28, 27648
    buffer_load_dwordx4 v[128:131], v58, s[16:19], s84 offen
    s_add_u32 s84, s28, 27648
    buffer_load_dwordx4 v[132:135], v59, s[16:19], s84 offen
    ds_read_b128 v[8:11], v5 offset:4096
    ds_read_b128 v[12:15], v1 offset:32768
    ds_read_b128 v[16:19], v1 offset:33024
    ds_read_b128 v[20:23], v1 offset:33280
    ds_read_b128 v[24:27], v1 offset:33536
    s_waitcnt lgkmcnt(5)
    v_mfma_f32_16x16x32_bf16 v[72:75], v[168:171], v[28:31], v[72:75]
    v_mfma_f32_16x16x32_bf16 v[76:79], v[168:171], v[32:35], v[76:79]
    v_mfma_f32_16x16x32_bf16 v[80:83], v[168:171], v[36:39], v[80:83]
    v_mfma_f32_16x16x32_bf16 v[84:87], v[168:171], v[40:43], v[84:87]
    v_mfma_f32_16x16x32_bf16 v[88:91], v[168:171], v[44:47], v[88:91]
    v_mfma_f32_16x16x32_bf16 v[92:95], v[172:175], v[28:31], v[92:95]
    v_mfma_f32_16x16x32_bf16 v[96:99], v[172:175], v[32:35], v[96:99]
    v_mfma_f32_16x16x32_bf16 v[100:103], v[172:175], v[36:39], v[100:103]
    s_add_u32 s84, s28, 41472
    buffer_load_dwordx4 v[136:139], v58, s[16:19], s84 offen
    s_add_u32 s84, s28, 41472
    buffer_load_dwordx4 v[140:143], v59, s[16:19], s84 offen
    ds_read_b128 v[28:31], v5 offset:4608
    ds_read_b128 v[32:35], v4 offset:0
    ds_read_b128 v[36:39], v4 offset:256
    ds_read_b128 v[40:43], v4 offset:512
    ds_read_b128 v[44:47], v4 offset:768
    s_waitcnt lgkmcnt(5)
    v_mfma_f32_16x16x32_bf16 v[72:75], v[176:179], v[8:11], v[72:75]
    v_mfma_f32_16x16x32_bf16 v[76:79], v[176:179], v[12:15], v[76:79]
    s_add_u32 m0, s26, 65536
    s_nop 0
    buffer_load_dwordx4 v70, s[12:15], s27 offen sc1 lds
    s_add_u32 s27, s27, 8192
    v_mfma_f32_16x16x32_bf16 v[80:83], v[176:179], v[16:19], v[80:83]
    v_mfma_f32_16x16x32_bf16 v[84:87], v[176:179], v[20:23], v[84:87]
    v_mfma_f32_16x16x32_bf16 v[88:91], v[176:179], v[24:27], v[88:91]
    v_mfma_f32_16x16x32_bf16 v[92:95], v[180:183], v[8:11], v[92:95]
    v_mfma_f32_16x16x32_bf16 v[96:99], v[180:183], v[12:15], v[96:99]
    v_mfma_f32_16x16x32_bf16 v[100:103], v[180:183], v[16:19], v[100:103]
    s_add_u32 s84, s28, 55296
    buffer_load_dwordx4 v[144:147], v58, s[16:19], s84 offen
    s_add_u32 s84, s28, 55296
    buffer_load_dwordx4 v[148:151], v59, s[16:19], s84 offen
    s_waitcnt vmcnt(12)
    s_barrier
    ds_read_b128 v[8:11], v5 offset:5120
    ds_read_b128 v[12:15], v4 offset:4096
    ds_read_b128 v[16:19], v4 offset:4352
    ds_read_b128 v[20:23], v4 offset:4608
    ds_read_b128 v[24:27], v4 offset:4864
    s_waitcnt lgkmcnt(5)
    v_mfma_f32_16x16x32_bf16 v[72:75], v[184:187], v[28:31], v[72:75]
    v_mfma_f32_16x16x32_bf16 v[76:79], v[184:187], v[32:35], v[76:79]
    v_mfma_f32_16x16x32_bf16 v[80:83], v[184:187], v[36:39], v[80:83]
    v_mfma_f32_16x16x32_bf16 v[84:87], v[184:187], v[40:43], v[84:87]
    v_mfma_f32_16x16x32_bf16 v[88:91], v[184:187], v[44:47], v[88:91]
    v_mfma_f32_16x16x32_bf16 v[92:95], v[188:191], v[28:31], v[92:95]
    v_mfma_f32_16x16x32_bf16 v[96:99], v[188:191], v[32:35], v[96:99]
    v_mfma_f32_16x16x32_bf16 v[100:103], v[188:191], v[36:39], v[100:103]
    s_add_u32 s84, s28, 69120
    buffer_load_dwordx4 v[152:155], v58, s[16:19], s84 offen
    s_add_u32 s84, s28, 69120
    buffer_load_dwordx4 v[156:159], v59, s[16:19], s84 offen
    ds_read_b128 v[28:31], v5 offset:5632
    ds_read_b128 v[32:35], v4 offset:8192
    ds_read_b128 v[36:39], v4 offset:8448
    ds_read_b128 v[40:43], v4 offset:8704
    ds_read_b128 v[44:47], v4 offset:8960
    s_waitcnt lgkmcnt(5)
    v_mfma_f32_16x16x32_bf16 v[72:75], v[192:195], v[8:11], v[72:75]
    v_mfma_f32_16x16x32_bf16 v[76:79], v[192:195], v[12:15], v[76:79]
    v_mfma_f32_16x16x32_bf16 v[80:83], v[192:195], v[16:19], v[80:83]
    v_mfma_f32_16x16x32_bf16 v[84:87], v[192:195], v[20:23], v[84:87]
    v_mfma_f32_16x16x32_bf16 v[88:91], v[192:195], v[24:27], v[88:91]
    v_mfma_f32_16x16x32_bf16 v[92:95], v[196:199], v[8:11], v[92:95]
    v_mfma_f32_16x16x32_bf16 v[96:99], v[196:199], v[12:15], v[96:99]
    v_mfma_f32_16x16x32_bf16 v[100:103], v[196:199], v[16:19], v[100:103]
    s_add_u32 s84, s28, 82944
    buffer_load_dwordx4 v[160:163], v58, s[16:19], s84 offen
    s_add_u32 s84, s28, 82944
    buffer_load_dwordx4 v[164:167], v59, s[16:19], s84 offen
    ds_read_b128 v[8:11], v5 offset:6144
    ds_read_b128 v[12:15], v4 offset:12288
    ds_read_b128 v[16:19], v4 offset:12544
    ds_read_b128 v[20:23], v4 offset:12800
    ds_read_b128 v[24:27], v4 offset:13056
    s_waitcnt lgkmcnt(5)
    v_mfma_f32_16x16x32_bf16 v[72:75], v[200:203], v[28:31], v[72:75]
    v_mfma_f32_16x16x32_bf16 v[76:79], v[200:203], v[32:35], v[76:79]
    v_mfma_f32_16x16x32_bf16 v[80:83], v[200:203], v[36:39], v[80:83]
    v_mfma_f32_16x16x32_bf16 v[84:87], v[200:203], v[40:43], v[84:87]
    v_mfma_f32_16x16x32_bf16 v[88:91], v[200:203], v[44:47], v[88:91]
    v_mfma_f32_16x16x32_bf16 v[92:95], v[204:207], v[28:31], v[92:95]
    v_mfma_f32_16x16x32_bf16 v[96:99], v[204:207], v[32:35], v[96:99]
    v_mfma_f32_16x16x32_bf16 v[100:103], v[204:207], v[36:39], v[100:103]
    s_add_u32 s84, s28, 96768
    buffer_load_dwordx4 v[168:171], v58, s[16:19], s84 offen
    s_add_u32 s84, s28, 96768
    buffer_load_dwordx4 v[172:175], v59, s[16:19], s84 offen
    ds_read_b128 v[28:31], v5 offset:6656
    ds_read_b128 v[32:35], v4 offset:16384
    ds_read_b128 v[36:39], v4 offset:16640
    ds_read_b128 v[40:43], v4 offset:16896
    ds_read_b128 v[44:47], v4 offset:17152
    s_waitcnt lgkmcnt(5)
    v_mfma_f32_16x16x32_bf16 v[72:75], v[208:211], v[8:11], v[72:75]
    v_mfma_f32_16x16x32_bf16 v[76:79], v[208:211], v[12:15], v[76:79]
    v_mfma_f32_16x16x32_bf16 v[80:83], v[208:211], v[16:19], v[80:83]
    v_mfma_f32_16x16x32_bf16 v[84:87], v[208:211], v[20:23], v[84:87]
    v_mfma_f32_16x16x32_bf16 v[88:91], v[208:211], v[24:27], v[88:91]
    v_mfma_f32_16x16x32_bf16 v[92:95], v[212:215], v[8:11], v[92:95]
    v_mfma_f32_16x16x32_bf16 v[96:99], v[212:215], v[12:15], v[96:99]
    v_mfma_f32_16x16x32_bf16 v[100:103], v[212:215], v[16:19], v[100:103]
    s_add_u32 s84, s28, 110592
    buffer_load_dwordx4 v[176:179], v58, s[16:19], s84 offen
    s_add_u32 s84, s28, 110592
    buffer_load_dwordx4 v[180:183], v59, s[16:19], s84 offen
    s_waitcnt vmcnt(10)
    s_barrier
    ds_read_b128 v[8:11], v5 offset:7168
    ds_read_b128 v[12:15], v4 offset:20480
    ds_read_b128 v[16:19], v4 offset:20736
    ds_read_b128 v[20:23], v4 offset:20992
    ds_read_b128 v[24:27], v4 offset:21248
    s_waitcnt lgkmcnt(5)
    v_mfma_f32_16x16x32_bf16 v[72:75], v[216:219], v[28:31], v[72:75]
    v_mfma_f32_16x16x32_bf16 v[76:79], v[216:219], v[32:35], v[76:79]
    v_mfma_f32_16x16x32_bf16 v[80:83], v[216:219], v[36:39], v[80:83]
    v_mfma_f32_16x16x32_bf16 v[84:87], v[216:219], v[40:43], v[84:87]
    v_mfma_f32_16x16x32_bf16 v[88:91], v[216:219], v[44:47], v[88:91]
    v_mfma_f32_16x16x32_bf16 v[92:95], v[220:223], v[28:31], v[92:95]
    v_mfma_f32_16x16x32_bf16 v[96:99], v[220:223], v[32:35], v[96:99]
    v_mfma_f32_16x16x32_bf16 v[100:103], v[220:223], v[36:39], v[100:103]
    s_add_u32 s84, s28, 124416
    buffer_load_dwordx4 v[184:187], v58, s[16:19], s84 offen
    s_add_u32 s84, s28, 124416
    buffer_load_dwordx4 v[188:191], v59, s[16:19], s84 offen
    ds_read_b128 v[28:31], v5 offset:7680
    ds_read_b128 v[32:35], v4 offset:24576
    ds_read_b128 v[36:39], v4 offset:24832
    ds_read_b128 v[40:43], v4 offset:25088
    ds_read_b128 v[44:47], v4 offset:25344
    s_waitcnt lgkmcnt(5)
    v_mfma_f32_16x16x32_bf16 v[72:75], v[224:227], v[8:11], v[72:75]
    v_mfma_f32_16x16x32_bf16 v[76:79], v[224:227], v[12:15], v[76:79]
    v_mfma_f32_16x16x32_bf16 v[80:83], v[224:227], v[16:19], v[80:83]
    v_mfma_f32_16x16x32_bf16 v[84:87], v[224:227], v[20:23], v[84:87]
    v_mfma_f32_16x16x32_bf16 v[88:91], v[224:227], v[24:27], v[88:91]
    v_mfma_f32_16x16x32_bf16 v[92:95], v[228:231], v[8:11], v[92:95]
    v_mfma_f32_16x16x32_bf16 v[96:99], v[228:231], v[12:15], v[96:99]
    v_mfma_f32_16x16x32_bf16 v[100:103], v[228:231], v[16:19], v[100:103]
    s_add_u32 s84, s28, 138240
    buffer_load_dwordx4 v[192:195], v58, s[16:19], s84 offen
    s_add_u32 s84, s28, 138240
    buffer_load_dwordx4 v[196:199], v59, s[16:19], s84 offen
    ds_read_b128 v[8:11], v5 offset:8192
    ds_read_b128 v[12:15], v4 offset:28672
    ds_read_b128 v[16:19], v4 offset:28928
    ds_read_b128 v[20:23], v4 offset:29184
    ds_read_b128 v[24:27], v4 offset:29440
    s_waitcnt lgkmcnt(5)
    v_mfma_f32_16x16x32_bf16 v[72:75], v[232:235], v[28:31], v[72:75]
    v_mfma_f32_16x16x32_bf16 v[76:79], v[232:235], v[32:35], v[76:79]
    v_mfma_f32_16x16x32_bf16 v[80:83], v[232:235], v[36:39], v[80:83]
    v_mfma_f32_16x16x32_bf16 v[84:87], v[232:235], v[40:43], v[84:87]
    v_mfma_f32_16x16x32_bf16 v[88:91], v[232:235], v[44:47], v[88:91]
    v_mfma_f32_16x16x32_bf16 v[92:95], v[236:239], v[28:31], v[92:95]
    v_mfma_f32_16x16x32_bf16 v[96:99], v[236:239], v[32:35], v[96:99]
    v_mfma_f32_16x16x32_bf16 v[100:103], v[236:239], v[36:39], v[100:103]
    s_add_u32 s84, s28, 152064
    buffer_load_dwordx4 v[200:203], v58, s[16:19], s84 offen
    s_add_u32 s84, s28, 152064
    buffer_load_dwordx4 v[204:207], v59, s[16:19], s84 offen
    ds_read_b128 v[28:31], v5 offset:8704
    ds_read_b128 v[32:35], v4 offset:32768
    ds_read_b128 v[36:39], v4 offset:33024
    ds_read_b128 v[40:43], v4 offset:33280
    ds_read_b128 v[44:47], v4 offset:33536
    s_waitcnt lgkmcnt(5)
    v_mfma_f32_16x16x32_bf16 v[72:75], v[240:243], v[8:11], v[72:75]
    v_and_b32 v2, 15, v0
    v_lshrrev_b32 v3, 4, v0
    v_lshlrev_b32 v224, 2, v2
    v_lshlrev_b32 v225, 4, v3
    v_lshlrev_b32 v6, 3, v0
    v_mfma_f32_16x16x32_bf16 v[76:79], v[240:243], v[12:15], v[76:79]
    s_mul_i32 s5, s30, 2560
    s_add_u32 s5, s5, 128000
    v_add_u32 v226, s5, v6
    s_mul_i32 s5, s31, 2560
    s_add_u32 s5, s5, 128000
    v_mfma_f32_16x16x32_bf16 v[80:83], v[240:243], v[16:19], v[80:83]
    v_add_u32 v227, s5, v6
    s_and_b32 s7, s3, 1
    s_mul_i32 s7, s7, 896
    s_add_u32 s7, s7, 640
    s_add_u32 s5, s7, 416
    v_mfma_f32_16x16x32_bf16 v[84:87], v[240:243], v[20:23], v[84:87]
    v_add_u32 v232, s5, v225
    v_lshrrev_b32 v233, 1, v3
    v_lshlrev_b32 v233, 8, v233
    s_add_u32 s5, s7, 256
    v_add3_u32 v233, v233, v225, s5
    v_mfma_f32_16x16x32_bf16 v[88:91], v[240:243], v[24:27], v[88:91]
    v_add_u32 v234, 129024, v6
    v_add_u32 v6, 256, v6
    v_and_b32 v6, 0x1ff, v6
    v_add_u32 v235, 139264, v6
    v_lshlrev_b32 v3, 2, v3
    v_mfma_f32_16x16x32_bf16 v[92:95], v[244:247], v[8:11], v[92:95]
    v_cmp_le_u32 s[80:81], v3, v2
    v_sub_u32 v6, v2, v3
    v_mov_b32 v2, 0xf149f2ca
    s_mov_b32 s5, 8
    v_add_u32 v3, 16, v6
    v_mfma_f32_16x16x32_bf16 v[96:99], v[244:247], v[12:15], v[96:99]
    v_cmp_gt_u32 s[76:77], s5, v3
    v_subrev_u32 v3, 0, v6
    v_cmp_gt_u32 s[78:79], 8, v3
    s_nop 0
    v_cndmask_b32 v228, v2, 0, s[76:77]
    v_mfma_f32_16x16x32_bf16 v[100:103], v[244:247], v[16:19], v[100:103]
    v_cndmask_b32 v236, v2, 0, s[78:79]
    v_add_u32 v3, 15, v6
    v_cmp_gt_u32 s[76:77], s5, v3
    v_subrev_u32 v3, 1, v6
    v_cmp_gt_u32 s[78:79], 8, v3
    s_waitcnt lgkmcnt(0)
    v_mfma_f32_16x16x32_bf16 v[72:75], v[248:251], v[28:31], v[72:75]
    s_nop 0
    v_cndmask_b32 v229, v2, 0, s[76:77]
    v_cndmask_b32 v237, v2, 0, s[78:79]
    v_add_u32 v3, 14, v6
    v_cmp_gt_u32 s[76:77], s5, v3
    v_mfma_f32_16x16x32_bf16 v[76:79], v[248:251], v[32:35], v[76:79]
    v_subrev_u32 v3, 2, v6
    v_cmp_gt_u32 s[78:79], 8, v3
    s_nop 0
    v_cndmask_b32 v230, v2, 0, s[76:77]
    v_cndmask_b32 v238, v2, 0, s[78:79]
    v_mfma_f32_16x16x32_bf16 v[80:83], v[248:251], v[36:39], v[80:83]
    v_add_u32 v3, 13, v6
    v_cmp_gt_u32 s[76:77], s5, v3
    v_subrev_u32 v3, 3, v6
    v_cmp_gt_u32 s[78:79], 8, v3
    s_nop 0
    v_mfma_f32_16x16x32_bf16 v[84:87], v[248:251], v[40:43], v[84:87]
    v_cndmask_b32 v231, v2, 0, s[76:77]
    v_cndmask_b32 v239, v2, 0, s[78:79]
    v_mfma_f32_16x16x32_bf16 v[88:91], v[248:251], v[44:47], v[88:91]
    v_mfma_f32_16x16x32_bf16 v[92:95], v[252:255], v[28:31], v[92:95]
    v_mfma_f32_16x16x32_bf16 v[96:99], v[252:255], v[32:35], v[96:99]
    v_mfma_f32_16x16x32_bf16 v[100:103], v[252:255], v[36:39], v[100:103]
    s_setprio 0
M_S6_epi:
    ds_read_b128 v[48:51], v232
    ds_read_b128 v[52:55], v233
    ds_read2_b32 v[8:9], v224 offset0:0 offset1:80
    ds_read2_b32 v[10:11], v224 offset0:16 offset1:96
    ds_read2_b32 v[12:13], v224 offset0:32 offset1:112
    ds_read2_b32 v[14:15], v224 offset0:48 offset1:128
    ds_read2_b32 v[16:17], v224 offset0:64 offset1:144
    s_waitcnt lgkmcnt(0)
    v_mul_f32 v72, v72, v8
    v_mul_f32 v73, v73, v8
    v_mul_f32 v74, v74, v8
    v_mul_f32 v75, v75, v8
    v_mul_f32 v76, v76, v10
    v_mul_f32 v77, v77, v10
    v_mul_f32 v78, v78, v10
    v_mul_f32 v79, v79, v10
    v_mul_f32 v80, v80, v12
    v_mul_f32 v81, v81, v12
    v_mul_f32 v82, v82, v12
    v_mul_f32 v83, v83, v12
    v_mul_f32 v84, v84, v14
    v_mul_f32 v85, v85, v14
    v_mul_f32 v86, v86, v14
    v_mul_f32 v87, v87, v14
    v_mul_f32 v88, v88, v16
    v_mul_f32 v89, v89, v16
    v_mul_f32 v90, v90, v16
    v_mul_f32 v91, v91, v16
    v_fma_f32 v72, -v9, v48, v72
    v_fma_f32 v73, -v9, v49, v73
    v_fma_f32 v74, -v9, v50, v74
    v_fma_f32 v75, -v9, v51, v75
    v_fma_f32 v76, -v11, v48, v76
    v_fma_f32 v77, -v11, v49, v77
    v_fma_f32 v78, -v11, v50, v78
    v_fma_f32 v79, -v11, v51, v79
    v_fma_f32 v80, -v13, v48, v80
    v_fma_f32 v81, -v13, v49, v81
    v_fma_f32 v82, -v13, v50, v82
    v_fma_f32 v83, -v13, v51, v83
    v_fma_f32 v84, -v15, v48, v84
    v_fma_f32 v85, -v15, v49, v85
    v_fma_f32 v86, -v15, v50, v86
    v_fma_f32 v87, -v15, v51, v87
    v_fma_f32 v88, -v17, v48, v88
    v_fma_f32 v89, -v17, v49, v89
    v_fma_f32 v90, -v17, v50, v90
    v_fma_f32 v91, -v17, v51, v91
    v_cvt_pk_bf16_f32 v72, v72, v73
    v_cvt_pk_bf16_f32 v73, v74, v75
    ds_write_b64 v226, v[72:73] offset:0
    v_cvt_pk_bf16_f32 v76, v76, v77
    v_cvt_pk_bf16_f32 v77, v78, v79
    ds_write_b64 v226, v[76:77] offset:512
    v_cvt_pk_bf16_f32 v80, v80, v81
    v_cvt_pk_bf16_f32 v81, v82, v83
    ds_write_b64 v226, v[80:81] offset:1024
    v_cvt_pk_bf16_f32 v84, v84, v85
    v_cvt_pk_bf16_f32 v85, v86, v87
    ds_write_b64 v226, v[84:85] offset:1536
    v_cvt_pk_bf16_f32 v88, v88, v89
    v_cvt_pk_bf16_f32 v89, v90, v91
    ds_write_b64 v226, v[88:89] offset:2048
    v_mul_f32 v92, v92, v8
    v_mul_f32 v93, v93, v8
    v_mul_f32 v94, v94, v8
    v_mul_f32 v95, v95, v8
    v_mul_f32 v96, v96, v10
    v_mul_f32 v97, v97, v10
    v_mul_f32 v98, v98, v10
    v_mul_f32 v99, v99, v10
    v_mul_f32 v100, v100, v12
    v_mul_f32 v101, v101, v12
    v_mul_f32 v102, v102, v12
    v_mul_f32 v103, v103, v12
    v_fma_f32 v92, -v9, v52, v92
    v_fma_f32 v93, -v9, v53, v93
    v_fma_f32 v94, -v9, v54, v94
    v_fma_f32 v95, -v9, v55, v95
    v_fma_f32 v96, -v11, v52, v96
    v_fma_f32 v97, -v11, v53, v97
    v_fma_f32 v98, -v11, v54, v98
    v_fma_f32 v99, -v11, v55, v99
    v_fma_f32 v100, -v13, v52, v100
    v_fma_f32 v101, -v13, v53, v101
    v_fma_f32 v102, -v13, v54, v102
    v_fma_f32 v103, -v13, v55, v103
    v_cvt_pk_bf16_f32 v92, v92, v93
    v_cvt_pk_bf16_f32 v93, v94, v95
    ds_write_b64 v227, v[92:93] offset:0
    v_cvt_pk_bf16_f32 v96, v96, v97
    v_cvt_pk_bf16_f32 v97, v98, v99
    ds_write_b64 v227, v[96:97] offset:512
    v_cvt_pk_bf16_f32 v100, v100, v101
    v_cvt_pk_bf16_f32 v101, v102, v103
    ds_write_b64 v227, v[100:101] offset:1024
    s_branch M_att
M_S7:
    v_mov_b32 v72, 0
    v_mov_b32 v73, 0
    v_mov_b32 v74, 0
    v_mov_b32 v75, 0
    v_mov_b32 v76, 0
    v_mov_b32 v77, 0
    v_mov_b32 v78, 0
    v_mov_b32 v79, 0
    v_mov_b32 v80, 0
    v_mov_b32 v81, 0
    v_mov_b32 v82, 0
    v_mov_b32 v83, 0
    v_mov_b32 v84, 0
    v_mov_b32 v85, 0
    v_mov_b32 v86, 0
    v_mov_b32 v87, 0
    v_mov_b32 v88, 0
    v_mov_b32 v89, 0
    v_mov_b32 v90, 0
    v_mov_b32 v91, 0
    v_mov_b32 v92, 0
    v_mov_b32 v93, 0
    v_mov_b32 v94, 0
    v_mov_b32 v95, 0
    v_mov_b32 v96, 0
    v_mov_b32 v97, 0
    v_mov_b32 v98, 0
    v_mov_b32 v99, 0
    s_setprio 3
    s_add_u32 m0, s26, 0
    s_nop 0
    buffer_load_dwordx4 v70, s[12:15], s27 offen sc1 lds
    s_add_u32 s27, s27, 8192
    s_mov_b32 m0, 76800
    s_nop 0
    buffer_load_dwordx4 v57, s[12:15], s85 offen sc1 lds
    s_add_u32 s85, s85, 8192
    buffer_load_dwordx4 v[112:115], v58, s[16:19], s86 offen
    buffer_load_dwordx4 v[116:119], v59, s[16:19], s86 offen
    s_add_u32 s86, s86, 13824
    buffer_load_dwordx4 v[120:123], v58, s[16:19], s86 offen
    buffer_load_dwordx4 v[124:127], v59, s[16:19], s86 offen
    s_add_u32 s86, s86, 13824
    s_setprio 2
    s_add_u32 m0, s26, 8192
    s_nop 0
    buffer_load_dwordx4 v70, s[12:15], s27 offen sc1 lds
    s_add_u32 s27, s27, 8192
    s_mov_b32 m0, 77824
    s_nop 0
    buffer_load_dwordx4 v57, s[12:15], s85 offen sc1 lds
    s_add_u32 s85, s85, 8192
    buffer_load_dwordx4 v[128:131], v58, s[16:19], s86 offen
    buffer_load_dwordx4 v[132:135], v59, s[16:19], s86 offen
    s_add_u32 s86, s86, 13824
    buffer_load_dwordx4 v[136:139], v58, s[16:19], s86 offen
    buffer_load_dwordx4 v[140:143], v59, s[16:19], s86 offen
    s_add_u32 s86, s86, 13824
    s_setprio 1
    s_add_u32 m0, s26, 16384
    s_nop 0
    buffer_load_dwordx4 v70, s[12:15], s27 offen sc1 lds
    s_add_u32 s27, s27, 8192
    s_mov_b32 m0, 78848
    s_nop 0
    buffer_load_dwordx4 v57, s[12:15], s85 offen sc1 lds
    s_add_u32 s85, s85, 8192
    buffer_load_dwordx4 v[144:147], v58, s[16:19], s86 offen
    buffer_load_dwordx4 v[148:151], v59, s[16:19], s86 offen
    s_add_u32 s86, s86, 13824
    buffer_load_dwordx4 v[152:155], v58, s[16:19], s86 offen
    buffer_load_dwordx4 v[156:159], v59, s[16:19], s86 offen
    s_add_u32 s86, s86, 13824
    s_setprio 0
    s_add_u32 m0, s26, 24576
    s_nop 0
    buffer_load_dwordx4 v70, s[12:15], s27 offen sc1 lds
    s_add_u32 s27, s27, 8192
    s_mov_b32 m0, 79872
    s_nop 0
    buffer_load_dwordx4 v57, s[12:15], s85 offen sc1 lds
    s_add_u32 s85, s85, 8192
    buffer_load_dwordx4 v[160:163], v58, s[16:19], s86 offen
    buffer_load_dwordx4 v[164:167], v59, s[16:19], s86 offen
    s_add_u32 s86, s86, 13824
    buffer_load_dwordx4 v[168:171], v58, s[16:19], s86 offen
    buffer_load_dwordx4 v[172:175], v59, s[16:19], s86 offen
    s_add_u32 s86, s86, 13824
    s_setprio 0
    buffer_load_dwordx4 v[176:179], v58, s[16:19], s86 offen
    buffer_load_dwordx4 v[180:183], v59, s[16:19], s86 offen
    s_add_u32 s86, s86, 13824
    buffer_load_dwordx4 v[184:187], v58, s[16:19], s86 offen
    buffer_load_dwordx4 v[188:191], v59, s[16:19], s86 offen
    s_add_u32 s86, s86, 13824
    s_setprio 2
    s_waitcnt vmcnt(26)
    s_barrier
    ds_read_b128 v[8:11], v5 offset:0
    ds_read_b128 v[12:15], v1 offset:0
    ds_read_b128 v[16:19], v1 offset:256
    ds_read_b128 v[20:23], v1 offset:512
    ds_read_b128 v[24:27], v1 offset:768
    ds_read_b128 v[28:31], v5 offset:512
    ds_read_b128 v[32:35], v1 offset:4096
    ds_read_b128 v[36:39], v1 offset:4352
    ds_read_b128 v[40:43], v1 offset:4608
    ds_read_b128 v[44:47], v1 offset:4864
    s_waitcnt lgkmcnt(5)
    s_waitcnt vmcnt(24)
    v_mfma_f32_16x16x32_bf16 v[72:75], v[112:115], v[8:11], v[72:75]
    v_mfma_f32_16x16x32_bf16 v[76:79], v[112:115], v[12:15], v[76:79]
    s_add_u32 m0, s26, 32768
    s_nop 0
    buffer_load_dwordx4 v70, s[12:15], s27 offen sc1 lds
    s_add_u32 s27, s27, 8192
    s_mov_b32 m0, 80896
    s_nop 0
    buffer_load_dwordx4 v57, s[12:15], s85 offen sc1 lds
    s_add_u32 s85, s85, 8192
    buffer_load_dwordx4 v[192:195], v58, s[16:19], s86 offen
    buffer_load_dwordx4 v[196:199], v59, s[16:19], s86 offen
    s_add_u32 s86, s86, 13824
    v_mfma_f32_16x16x32_bf16 v[80:83], v[112:115], v[16:19], v[80:83]
    v_mfma_f32_16x16x32_bf16 v[84:87], v[112:115], v[20:23], v[84:87]
    v_mfma_f32_16x16x32_bf16 v[88:91], v[112:115], v[24:27], v[88:91]
    v_mfma_f32_16x16x32_bf16 v[92:95], v[116:119], v[20:23], v[92:95]
    v_mfma_f32_16x16x32_bf16 v[96:99], v[116:119], v[24:27], v[96:99]
    s_waitcnt vmcnt(18)
    s_barrier
    ds_read_b128 v[8:11], v5 offset:1024
    ds_read_b128 v[12:15], v1 offset:8192
    ds_read_b128 v[16:19], v1 offset:8448
    ds_read_b128 v[20:23], v1 offset:8704
    ds_read_b128 v[24:27], v1 offset:8960
    s_waitcnt lgkmcnt(5)
    v_mfma_f32_16x16x32_bf16 v[72:75], v[120:123], v[28:31], v[72:75]
    v_mfma_f32_16x16x32_bf16 v[76:79], v[120:123], v[32:35], v[76:79]
    buffer_load_dwordx4 v[200:203], v58, s[16:19], s86 offen
    buffer_load_dwordx4 v[204:207], v59, s[16:19], s86 offen
    s_add_u32 s86, s86, 13824
    v_mfma_f32_16x16x32_bf16 v[80:83], v[120:123], v[36:39], v[80:83]
    v_mfma_f32_16x16x32_bf16 v[84:87], v[120:123], v[40:43], v[84:87]
    v_mfma_f32_16x16x32_bf16 v[88:91], v[120:123], v[44:47], v[88:91]
    v_mfma_f32_16x16x32_bf16 v[92:95], v[124:127], v[40:43], v[92:95]
    v_mfma_f32_16x16x32_bf16 v[96:99], v[124:127], v[44:47], v[96:99]
    ds_read_b128 v[28:31], v5 offset:1536
    ds_read_b128 v[32:35], v1 offset:12288
    ds_read_b128 v[36:39], v1 offset:12544
    ds_read_b128 v[40:43], v1 offset:12800
    ds_read_b128 v[44:47], v1 offset:13056
    s_waitcnt lgkmcnt(5)
    v_mfma_f32_16x16x32_bf16 v[72:75], v[128:131], v[8:11], v[72:75]
    v_mfma_f32_16x16x32_bf16 v[76:79], v[128:131], v[12:15], v[76:79]
    s_add_u32 m0, s26, 40960
    s_nop 0
    buffer_load_dwordx4 v70, s[12:15], s27 offen sc1 lds
    s_add_u32 s27, s27, 8192
    s_mov_b32 m0, 81920
    s_nop 0
    buffer_load_dwordx4 v57, s[12:15], s85 offen sc1 lds
    s_add_u32 s85, s85, 8192
    buffer_load_dwordx4 v[208:211], v58, s[16:19], s86 offen
    buffer_load_dwordx4 v[212:215], v59, s[16:19], s86 offen
    s_add_u32 s86, s86, 13824
    v_mfma_f32_16x16x32_bf16 v[80:83], v[128:131], v[16:19], v[80:83]
    v_mfma_f32_16x16x32_bf16 v[84:87], v[128:131], v[20:23], v[84:87]
    v_mfma_f32_16x16x32_bf16 v[88:91], v[128:131], v[24:27], v[88:91]
    v_mfma_f32_16x16x32_bf16 v[92:95], v[132:135], v[20:23], v[92:95]
    v_mfma_f32_16x16x32_bf16 v[96:99], v[132:135], v[24:27], v[96:99]
    ds_read_b128 v[8:11], v5 offset:2048
    ds_read_b128 v[12:15], v1 offset:16384
    ds_read_b128 v[16:19], v1 offset:16640
    ds_read_b128 v[20:23], v1 offset:16896
    ds_read_b128 v[24:27], v1 offset:17152
    s_waitcnt lgkmcnt(5)
    v_mfma_f32_16x16x32_bf16 v[72:75], v[136:139], v[28:31], v[72:75]
    v_mfma_f32_16x16x32_bf16 v[76:79], v[136:139], v[32:35], v[76:79]
    buffer_load_dwordx4 v[216:219], v58, s[16:19], s86 offen
    buffer_load_dwordx4 v[220:223], v59, s[16:19], s86 offen
    s_add_u32 s86, s86, 13824
    v_mfma_f32_16x16x32_bf16 v[80:83], v[136:139], v[36:39], v[80:83]
    v_mfma_f32_16x16x32_bf16 v[84:87], v[136:139], v[40:43], v[84:87]
    v_mfma_f32_16x16x32_bf16 v[88:91], v[136:139], v[44:47], v[88:91]
    v_mfma_f32_16x16x32_bf16 v[92:95], v[140:143], v[40:43], v[92:95]
    v_mfma_f32_16x16x32_bf16 v[96:99], v[140:143], v[44:47], v[96:99]
    ds_read_b128 v[28:31], v5 offset:2560
    ds_read_b128 v[32:35], v1 offset:20480
    ds_read_b128 v[36:39], v1 offset:20736
    ds_read_b128 v[40:43], v1 offset:20992
    ds_read_b128 v[44:47], v1 offset:21248
    s_waitcnt lgkmcnt(5)
    s_waitcnt vmcnt(24)
    v_mfma_f32_16x16x32_bf16 v[72:75], v[144:147], v[8:11], v[72:75]
    v_mfma_f32_16x16x32_bf16 v[76:79], v[144:147], v[12:15], v[76:79]
    s_add_u32 m0, s26, 49152
    s_nop 0
    buffer_load_dwordx4 v70, s[12:15], s27 offen sc1 lds
    s_add_u32 s27, s27, 8192
    s_mov_b32 m0, 82944
    s_nop 0
    buffer_load_dwordx4 v57, s[12:15], s85 offen sc1 lds
    s_add_u32 s85, s85, 8192
    buffer_load_dwordx4 v[224:227], v58, s[16:19], s86 offen
    buffer_load_dwordx4 v[228:231], v59, s[16:19], s86 offen
    s_add_u32 s86, s86, 13824
    v_mfma_f32_16x16x32_bf16 v[80:83], v[144:147], v[16:19], v[80:83]
    v_mfma_f32_16x16x32_bf16 v[84:87], v[144:147], v[20:23], v[84:87]
    v_mfma_f32_16x16x32_bf16 v[88:91], v[144:147], v[24:27], v[88:91]
    v_mfma_f32_16x16x32_bf16 v[92:95], v[148:151], v[20:23], v[92:95]
    v_mfma_f32_16x16x32_bf16 v[96:99], v[148:151], v[24:27], v[96:99]
    s_waitcnt vmcnt(14)
    s_barrier
    ds_read_b128 v[8:11], v5 offset:3072
    ds_read_b128 v[12:15], v1 offset:24576
    ds_read_b128 v[16:19], v1 offset:24832
    ds_read_b128 v[20:23], v1 offset:25088
    ds_read_b128 v[24:27], v1 offset:25344
    s_waitcnt lgkmcnt(5)
    v_mfma_f32_16x16x32_bf16 v[72:75], v[152:155], v[28:31], v[72:75]
    v_mfma_f32_16x16x32_bf16 v[76:79], v[152:155], v[32:35], v[76:79]
    buffer_load_dwordx4 v[232:235], v58, s[16:19], s86 offen
    buffer_load_dwordx4 v[236:239], v59, s[16:19], s86 offen
    s_add_u32 s86, s86, 13824
    v_mfma_f32_16x16x32_bf16 v[80:83], v[152:155], v[36:39], v[80:83]
    v_mfma_f32_16x16x32_bf16 v[84:87], v[152:155], v[40:43], v[84:87]
    v_mfma_f32_16x16x32_bf16 v[88:91], v[152:155], v[44:47], v[88:91]
    v_mfma_f32_16x16x32_bf16 v[92:95], v[156:159], v[40:43], v[92:95]
    v_mfma_f32_16x16x32_bf16 v[96:99], v[156:159], v[44:47], v[96:99]
    ds_read_b128 v[28:31], v5 offset:3584
    ds_read_b128 v[32:35], v1 offset:28672
    ds_read_b128 v[36:39], v1 offset:28928
    ds_read_b128 v[40:43], v1 offset:29184
    ds_read_b128 v[44:47], v1 offset:29440
    s_waitcnt lgkmcnt(5)
    v_mfma_f32_16x16x32_bf16 v[72:75], v[160:163], v[8:11], v[72:75]
    v_mfma_f32_16x16x32_bf16 v[76:79], v[160:163], v[12:15], v[76:79]
    s_add_u32 m0, s26, 57344
    s_nop 0
    buffer_load_dwordx4 v70, s[12:15], s27 offen sc1 lds
    s_add_u32 s27, s27, 8192
    s_mov_b32 m0, 83968
    s_nop 0
    buffer_load_dwordx4 v57, s[12:15], s85 offen sc1 lds
    s_add_u32 s85, s85, 8192
    buffer_load_dwordx4 v[240:243], v58, s[16:19], s86 offen
    buffer_load_dwordx4 v[244:247], v59, s[16:19], s86 offen
    s_add_u32 s86, s86, 13824
    v_mfma_f32_16x16x32_bf16 v[80:83], v[160:163], v[16:19], v[80:83]
    v_mfma_f32_16x16x32_bf16 v[84:87], v[160:163], v[20:23], v[84:87]
    v_mfma_f32_16x16x32_bf16 v[88:91], v[160:163], v[24:27], v[88:91]
    v_mfma_f32_16x16x32_bf16 v[92:95], v[164:167], v[20:23], v[92:95]
    v_mfma_f32_16x16x32_bf16 v[96:99], v[164:167], v[24:27], v[96:99]
    ds_read_b128 v[8:11], v5 offset:4096
    ds_read_b128 v[12:15], v1 offset:32768
    ds_read_b128 v[16:19], v1 offset:33024
    ds_read_b128 v[20:23], v1 offset:33280
    ds_read_b128 v[24:27], v1 offset:33536
    s_waitcnt lgkmcnt(5)
    v_mfma_f32_16x16x32_bf16 v[72:75], v[168:171], v[28:31], v[72:75]
    v_mfma_f32_16x16x32_bf16 v[76:79], v[168:171], v[32:35], v[76:79]
    buffer_load_dwordx4 v[248:251], v58, s[16:19], s86 offen
    buffer_load_dwordx4 v[252:255], v59, s[16:19], s86 offen
    s_add_u32 s86, s86, 13824
    v_mfma_f32_16x16x32_bf16 v[80:83], v[168:171], v[36:39], v[80:83]
    v_mfma_f32_16x16x32_bf16 v[84:87], v[168:171], v[40:43], v[84:87]
    v_mfma_f32_16x16x32_bf16 v[88:91], v[168:171], v[44:47], v[88:91]
    v_mfma_f32_16x16x32_bf16 v[92:95], v[172:175], v[40:43], v[92:95]
    v_mfma_f32_16x16x32_bf16 v[96:99], v[172:175], v[44:47], v[96:99]
    ds_read_b128 v[28:31], v5 offset:4608
    ds_read_b128 v[32:35], v4 offset:0
    ds_read_b128 v[36:39], v4 offset:256
    ds_read_b128 v[40:43], v4 offset:512
    ds_read_b128 v[44:47], v4 offset:768
    s_waitcnt lgkmcnt(5)
    v_mfma_f32_16x16x32_bf16 v[72:75], v[176:179], v[8:11], v[72:75]
    v_mfma_f32_16x16x32_bf16 v[76:79], v[176:179], v[12:15], v[76:79]
    s_add_u32 m0, s26, 65536
    s_nop 0
    buffer_load_dwordx4 v70, s[12:15], s27 offen sc1 lds
    s_add_u32 s27, s27, 8192
    s_mov_b32 m0, 84992
    s_nop 0
    buffer_load_dwordx4 v57, s[12:15], s85 offen sc1 lds
    s_add_u32 s85, s85, 8192
    v_mfma_f32_16x16x32_bf16 v[80:83], v[176:179], v[16:19], v[80:83]
    v_mfma_f32_16x16x32_bf16 v[84:87], v[176:179], v[20:23], v[84:87]
    v_mfma_f32_16x16x32_bf16 v[88:91], v[176:179], v[24:27], v[88:91]
    v_mfma_f32_16x16x32_bf16 v[92:95], v[180:183], v[20:23], v[92:95]
    v_mfma_f32_16x16x32_bf16 v[96:99], v[180:183], v[24:27], v[96:99]
    s_waitcnt vmcnt(12)
    s_barrier
    ds_read_b128 v[8:11], v5 offset:5120
    ds_read_b128 v[12:15], v4 offset:4096
    ds_read_b128 v[16:19], v4 offset:4352
    ds_read_b128 v[20:23], v4 offset:4608
    ds_read_b128 v[24:27], v4 offset:4864
    s_waitcnt lgkmcnt(5)
    v_mfma_f32_16x16x32_bf16 v[72:75], v[184:187], v[28:31], v[72:75]
    v_mfma_f32_16x16x32_bf16 v[76:79], v[184:187], v[32:35], v[76:79]
    v_mfma_f32_16x16x32_bf16 v[80:83], v[184:187], v[36:39], v[80:83]
    v_mfma_f32_16x16x32_bf16 v[84:87], v[184:187], v[40:43], v[84:87]
    v_mfma_f32_16x16x32_bf16 v[88:91], v[184:187], v[44:47], v[88:91]
    v_mfma_f32_16x16x32_bf16 v[92:95], v[188:191], v[40:43], v[92:95]
    v_mfma_f32_16x16x32_bf16 v[96:99], v[188:191], v[44:47], v[96:99]
    ds_read_b128 v[28:31], v5 offset:5632
    ds_read_b128 v[32:35], v4 offset:8192
    ds_read_b128 v[36:39], v4 offset:8448
    ds_read_b128 v[40:43], v4 offset:8704
    ds_read_b128 v[44:47], v4 offset:8960
    s_waitcnt lgkmcnt(5)
    v_mfma_f32_16x16x32_bf16 v[72:75], v[192:195], v[8:11], v[72:75]
    v_mfma_f32_16x16x32_bf16 v[76:79], v[192:195], v[12:15], v[76:79]
    v_mfma_f32_16x16x32_bf16 v[80:83], v[192:195], v[16:19], v[80:83]
    v_mfma_f32_16x16x32_bf16 v[84:87], v[192:195], v[20:23], v[84:87]
    v_mfma_f32_16x16x32_bf16 v[88:91], v[192:195], v[24:27], v[88:91]
    v_mfma_f32_16x16x32_bf16 v[92:95], v[196:199], v[20:23], v[92:95]
    v_mfma_f32_16x16x32_bf16 v[96:99], v[196:199], v[24:27], v[96:99]
    s_mul_i32 s5, s20, 9216
    s_add_u32 s5, s5, s24
    buffer_load_dwordx2 v[60:61], v67, s[12:15], s5 offen
    s_add_u32 s5, s5, 2048
    buffer_load_dwordx2 v[62:63], v67, s[12:15], s5 offen
    s_add_u32 s5, s5, 2048
    buffer_load_dwordx2 v[64:65], v67, s[12:15], s5 offen
    s_add_u32 s5, s5, 2048
    ds_read_b128 v[8:11], v5 offset:6144
    ds_read_b128 v[12:15], v4 offset:12288
    ds_read_b128 v[16:19], v4 offset:12544
    ds_read_b128 v[20:23], v4 offset:12800
    ds_read_b128 v[24:27], v4 offset:13056
    s_waitcnt lgkmcnt(5)
    v_mfma_f32_16x16x32_bf16 v[72:75], v[200:203], v[28:31], v[72:75]
    v_mfma_f32_16x16x32_bf16 v[76:79], v[200:203], v[32:35], v[76:79]
    v_mfma_f32_16x16x32_bf16 v[80:83], v[200:203], v[36:39], v[80:83]
    v_mfma_f32_16x16x32_bf16 v[84:87], v[200:203], v[40:43], v[84:87]
    v_mfma_f32_16x16x32_bf16 v[88:91], v[200:203], v[44:47], v[88:91]
    v_mfma_f32_16x16x32_bf16 v[92:95], v[204:207], v[40:43], v[92:95]
    v_mfma_f32_16x16x32_bf16 v[96:99], v[204:207], v[44:47], v[96:99]
    ds_read_b128 v[28:31], v5 offset:6656
    ds_read_b128 v[32:35], v4 offset:16384
    ds_read_b128 v[36:39], v4 offset:16640
    ds_read_b128 v[40:43], v4 offset:16896
    ds_read_b128 v[44:47], v4 offset:17152
    s_waitcnt lgkmcnt(5)
    v_mfma_f32_16x16x32_bf16 v[72:75], v[208:211], v[8:11], v[72:75]
    v_mfma_f32_16x16x32_bf16 v[76:79], v[208:211], v[12:15], v[76:79]
    v_mfma_f32_16x16x32_bf16 v[80:83], v[208:211], v[16:19], v[80:83]
    v_mfma_f32_16x16x32_bf16 v[84:87], v[208:211], v[20:23], v[84:87]
    v_mfma_f32_16x16x32_bf16 v[88:91], v[208:211], v[24:27], v[88:91]
    v_mfma_f32_16x16x32_bf16 v[92:95], v[212:215], v[20:23], v[92:95]
    v_mfma_f32_16x16x32_bf16 v[96:99], v[212:215], v[24:27], v[96:99]
    s_waitcnt vmcnt(3)
    s_barrier
    ds_read_b128 v[8:11], v5 offset:7168
    ds_read_b128 v[12:15], v4 offset:20480
    ds_read_b128 v[16:19], v4 offset:20736
    ds_read_b128 v[20:23], v4 offset:20992
    ds_read_b128 v[24:27], v4 offset:21248
    s_waitcnt lgkmcnt(5)
    v_mfma_f32_16x16x32_bf16 v[72:75], v[216:219], v[28:31], v[72:75]
    v_mfma_f32_16x16x32_bf16 v[76:79], v[216:219], v[32:35], v[76:79]
    v_mfma_f32_16x16x32_bf16 v[80:83], v[216:219], v[36:39], v[80:83]
    v_mfma_f32_16x16x32_bf16 v[84:87], v[216:219], v[40:43], v[84:87]
    v_mfma_f32_16x16x32_bf16 v[88:91], v[216:219], v[44:47], v[88:91]
    v_mfma_f32_16x16x32_bf16 v[92:95], v[220:223], v[40:43], v[92:95]
    v_mfma_f32_16x16x32_bf16 v[96:99], v[220:223], v[44:47], v[96:99]
    ds_read_b128 v[28:31], v5 offset:7680
    ds_read_b128 v[32:35], v4 offset:24576
    ds_read_b128 v[36:39], v4 offset:24832
    ds_read_b128 v[40:43], v4 offset:25088
    ds_read_b128 v[44:47], v4 offset:25344
    s_waitcnt lgkmcnt(5)
    v_mfma_f32_16x16x32_bf16 v[72:75], v[224:227], v[8:11], v[72:75]
    v_mfma_f32_16x16x32_bf16 v[76:79], v[224:227], v[12:15], v[76:79]
    v_mfma_f32_16x16x32_bf16 v[80:83], v[224:227], v[16:19], v[80:83]
    v_mfma_f32_16x16x32_bf16 v[84:87], v[224:227], v[20:23], v[84:87]
    v_mfma_f32_16x16x32_bf16 v[88:91], v[224:227], v[24:27], v[88:91]
    v_mfma_f32_16x16x32_bf16 v[92:95], v[228:231], v[20:23], v[92:95]
    v_mfma_f32_16x16x32_bf16 v[96:99], v[228:231], v[24:27], v[96:99]
    ds_read_b128 v[8:11], v5 offset:8192
    ds_read_b128 v[12:15], v4 offset:28672
    ds_read_b128 v[16:19], v4 offset:28928
    ds_read_b128 v[20:23], v4 offset:29184
    ds_read_b128 v[24:27], v4 offset:29440
    s_waitcnt lgkmcnt(5)
    v_mfma_f32_16x16x32_bf16 v[72:75], v[232:235], v[28:31], v[72:75]
    v_mfma_f32_16x16x32_bf16 v[76:79], v[232:235], v[32:35], v[76:79]
    v_mfma_f32_16x16x32_bf16 v[80:83], v[232:235], v[36:39], v[80:83]
    v_mfma_f32_16x16x32_bf16 v[84:87], v[232:235], v[40:43], v[84:87]
    v_mfma_f32_16x16x32_bf16 v[88:91], v[232:235], v[44:47], v[88:91]
    v_mfma_f32_16x16x32_bf16 v[92:95], v[236:239], v[40:43], v[92:95]
    v_mfma_f32_16x16x32_bf16 v[96:99], v[236:239], v[44:47], v[96:99]
    ds_read_b128 v[28:31], v5 offset:8704
    ds_read_b128 v[32:35], v4 offset:32768
    ds_read_b128 v[36:39], v4 offset:33024
    ds_read_b128 v[40:43], v4 offset:33280
    ds_read_b128 v[44:47], v4 offset:33536
    s_waitcnt lgkmcnt(5)
    v_mfma_f32_16x16x32_bf16 v[72:75], v[240:243], v[8:11], v[72:75]
    v_and_b32 v2, 15, v0
    v_lshrrev_b32 v3, 4, v0
    v_lshlrev_b32 v224, 2, v2
    v_lshlrev_b32 v225, 4, v3
    v_lshlrev_b32 v6, 3, v0
    v_mfma_f32_16x16x32_bf16 v[76:79], v[240:243], v[12:15], v[76:79]
    s_mul_i32 s5, s30, 2560
    s_add_u32 s5, s5, 128000
    v_add_u32 v226, s5, v6
    s_mul_i32 s5, s31, 2560
    s_add_u32 s5, s5, 128000
    v_mfma_f32_16x16x32_bf16 v[80:83], v[240:243], v[16:19], v[80:83]
    v_add_u32 v227, s5, v6
    s_and_b32 s7, s3, 1
    s_mul_i32 s7, s7, 896
    s_add_u32 s7, s7, 640
    s_add_u32 s5, s7, 480
    v_mfma_f32_16x16x32_bf16 v[84:87], v[240:243], v[20:23], v[84:87]
    v_add_u32 v232, s5, v225
    v_lshrrev_b32 v233, 1, v3
    v_lshlrev_b32 v233, 8, v233
    s_add_u32 s5, s7, 256
    v_add3_u32 v233, v233, v225, s5
    v_mfma_f32_16x16x32_bf16 v[88:91], v[240:243], v[24:27], v[88:91]
    v_add_u32 v234, 129536, v6
    v_add_u32 v6, 256, v6
    v_and_b32 v6, 0x1ff, v6
    v_add_u32 v235, 139776, v6
    v_lshlrev_b32 v3, 2, v3
    v_mfma_f32_16x16x32_bf16 v[92:95], v[244:247], v[20:23], v[92:95]
    v_cmp_le_u32 s[80:81], v3, v2
    v_sub_u32 v6, v2, v3
    v_mov_b32 v2, 0xf149f2ca
    s_mov_b32 s5, 8
    v_add_u32 v3, 16, v6
    v_mfma_f32_16x16x32_bf16 v[96:99], v[244:247], v[24:27], v[96:99]
    v_cmp_gt_u32 s[76:77], s5, v3
    v_subrev_u32 v3, 0, v6
    v_cmp_gt_u32 s[78:79], 8, v3
    s_nop 0
    v_cndmask_b32 v228, v2, 0, s[76:77]
    s_waitcnt lgkmcnt(0)
    v_mfma_f32_16x16x32_bf16 v[72:75], v[248:251], v[28:31], v[72:75]
    v_cndmask_b32 v236, v2, 0, s[78:79]
    v_add_u32 v3, 15, v6
    v_cmp_gt_u32 s[76:77], s5, v3
    v_subrev_u32 v3, 1, v6
    v_cmp_gt_u32 s[78:79], 8, v3
    v_mfma_f32_16x16x32_bf16 v[76:79], v[248:251], v[32:35], v[76:79]
    s_nop 0
    v_cndmask_b32 v229, v2, 0, s[76:77]
    v_cndmask_b32 v237, v2, 0, s[78:79]
    v_add_u32 v3, 14, v6
    v_cmp_gt_u32 s[76:77], s5, v3
    v_mfma_f32_16x16x32_bf16 v[80:83], v[248:251], v[36:39], v[80:83]
    v_subrev_u32 v3, 2, v6
    v_cmp_gt_u32 s[78:79], 8, v3
    s_nop 0
    v_cndmask_b32 v230, v2, 0, s[76:77]
    v_cndmask_b32 v238, v2, 0, s[78:79]
    v_mfma_f32_16x16x32_bf16 v[84:87], v[248:251], v[40:43], v[84:87]
    v_add_u32 v3, 13, v6
    v_cmp_gt_u32 s[76:77], s5, v3
    v_subrev_u32 v3, 3, v6
    v_cmp_gt_u32 s[78:79], 8, v3
    s_nop 0
    v_mfma_f32_16x16x32_bf16 v[88:91], v[248:251], v[44:47], v[88:91]
    v_cndmask_b32 v231, v2, 0, s[76:77]
    v_cndmask_b32 v239, v2, 0, s[78:79]
    v_mfma_f32_16x16x32_bf16 v[92:95], v[252:255], v[40:43], v[92:95]
    v_mfma_f32_16x16x32_bf16 v[96:99], v[252:255], v[44:47], v[96:99]
    s_setprio 0
    s_branch M_S7_epi
M_S7_loop:
    v_mov_b32 v72, 0
    v_mov_b32 v73, 0
    v_mov_b32 v74, 0
    v_mov_b32 v75, 0
    v_mov_b32 v76, 0
    v_mov_b32 v77, 0
    v_mov_b32 v78, 0
    v_mov_b32 v79, 0
    v_mov_b32 v80, 0
    v_mov_b32 v81, 0
    v_mov_b32 v82, 0
    v_mov_b32 v83, 0
    v_mov_b32 v84, 0
    v_mov_b32 v85, 0
    v_mov_b32 v86, 0
    v_mov_b32 v87, 0
    v_mov_b32 v88, 0
    v_mov_b32 v89, 0
    v_mov_b32 v90, 0
    v_mov_b32 v91, 0
    v_mov_b32 v92, 0
    v_mov_b32 v93, 0
    v_mov_b32 v94, 0
    v_mov_b32 v95, 0
    v_mov_b32 v96, 0
    v_mov_b32 v97, 0
    v_mov_b32 v98, 0
    v_mov_b32 v99, 0
    s_setprio 3
    s_add_u32 m0, s26, 0
    s_nop 0
    buffer_load_dwordx4 v70, s[12:15], s27 offen sc1 lds
    s_add_u32 s27, s27, 8192
    s_mov_b32 m0, 76800
    s_nop 0
    buffer_load_dwordx4 v57, s[12:15], s85 offen sc1 lds
    s_add_u32 s85, s85, 8192
    s_setprio 2
    s_add_u32 m0, s26, 8192
    s_nop 0
    buffer_load_dwordx4 v70, s[12:15], s27 offen sc1 lds
    s_add_u32 s27, s27, 8192
    s_mov_b32 m0, 77824
    s_nop 0
    buffer_load_dwordx4 v57, s[12:15], s85 offen sc1 lds
    s_add_u32 s85, s85, 8192
    s_setprio 1
    s_add_u32 m0, s26, 16384
    s_nop 0
    buffer_load_dwordx4 v70, s[12:15], s27 offen sc1 lds
    s_add_u32 s27, s27, 8192
    s_mov_b32 m0, 78848
    s_nop 0
    buffer_load_dwordx4 v57, s[12:15], s85 offen sc1 lds
    s_add_u32 s85, s85, 8192
    s_setprio 0
    s_add_u32 m0, s26, 24576
    s_nop 0
    buffer_load_dwordx4 v70, s[12:15], s27 offen sc1 lds
    s_add_u32 s27, s27, 8192
    s_mov_b32 m0, 79872
    s_nop 0
    buffer_load_dwordx4 v57, s[12:15], s85 offen sc1 lds
    s_add_u32 s85, s85, 8192
    s_setprio 2
    s_waitcnt vmcnt(6)
    s_barrier
    ds_read_b128 v[8:11], v5 offset:0
    ds_read_b128 v[12:15], v1 offset:0
    ds_read_b128 v[16:19], v1 offset:256
    ds_read_b128 v[20:23], v1 offset:512
    ds_read_b128 v[24:27], v1 offset:768
    ds_read_b128 v[28:31], v5 offset:512
    ds_read_b128 v[32:35], v1 offset:4096
    ds_read_b128 v[36:39], v1 offset:4352
    ds_read_b128 v[40:43], v1 offset:4608
    ds_read_b128 v[44:47], v1 offset:4864
    s_waitcnt lgkmcnt(5)
    v_mfma_f32_16x16x32_bf16 v[72:75], v[112:115], v[8:11], v[72:75]
    v_mfma_f32_16x16x32_bf16 v[76:79], v[112:115], v[12:15], v[76:79]
    s_add_u32 m0, s26, 32768
    s_nop 0
    buffer_load_dwordx4 v70, s[12:15], s27 offen sc1 lds
    s_add_u32 s27, s27, 8192
    s_mov_b32 m0, 80896
    s_nop 0
    buffer_load_dwordx4 v57, s[12:15], s85 offen sc1 lds
    s_add_u32 s85, s85, 8192
    v_mfma_f32_16x16x32_bf16 v[80:83], v[112:115], v[16:19], v[80:83]
    v_mfma_f32_16x16x32_bf16 v[84:87], v[112:115], v[20:23], v[84:87]
    v_mfma_f32_16x16x32_bf16 v[88:91], v[112:115], v[24:27], v[88:91]
    v_mfma_f32_16x16x32_bf16 v[92:95], v[116:119], v[20:23], v[92:95]
    v_mfma_f32_16x16x32_bf16 v[96:99], v[116:119], v[24:27], v[96:99]
    s_waitcnt vmcnt(4)
    s_barrier
    ds_read_b128 v[8:11], v5 offset:1024
    ds_read_b128 v[12:15], v1 offset:8192
    ds_read_b128 v[16:19], v1 offset:8448
    ds_read_b128 v[20:23], v1 offset:8704
    ds_read_b128 v[24:27], v1 offset:8960
    s_waitcnt lgkmcnt(5)
    v_mfma_f32_16x16x32_bf16 v[72:75], v[120:123], v[28:31], v[72:75]
    v_mfma_f32_16x16x32_bf16 v[76:79], v[120:123], v[32:35], v[76:79]
    v_mfma_f32_16x16x32_bf16 v[80:83], v[120:123], v[36:39], v[80:83]
    v_mfma_f32_16x16x32_bf16 v[84:87], v[120:123], v[40:43], v[84:87]
    v_mfma_f32_16x16x32_bf16 v[88:91], v[120:123], v[44:47], v[88:91]
    v_mfma_f32_16x16x32_bf16 v[92:95], v[124:127], v[40:43], v[92:95]
    v_mfma_f32_16x16x32_bf16 v[96:99], v[124:127], v[44:47], v[96:99]
    ds_read_b128 v[28:31], v5 offset:1536
    ds_read_b128 v[32:35], v1 offset:12288
    ds_read_b128 v[36:39], v1 offset:12544
    ds_read_b128 v[40:43], v1 offset:12800
    ds_read_b128 v[44:47], v1 offset:13056
    s_waitcnt lgkmcnt(5)
    v_mfma_f32_16x16x32_bf16 v[72:75], v[128:131], v[8:11], v[72:75]
    v_mfma_f32_16x16x32_bf16 v[76:79], v[128:131], v[12:15], v[76:79]
    s_add_u32 m0, s26, 40960
    s_nop 0
    buffer_load_dwordx4 v70, s[12:15], s27 offen sc1 lds
    s_add_u32 s27, s27, 8192
    s_mov_b32 m0, 81920
    s_nop 0
    buffer_load_dwordx4 v57, s[12:15], s85 offen sc1 lds
    s_add_u32 s85, s85, 8192
    v_mfma_f32_16x16x32_bf16 v[80:83], v[128:131], v[16:19], v[80:83]
    v_mfma_f32_16x16x32_bf16 v[84:87], v[128:131], v[20:23], v[84:87]
    v_mfma_f32_16x16x32_bf16 v[88:91], v[128:131], v[24:27], v[88:91]
    v_mfma_f32_16x16x32_bf16 v[92:95], v[132:135], v[20:23], v[92:95]
    v_mfma_f32_16x16x32_bf16 v[96:99], v[132:135], v[24:27], v[96:99]
    ds_read_b128 v[8:11], v5 offset:2048
    ds_read_b128 v[12:15], v1 offset:16384
    ds_read_b128 v[16:19], v1 offset:16640
    ds_read_b128 v[20:23], v1 offset:16896
    ds_read_b128 v[24:27], v1 offset:17152
    s_waitcnt lgkmcnt(5)
    v_mfma_f32_16x16x32_bf16 v[72:75], v[136:139], v[28:31], v[72:75]
    v_mfma_f32_16x16x32_bf16 v[76:79], v[136:139], v[32:35], v[76:79]
    v_mfma_f32_16x16x32_bf16 v[80:83], v[136:139], v[36:39], v[80:83]
    v_mfma_f32_16x16x32_bf16 v[84:87], v[136:139], v[40:43], v[84:87]
    v_mfma_f32_16x16x32_bf16 v[88:91], v[136:139], v[44:47], v[88:91]
    v_mfma_f32_16x16x32_bf16 v[92:95], v[140:143], v[40:43], v[92:95]
    v_mfma_f32_16x16x32_bf16 v[96:99], v[140:143], v[44:47], v[96:99]
    ds_read_b128 v[28:31], v5 offset:2560
    ds_read_b128 v[32:35], v1 offset:20480
    ds_read_b128 v[36:39], v1 offset:20736
    ds_read_b128 v[40:43], v1 offset:20992
    ds_read_b128 v[44:47], v1 offset:21248
    s_waitcnt lgkmcnt(5)
    v_mfma_f32_16x16x32_bf16 v[72:75], v[144:147], v[8:11], v[72:75]
    v_mfma_f32_16x16x32_bf16 v[76:79], v[144:147], v[12:15], v[76:79]
    s_add_u32 m0, s26, 49152
    s_nop 0
    buffer_load_dwordx4 v70, s[12:15], s27 offen sc1 lds
    s_add_u32 s27, s27, 8192
    s_mov_b32 m0, 82944
    s_nop 0
    buffer_load_dwordx4 v57, s[12:15], s85 offen sc1 lds
    s_add_u32 s85, s85, 8192
    v_mfma_f32_16x16x32_bf16 v[80:83], v[144:147], v[16:19], v[80:83]
    v_mfma_f32_16x16x32_bf16 v[84:87], v[144:147], v[20:23], v[84:87]
    v_mfma_f32_16x16x32_bf16 v[88:91], v[144:147], v[24:27], v[88:91]
    v_mfma_f32_16x16x32_bf16 v[92:95], v[148:151], v[20:23], v[92:95]
    v_mfma_f32_16x16x32_bf16 v[96:99], v[148:151], v[24:27], v[96:99]
    s_add_u32 s84, s28, 0
    buffer_load_dwordx4 v[112:115], v58, s[16:19], s84 offen
    s_add_u32 s84, s28, 0
    buffer_load_dwordx4 v[116:119], v59, s[16:19], s84 offen
    s_waitcnt vmcnt(6)
    s_barrier
    ds_read_b128 v[8:11], v5 offset:3072
    ds_read_b128 v[12:15], v1 offset:24576
    ds_read_b128 v[16:19], v1 offset:24832
    ds_read_b128 v[20:23], v1 offset:25088
    ds_read_b128 v[24:27], v1 offset:25344
    s_waitcnt lgkmcnt(5)
    v_mfma_f32_16x16x32_bf16 v[72:75], v[152:155], v[28:31], v[72:75]
    v_mfma_f32_16x16x32_bf16 v[76:79], v[152:155], v[32:35], v[76:79]
    v_mfma_f32_16x16x32_bf16 v[80:83], v[152:155], v[36:39], v[80:83]
    v_mfma_f32_16x16x32_bf16 v[84:87], v[152:155], v[40:43], v[84:87]
    v_mfma_f32_16x16x32_bf16 v[88:91], v[152:155], v[44:47], v[88:91]
    v_mfma_f32_16x16x32_bf16 v[92:95], v[156:159], v[40:43], v[92:95]
    v_mfma_f32_16x16x32_bf16 v[96:99], v[156:159], v[44:47], v[96:99]
    s_add_u32 s84, s28, 13824
    buffer_load_dwordx4 v[120:123], v58, s[16:19], s84 offen
    s_add_u32 s84, s28, 13824
    buffer_load_dwordx4 v[124:127], v59, s[16:19], s84 offen
    ds_read_b128 v[28:31], v5 offset:3584
    ds_read_b128 v[32:35], v1 offset:28672
    ds_read_b128 v[36:39], v1 offset:28928
    ds_read_b128 v[40:43], v1 offset:29184
    ds_read_b128 v[44:47], v1 offset:29440
    s_waitcnt lgkmcnt(5)
    v_mfma_f32_16x16x32_bf16 v[72:75], v[160:163], v[8:11], v[72:75]
    v_mfma_f32_16x16x32_bf16 v[76:79], v[160:163], v[12:15], v[76:79]
    s_add_u32 m0, s26, 57344
    s_nop 0
    buffer_load_dwordx4 v70, s[12:15], s27 offen sc1 lds
    s_add_u32 s27, s27, 8192
    s_mov_b32 m0, 83968
    s_nop 0
    buffer_load_dwordx4 v57, s[12:15], s85 offen sc1 lds
    s_add_u32 s85, s85, 8192
    v_mfma_f32_16x16x32_bf16 v[80:83], v[160:163], v[16:19], v[80:83]
    v_mfma_f32_16x16x32_bf16 v[84:87], v[160:163], v[20:23], v[84:87]
    v_mfma_f32_16x16x32_bf16 v[88:91], v[160:163], v[24:27], v[88:91]
    v_mfma_f32_16x16x32_bf16 v[92:95], v[164:167], v[20:23], v[92:95]
    v_mfma_f32_16x16x32_bf16 v[96:99], v[164:167], v[24:27], v[96:99]
    s_add_u32 s84, s28, 27648
    buffer_load_dwordx4 v[128:131], v58, s[16:19], s84 offen
    s_add_u32 s84, s28, 27648
    buffer_load_dwordx4 v[132:135], v59, s[16:19], s84 offen
    ds_read_b128 v[8:11], v5 offset:4096
    ds_read_b128 v[12:15], v1 offset:32768
    ds_read_b128 v[16:19], v1 offset:33024
    ds_read_b128 v[20:23], v1 offset:33280
    ds_read_b128 v[24:27], v1 offset:33536
    s_waitcnt lgkmcnt(5)
    v_mfma_f32_16x16x32_bf16 v[72:75], v[168:171], v[28:31], v[72:75]
    v_mfma_f32_16x16x32_bf16 v[76:79], v[168:171], v[32:35], v[76:79]
    v_mfma_f32_16x16x32_bf16 v[80:83], v[168:171], v[36:39], v[80:83]
    v_mfma_f32_16x16x32_bf16 v[84:87], v[168:171], v[40:43], v[84:87]
    v_mfma_f32_16x16x32_bf16 v[88:91], v[168:171], v[44:47], v[88:91]
    v_mfma_f32_16x16x32_bf16 v[92:95], v[172:175], v[40:43], v[92:95]
    v_mfma_f32_16x16x32_bf16 v[96:99], v[172:175], v[44:47], v[96:99]
    s_add_u32 s84, s28, 41472
    buffer_load_dwordx4 v[136:139], v58, s[16:19], s84 offen
    s_add_u32 s84, s28, 41472
    buffer_load_dwordx4 v[140:143], v59, s[16:19], s84 offen
    ds_read_b128 v[28:31], v5 offset:4608
    ds_read_b128 v[32:35], v4 offset:0
    ds_read_b128 v[36:39], v4 offset:256
    ds_read_b128 v[40:43], v4 offset:512
    ds_read_b128 v[44:47], v4 offset:768
    s_waitcnt lgkmcnt(5)
    v_mfma_f32_16x16x32_bf16 v[72:75], v[176:179], v[8:11], v[72:75]
    v_mfma_f32_16x16x32_bf16 v[76:79], v[176:179], v[12:15], v[76:79]
    s_add_u32 m0, s26, 65536
    s_nop 0
    buffer_load_dwordx4 v70, s[12:15], s27 offen sc1 lds
    s_add_u32 s27, s27, 8192
    s_mov_b32 m0, 84992
    s_nop 0
    buffer_load_dwordx4 v57, s[12:15], s85 offen sc1 lds
    s_add_u32 s85, s85, 8192
    v_mfma_f32_16x16x32_bf16 v[80:83], v[176:179], v[16:19], v[80:83]
    v_mfma_f32_16x16x32_bf16 v[84:87], v[176:179], v[20:23], v[84:87]
    v_mfma_f32_16x16x32_bf16 v[88:91], v[176:179], v[24:27], v[88:91]
    v_mfma_f32_16x16x32_bf16 v[92:95], v[180:183], v[20:23], v[92:95]
    v_mfma_f32_16x16x32_bf16 v[96:99], v[180:183], v[24:27], v[96:99]
    s_add_u32 s84, s28, 55296
    buffer_load_dwordx4 v[144:147], v58, s[16:19], s84 offen
    s_add_u32 s84, s28, 55296
    buffer_load_dwordx4 v[148:151], v59, s[16:19], s84 offen
    s_waitcnt vmcnt(14)
    s_barrier
    ds_read_b128 v[8:11], v5 offset:5120
    ds_read_b128 v[12:15], v4 offset:4096
    ds_read_b128 v[16:19], v4 offset:4352
    ds_read_b128 v[20:23], v4 offset:4608
    ds_read_b128 v[24:27], v4 offset:4864
    s_waitcnt lgkmcnt(5)
    v_mfma_f32_16x16x32_bf16 v[72:75], v[184:187], v[28:31], v[72:75]
    v_mfma_f32_16x16x32_bf16 v[76:79], v[184:187], v[32:35], v[76:79]
    v_mfma_f32_16x16x32_bf16 v[80:83], v[184:187], v[36:39], v[80:83]
    v_mfma_f32_16x16x32_bf16 v[84:87], v[184:187], v[40:43], v[84:87]
    v_mfma_f32_16x16x32_bf16 v[88:91], v[184:187], v[44:47], v[88:91]
    v_mfma_f32_16x16x32_bf16 v[92:95], v[188:191], v[40:43], v[92:95]
    v_mfma_f32_16x16x32_bf16 v[96:99], v[188:191], v[44:47], v[96:99]
    s_add_u32 s84, s28, 69120
    buffer_load_dwordx4 v[152:155], v58, s[16:19], s84 offen
    s_add_u32 s84, s28, 69120
    buffer_load_dwordx4 v[156:159], v59, s[16:19], s84 offen
    ds_read_b128 v[28:31], v5 offset:5632
    ds_read_b128 v[32:35], v4 offset:8192
    ds_read_b128 v[36:39], v4 offset:8448
    ds_read_b128 v[40:43], v4 offset:8704
    ds_read_b128 v[44:47], v4 offset:8960
    s_waitcnt lgkmcnt(5)
    v_mfma_f32_16x16x32_bf16 v[72:75], v[192:195], v[8:11], v[72:75]
    v_mfma_f32_16x16x32_bf16 v[76:79], v[192:195], v[12:15], v[76:79]
    v_mfma_f32_16x16x32_bf16 v[80:83], v[192:195], v[16:19], v[80:83]
    v_mfma_f32_16x16x32_bf16 v[84:87], v[192:195], v[20:23], v[84:87]
    v_mfma_f32_16x16x32_bf16 v[88:91], v[192:195], v[24:27], v[88:91]
    v_mfma_f32_16x16x32_bf16 v[92:95], v[196:199], v[20:23], v[92:95]
    v_mfma_f32_16x16x32_bf16 v[96:99], v[196:199], v[24:27], v[96:99]
    s_add_u32 s84, s28, 82944
    buffer_load_dwordx4 v[160:163], v58, s[16:19], s84 offen
    s_add_u32 s84, s28, 82944
    buffer_load_dwordx4 v[164:167], v59, s[16:19], s84 offen
    ds_read_b128 v[8:11], v5 offset:6144
    ds_read_b128 v[12:15], v4 offset:12288
    ds_read_b128 v[16:19], v4 offset:12544
    ds_read_b128 v[20:23], v4 offset:12800
    ds_read_b128 v[24:27], v4 offset:13056
    s_waitcnt lgkmcnt(5)
    v_mfma_f32_16x16x32_bf16 v[72:75], v[200:203], v[28:31], v[72:75]
    v_mfma_f32_16x16x32_bf16 v[76:79], v[200:203], v[32:35], v[76:79]
    v_mfma_f32_16x16x32_bf16 v[80:83], v[200:203], v[36:39], v[80:83]
    v_mfma_f32_16x16x32_bf16 v[84:87], v[200:203], v[40:43], v[84:87]
    v_mfma_f32_16x16x32_bf16 v[88:91], v[200:203], v[44:47], v[88:91]
    v_mfma_f32_16x16x32_bf16 v[92:95], v[204:207], v[40:43], v[92:95]
    v_mfma_f32_16x16x32_bf16 v[96:99], v[204:207], v[44:47], v[96:99]
    s_add_u32 s84, s28, 96768
    buffer_load_dwordx4 v[168:171], v58, s[16:19], s84 offen
    s_add_u32 s84, s28, 96768
    buffer_load_dwordx4 v[172:175], v59, s[16:19], s84 offen
    ds_read_b128 v[28:31], v5 offset:6656
    ds_read_b128 v[32:35], v4 offset:16384
    ds_read_b128 v[36:39], v4 offset:16640
    ds_read_b128 v[40:43], v4 offset:16896
    ds_read_b128 v[44:47], v4 offset:17152
    s_waitcnt lgkmcnt(5)
    v_mfma_f32_16x16x32_bf16 v[72:75], v[208:211], v[8:11], v[72:75]
    v_mfma_f32_16x16x32_bf16 v[76:79], v[208:211], v[12:15], v[76:79]
    v_mfma_f32_16x16x32_bf16 v[80:83], v[208:211], v[16:19], v[80:83]
    v_mfma_f32_16x16x32_bf16 v[84:87], v[208:211], v[20:23], v[84:87]
    v_mfma_f32_16x16x32_bf16 v[88:91], v[208:211], v[24:27], v[88:91]
    v_mfma_f32_16x16x32_bf16 v[92:95], v[212:215], v[20:23], v[92:95]
    v_mfma_f32_16x16x32_bf16 v[96:99], v[212:215], v[24:27], v[96:99]
    s_add_u32 s84, s28, 110592
    buffer_load_dwordx4 v[176:179], v58, s[16:19], s84 offen
    s_add_u32 s84, s28, 110592
    buffer_load_dwordx4 v[180:183], v59, s[16:19], s84 offen
    s_waitcnt vmcnt(10)
    s_barrier
    ds_read_b128 v[8:11], v5 offset:7168
    ds_read_b128 v[12:15], v4 offset:20480
    ds_read_b128 v[16:19], v4 offset:20736
    ds_read_b128 v[20:23], v4 offset:20992
    ds_read_b128 v[24:27], v4 offset:21248
    s_waitcnt lgkmcnt(5)
    v_mfma_f32_16x16x32_bf16 v[72:75], v[216:219], v[28:31], v[72:75]
    v_mfma_f32_16x16x32_bf16 v[76:79], v[216:219], v[32:35], v[76:79]
    v_mfma_f32_16x16x32_bf16 v[80:83], v[216:219], v[36:39], v[80:83]
    v_mfma_f32_16x16x32_bf16 v[84:87], v[216:219], v[40:43], v[84:87]
    v_mfma_f32_16x16x32_bf16 v[88:91], v[216:219], v[44:47], v[88:91]
    v_mfma_f32_16x16x32_bf16 v[92:95], v[220:223], v[40:43], v[92:95]
    v_mfma_f32_16x16x32_bf16 v[96:99], v[220:223], v[44:47], v[96:99]
    s_add_u32 s84, s28, 124416
    buffer_load_dwordx4 v[184:187], v58, s[16:19], s84 offen
    s_add_u32 s84, s28, 124416
    buffer_load_dwordx4 v[188:191], v59, s[16:19], s84 offen
    ds_read_b128 v[28:31], v5 offset:7680
    ds_read_b128 v[32:35], v4 offset:24576
    ds_read_b128 v[36:39], v4 offset:24832
    ds_read_b128 v[40:43], v4 offset:25088
    ds_read_b128 v[44:47], v4 offset:25344
    s_waitcnt lgkmcnt(5)
    v_mfma_f32_16x16x32_bf16 v[72:75], v[224:227], v[8:11], v[72:75]
    v_mfma_f32_16x16x32_bf16 v[76:79], v[224:227], v[12:15], v[76:79]
    v_mfma_f32_16x16x32_bf16 v[80:83], v[224:227], v[16:19], v[80:83]
    v_mfma_f32_16x16x32_bf16 v[84:87], v[224:227], v[20:23], v[84:87]
    v_mfma_f32_16x16x32_bf16 v[88:91], v[224:227], v[24:27], v[88:91]
    v_mfma_f32_16x16x32_bf16 v[92:95], v[228:231], v[20:23], v[92:95]
    v_mfma_f32_16x16x32_bf16 v[96:99], v[228:231], v[24:27], v[96:99]
    s_add_u32 s84, s28, 138240
    buffer_load_dwordx4 v[192:195], v58, s[16:19], s84 offen
    s_add_u32 s84, s28, 138240
    buffer_load_dwordx4 v[196:199], v59, s[16:19], s84 offen
    ds_read_b128 v[8:11], v5 offset:8192
    ds_read_b128 v[12:15], v4 offset:28672
    ds_read_b128 v[16:19], v4 offset:28928
    ds_read_b128 v[20:23], v4 offset:29184
    ds_read_b128 v[24:27], v4 offset:29440
    s_waitcnt lgkmcnt(5)
    v_mfma_f32_16x16x32_bf16 v[72:75], v[232:235], v[28:31], v[72:75]
    v_mfma_f32_16x16x32_bf16 v[76:79], v[232:235], v[32:35], v[76:79]
    v_mfma_f32_16x16x32_bf16 v[80:83], v[232:235], v[36:39], v[80:83]
    v_mfma_f32_16x16x32_bf16 v[84:87], v[232:235], v[40:43], v[84:87]
    v_mfma_f32_16x16x32_bf16 v[88:91], v[232:235], v[44:47], v[88:91]
    v_mfma_f32_16x16x32_bf16 v[92:95], v[236:239], v[40:43], v[92:95]
    v_mfma_f32_16x16x32_bf16 v[96:99], v[236:239], v[44:47], v[96:99]
    s_add_u32 s84, s28, 152064
    buffer_load_dwordx4 v[200:203], v58, s[16:19], s84 offen
    s_add_u32 s84, s28, 152064
    buffer_load_dwordx4 v[204:207], v59, s[16:19], s84 offen
    ds_read_b128 v[28:31], v5 offset:8704
    ds_read_b128 v[32:35], v4 offset:32768
    ds_read_b128 v[36:39], v4 offset:33024
    ds_read_b128 v[40:43], v4 offset:33280
    ds_read_b128 v[44:47], v4 offset:33536
    s_waitcnt lgkmcnt(5)
    v_mfma_f32_16x16x32_bf16 v[72:75], v[240:243], v[8:11], v[72:75]
    v_and_b32 v2, 15, v0
    v_lshrrev_b32 v3, 4, v0
    v_lshlrev_b32 v224, 2, v2
    v_lshlrev_b32 v225, 4, v3
    v_lshlrev_b32 v6, 3, v0
    v_mfma_f32_16x16x32_bf16 v[76:79], v[240:243], v[12:15], v[76:79]
    s_mul_i32 s5, s30, 2560
    s_add_u32 s5, s5, 128000
    v_add_u32 v226, s5, v6
    s_mul_i32 s5, s31, 2560
    s_add_u32 s5, s5, 128000
    v_mfma_f32_16x16x32_bf16 v[80:83], v[240:243], v[16:19], v[80:83]
    v_add_u32 v227, s5, v6
    s_and_b32 s7, s3, 1
    s_mul_i32 s7, s7, 896
    s_add_u32 s7, s7, 640
    s_add_u32 s5, s7, 480
    v_mfma_f32_16x16x32_bf16 v[84:87], v[240:243], v[20:23], v[84:87]
    v_add_u32 v232, s5, v225
    v_lshrrev_b32 v233, 1, v3
    v_lshlrev_b32 v233, 8, v233
    s_add_u32 s5, s7, 256
    v_add3_u32 v233, v233, v225, s5
    v_mfma_f32_16x16x32_bf16 v[88:91], v[240:243], v[24:27], v[88:91]
    v_add_u32 v234, 129536, v6
    v_add_u32 v6, 256, v6
    v_and_b32 v6, 0x1ff, v6
    v_add_u32 v235, 139776, v6
    v_lshlrev_b32 v3, 2, v3
    v_mfma_f32_16x16x32_bf16 v[92:95], v[244:247], v[20:23], v[92:95]
    v_cmp_le_u32 s[80:81], v3, v2
    v_sub_u32 v6, v2, v3
    v_mov_b32 v2, 0xf149f2ca
    s_mov_b32 s5, 8
    v_add_u32 v3, 16, v6
    v_mfma_f32_16x16x32_bf16 v[96:99], v[244:247], v[24:27], v[96:99]
    v_cmp_gt_u32 s[76:77], s5, v3
    v_subrev_u32 v3, 0, v6
    v_cmp_gt_u32 s[78:79], 8, v3
    s_nop 0
    v_cndmask_b32 v228, v2, 0, s[76:77]
    s_waitcnt lgkmcnt(0)
    v_mfma_f32_16x16x32_bf16 v[72:75], v[248:251], v[28:31], v[72:75]
    v_cndmask_b32 v236, v2, 0, s[78:79]
    v_add_u32 v3, 15, v6
    v_cmp_gt_u32 s[76:77], s5, v3
    v_subrev_u32 v3, 1, v6
    v_cmp_gt_u32 s[78:79], 8, v3
    v_mfma_f32_16x16x32_bf16 v[76:79], v[248:251], v[32:35], v[76:79]
    s_nop 0
    v_cndmask_b32 v229, v2, 0, s[76:77]
    v_cndmask_b32 v237, v2, 0, s[78:79]
    v_add_u32 v3, 14, v6
    v_cmp_gt_u32 s[76:77], s5, v3
    v_mfma_f32_16x16x32_bf16 v[80:83], v[248:251], v[36:39], v[80:83]
    v_subrev_u32 v3, 2, v6
    v_cmp_gt_u32 s[78:79], 8, v3
    s_nop 0
    v_cndmask_b32 v230, v2, 0, s[76:77]
    v_cndmask_b32 v238, v2, 0, s[78:79]
    v_mfma_f32_16x16x32_bf16 v[84:87], v[248:251], v[40:43], v[84:87]
    v_add_u32 v3, 13, v6
    v_cmp_gt_u32 s[76:77], s5, v3
    v_subrev_u32 v3, 3, v6
    v_cmp_gt_u32 s[78:79], 8, v3
    s_nop 0
    v_mfma_f32_16x16x32_bf16 v[88:91], v[248:251], v[44:47], v[88:91]
    v_cndmask_b32 v231, v2, 0, s[76:77]
    v_cndmask_b32 v239, v2, 0, s[78:79]
    v_mfma_f32_16x16x32_bf16 v[92:95], v[252:255], v[40:43], v[92:95]
    v_mfma_f32_16x16x32_bf16 v[96:99], v[252:255], v[44:47], v[96:99]
    s_setprio 0
M_S7_epi:
    ds_read_b128 v[48:51], v232
    ds_read_b128 v[52:55], v233
    ds_read2_b32 v[8:9], v224 offset0:0 offset1:80
    ds_read2_b32 v[10:11], v224 offset0:16 offset1:96
    ds_read2_b32 v[12:13], v224 offset0:32 offset1:112
    ds_read2_b32 v[14:15], v224 offset0:48 offset1:128
    ds_read2_b32 v[16:17], v224 offset0:64 offset1:144
    s_waitcnt lgkmcnt(0)
    v_mul_f32 v72, v72, v8
    v_mul_f32 v73, v73, v8
    v_mul_f32 v74, v74, v8
    v_mul_f32 v75, v75, v8
    v_mul_f32 v76, v76, v10
    v_mul_f32 v77, v77, v10
    v_mul_f32 v78, v78, v10
    v_mul_f32 v79, v79, v10
    v_mul_f32 v80, v80, v12
    v_mul_f32 v81, v81, v12
    v_mul_f32 v82, v82, v12
    v_mul_f32 v83, v83, v12
    v_mul_f32 v84, v84, v14
    v_mul_f32 v85, v85, v14
    v_mul_f32 v86, v86, v14
    v_mul_f32 v87, v87, v14
    v_mul_f32 v88, v88, v16
    v_mul_f32 v89, v89, v16
    v_mul_f32 v90, v90, v16
    v_mul_f32 v91, v91, v16
    v_fma_f32 v72, -v9, v48, v72
    v_fma_f32 v73, -v9, v49, v73
    v_fma_f32 v74, -v9, v50, v74
    v_fma_f32 v75, -v9, v51, v75
    v_fma_f32 v76, -v11, v48, v76
    v_fma_f32 v77, -v11, v49, v77
    v_fma_f32 v78, -v11, v50, v78
    v_fma_f32 v79, -v11, v51, v79
    v_fma_f32 v80, -v13, v48, v80
    v_fma_f32 v81, -v13, v49, v81
    v_fma_f32 v82, -v13, v50, v82
    v_fma_f32 v83, -v13, v51, v83
    v_fma_f32 v84, -v15, v48, v84
    v_fma_f32 v85, -v15, v49, v85
    v_fma_f32 v86, -v15, v50, v86
    v_fma_f32 v87, -v15, v51, v87
    v_fma_f32 v88, -v17, v48, v88
    v_fma_f32 v89, -v17, v49, v89
    v_fma_f32 v90, -v17, v50, v90
    v_fma_f32 v91, -v17, v51, v91
    v_cvt_pk_bf16_f32 v72, v72, v73
    v_cvt_pk_bf16_f32 v73, v74, v75
    ds_write_b64 v226, v[72:73] offset:0
    v_cvt_pk_bf16_f32 v76, v76, v77
    v_cvt_pk_bf16_f32 v77, v78, v79
    ds_write_b64 v226, v[76:77] offset:512
    v_cvt_pk_bf16_f32 v80, v80, v81
    v_cvt_pk_bf16_f32 v81, v82, v83
    ds_write_b64 v226, v[80:81] offset:1024
    v_cvt_pk_bf16_f32 v84, v84, v85
    v_cvt_pk_bf16_f32 v85, v86, v87
    ds_write_b64 v226, v[84:85] offset:1536
    v_cvt_pk_bf16_f32 v88, v88, v89
    v_cvt_pk_bf16_f32 v89, v90, v91
    ds_write_b64 v226, v[88:89] offset:2048
    v_mul_f32 v92, v92, v14
    v_mul_f32 v93, v93, v14
    v_mul_f32 v94, v94, v14
    v_mul_f32 v95, v95, v14
    v_mul_f32 v96, v96, v16
    v_mul_f32 v97, v97, v16
    v_mul_f32 v98, v98, v16
    v_mul_f32 v99, v99, v16
    v_fma_f32 v92, -v15, v52, v92
    v_fma_f32 v93, -v15, v53, v93
    v_fma_f32 v94, -v15, v54, v94
    v_fma_f32 v95, -v15, v55, v95
    v_fma_f32 v96, -v17, v52, v96
    v_fma_f32 v97, -v17, v53, v97
    v_fma_f32 v98, -v17, v54, v98
    v_fma_f32 v99, -v17, v55, v99
    v_cvt_pk_bf16_f32 v92, v92, v93
    v_cvt_pk_bf16_f32 v93, v94, v95
    ds_write_b64 v227, v[92:93] offset:1536
    v_cvt_pk_bf16_f32 v96, v96, v97
    v_cvt_pk_bf16_f32 v97, v98, v99
    ds_write_b64 v227, v[96:97] offset:2048
    s_branch M_att
M_att:
    s_mov_b32 s58, 0x3eae1a93
    s_mov_b32 s59, 0x3eae1a93
    s_mov_b32 s60, 0xffff0000
    s_mov_b32 s61, -1
    s_mov_b32 s62, 0
    s_mov_b32 s63, -1
    s_waitcnt lgkmcnt(0)
    s_barrier
    ds_read_b64 v[8:9], v234 offset:512
    ds_read_b64 v[10:11], v234 offset:3072
    ds_read_b64 v[12:13], v234 offset:5632
    ds_read_b64 v[14:15], v234 offset:8192
    ds_read_b64 v[16:17], v234 offset:10752
    ds_read_b64 v[18:19], v234 offset:12800
    ds_read_b64 v[28:29], v234 offset:13312
    ds_read_b64 v[20:21], v234 offset:15360
    ds_read_b64 v[30:31], v234 offset:15872
    ds_read_b64 v[22:23], v234 offset:17920
    ds_read_b64 v[32:33], v234 offset:18432
    ds_read_b64 v[24:25], v234 offset:20480
    ds_read_b64 v[34:35], v234 offset:20992
    ds_read_b64 v[26:27], v235
    ds_read_b64 v[36:37], v235 offset:512
    s_waitcnt lgkmcnt(10)
    v_mov_b32 v72, v8
    v_mov_b32 v73, v9
    v_cndmask_b32 v74, v10, 0, s[60:61]
    v_mov_b32 v75, 0
    v_cndmask_b32 v76, 0, v10, s[60:61]
    v_mov_b32 v77, v11
    v_cndmask_b32 v78, v12, 0, s[60:61]
    v_cndmask_b32 v79, v13, 0, s[60:61]
    v_cndmask_b32 v80, 0, v12, s[60:61]
    v_cndmask_b32 v81, 0, v13, s[60:61]
    v_cndmask_b32 v82, v14, 0, s[62:63]
    v_cndmask_b32 v83, v15, 0, s[60:61]
    v_cndmask_b32 v84, 0, v14, s[62:63]
    v_cndmask_b32 v85, 0, v15, s[60:61]
    v_cndmask_b32 v86, v16, 0, s[62:63]
    v_cndmask_b32 v87, v17, 0, s[62:63]
    s_waitcnt lgkmcnt(0)
    s_nop 0
    v_mfma_f32_16x16x32_bf16 v[88:91], v[18:21], v[72:75], v[228:231]
    v_mfma_f32_16x16x32_bf16 v[92:95], v[28:31], v[72:75], v[236:239]
    v_mfma_f32_16x16x32_bf16 v[96:99], v[20:23], v[76:79], v[228:231]
    v_mfma_f32_16x16x32_bf16 v[100:103], v[30:33], v[76:79], v[236:239]
    v_mfma_f32_16x16x32_bf16 v[104:107], v[22:25], v[80:83], v[228:231]
    v_mfma_f32_16x16x32_bf16 v[108:111], v[32:35], v[80:83], v[236:239]
    v_mfma_f32_16x16x32_bf16 v[40:43], v[24:27], v[84:87], v[228:231]
    v_mfma_f32_16x16x32_bf16 v[44:47], v[34:37], v[84:87], v[236:239]
    s_add_u32 s84, s28, 165888
    buffer_load_dwordx4 v[208:211], v58, s[16:19], s84 offen
    s_add_u32 s84, s28, 165888
    buffer_load_dwordx4 v[212:215], v59, s[16:19], s84 offen
    s_nop 3
    v_max_f32 v88, v88, v92
    v_max_f32 v96, v96, v100
    v_max_f32 v104, v104, v108
    v_max_f32 v40, v40, v44
    v_max_f32 v89, v89, v93
    v_max_f32 v97, v97, v101
    v_max_f32 v105, v105, v109
    v_max_f32 v41, v41, v45
    v_max_f32 v90, v90, v94
    v_max_f32 v98, v98, v102
    v_max_f32 v106, v106, v110
    v_max_f32 v42, v42, v46
    v_max_f32 v91, v91, v95
    v_max_f32 v99, v99, v103
    v_max_f32 v107, v107, v111
    v_max_f32 v43, v43, v47
    v_max3_f32 v48, v88, v89, v90
    v_max3_f32 v50, v96, v97, v98
    v_max3_f32 v52, v104, v105, v106
    v_max3_f32 v54, v40, v41, v42
    v_max_f32 v48, v48, v91
    v_max_f32 v50, v50, v99
    v_max_f32 v52, v52, v107
    v_max_f32 v54, v54, v43
    v_mov_b32 v49, v48
    v_mov_b32 v51, v50
    v_mov_b32 v53, v52
    v_mov_b32 v55, v54
    v_permlane32_swap_b32 v48, v49
    v_permlane32_swap_b32 v50, v51
    v_permlane32_swap_b32 v52, v53
    v_permlane32_swap_b32 v54, v55
    v_max_f32 v48, v48, v49
    v_max_f32 v50, v50, v51
    v_max_f32 v52, v52, v53
    v_max_f32 v54, v54, v55
    v_mov_b32 v49, v48
    v_mov_b32 v51, v50
    v_mov_b32 v53, v52
    v_mov_b32 v55, v54
    v_permlane16_swap_b32 v48, v49
    v_permlane16_swap_b32 v50, v51
    v_permlane16_swap_b32 v52, v53
    v_permlane16_swap_b32 v54, v55
    v_max_f32 v48, v48, v49
    v_max_f32 v50, v50, v51
    v_max_f32 v52, v52, v53
    v_max_f32 v54, v54, v55
    v_mul_f32 v48, s58, v48
    v_mul_f32 v50, s58, v50
    v_mul_f32 v52, s58, v52
    v_mul_f32 v54, s58, v54
    v_fma_f32 v88, v88, s58, -v48
    v_fma_f32 v96, v96, s58, -v50
    v_fma_f32 v104, v104, s58, -v52
    v_fma_f32 v40, v40, s58, -v54
    v_fma_f32 v89, v89, s58, -v48
    v_fma_f32 v97, v97, s58, -v50
    v_fma_f32 v105, v105, s58, -v52
    v_fma_f32 v41, v41, s58, -v54
    v_fma_f32 v90, v90, s58, -v48
    v_fma_f32 v98, v98, s58, -v50
    v_fma_f32 v106, v106, s58, -v52
    v_fma_f32 v42, v42, s58, -v54
    v_fma_f32 v91, v91, s58, -v48
    v_fma_f32 v99, v99, s58, -v50
    v_fma_f32 v107, v107, s58, -v52
    v_fma_f32 v43, v43, s58, -v54
    v_exp_f32 v88, v88
    v_exp_f32 v96, v96
    v_exp_f32 v104, v104
    v_exp_f32 v40, v40
    v_exp_f32 v89, v89
    v_exp_f32 v97, v97
    v_exp_f32 v105, v105
    v_exp_f32 v41, v41
    v_exp_f32 v90, v90
    v_exp_f32 v98, v98
    v_exp_f32 v106, v106
    v_exp_f32 v42, v42
    v_exp_f32 v91, v91
    v_exp_f32 v99, v99
    v_exp_f32 v107, v107
    v_exp_f32 v43, v43
    v_add_f32 v92, v88, v89
    v_add_f32 v100, v96, v97
    v_add_f32 v108, v104, v105
    v_add_f32 v44, v40, v41
    v_add_f32 v93, v90, v91
    v_add_f32 v101, v98, v99
    v_add_f32 v109, v106, v107
    v_add_f32 v45, v42, v43
    v_add_f32 v48, v92, v93
    v_add_f32 v50, v100, v101
    v_add_f32 v52, v108, v109
    v_add_f32 v54, v44, v45
    v_mov_b32 v49, v48
    v_mov_b32 v51, v50
    v_mov_b32 v53, v52
    v_mov_b32 v55, v54
    v_permlane32_swap_b32 v48, v49
    v_permlane32_swap_b32 v50, v51
    v_permlane32_swap_b32 v52, v53
    v_permlane32_swap_b32 v54, v55
    v_add_f32 v48, v48, v49
    v_add_f32 v50, v50, v51
    v_add_f32 v52, v52, v53
    v_add_f32 v54, v54, v55
    v_mov_b32 v49, v48
    v_mov_b32 v51, v50
    v_mov_b32 v53, v52
    v_mov_b32 v55, v54
    v_permlane16_swap_b32 v48, v49
    v_permlane16_swap_b32 v50, v51
    v_permlane16_swap_b32 v52, v53
    v_permlane16_swap_b32 v54, v55
    v_add_f32 v48, v48, v49
    v_add_f32 v50, v50, v51
    v_add_f32 v52, v52, v53
    v_add_f32 v54, v54, v55
    v_rcp_f32 v48, v48
    v_rcp_f32 v50, v50
    v_rcp_f32 v52, v52
    v_rcp_f32 v54, v54
    v_mul_f32 v88, v88, v48
    v_mul_f32 v96, v96, v50
    v_mul_f32 v104, v104, v52
    v_mul_f32 v40, v40, v54
    v_mul_f32 v89, v89, v48
    v_mul_f32 v97, v97, v50
    v_mul_f32 v105, v105, v52
    v_mul_f32 v41, v41, v54
    v_mul_f32 v90, v90, v48
    v_mul_f32 v98, v98, v50
    v_mul_f32 v106, v106, v52
    v_mul_f32 v42, v42, v54
    v_mul_f32 v91, v91, v48
    v_mul_f32 v99, v99, v50
    v_mul_f32 v107, v107, v52
    v_mul_f32 v43, v43, v54
    v_cvt_pk_bf16_f32 v92, v88, v89
    v_cvt_pk_bf16_f32 v100, v96, v97
    v_cvt_pk_bf16_f32 v108, v104, v105
    v_cvt_pk_bf16_f32 v44, v40, v41
    v_cvt_pk_bf16_f32 v93, v90, v91
    v_cvt_pk_bf16_f32 v101, v98, v99
    v_cvt_pk_bf16_f32 v109, v106, v107
    v_cvt_pk_bf16_f32 v45, v42, v43
    v_cndmask_b32 v72, v92, 0, s[80:81]
    v_cndmask_b32 v76, v100, 0, s[80:81]
    v_cndmask_b32 v80, v108, 0, s[80:81]
    v_cndmask_b32 v84, v44, 0, s[80:81]
    v_cndmask_b32 v73, v93, 0, s[80:81]
    v_cndmask_b32 v77, v101, 0, s[80:81]
    v_cndmask_b32 v81, v109, 0, s[80:81]
    v_cndmask_b32 v85, v45, 0, s[80:81]
    v_cndmask_b32 v74, 0, v92, s[80:81]
    v_cndmask_b32 v78, 0, v100, s[80:81]
    v_cndmask_b32 v82, 0, v108, s[80:81]
    v_cndmask_b32 v86, 0, v44, s[80:81]
    v_cndmask_b32 v75, 0, v93, s[80:81]
    v_cndmask_b32 v79, 0, v101, s[80:81]
    v_cndmask_b32 v83, 0, v109, s[80:81]
    v_cndmask_b32 v87, 0, v45, s[80:81]
    s_add_u32 s84, s28, 179712
    buffer_load_dwordx4 v[216:219], v58, s[16:19], s84 offen
    s_add_u32 s84, s28, 179712
    buffer_load_dwordx4 v[220:223], v59, s[16:19], s84 offen
    s_mul_i32 s83, s3, 2621440
    s_add_u32 s83, s83, 10479616
    s_add_u32 s83, s83, s24
    s_mul_i32 s5, s20, 9216
    s_add_u32 s83, s83, s5
    s_barrier
    ds_read_b64 v[8:9], v234 offset:23040
    ds_read_b64 v[10:11], v234 offset:23552
    ds_read_b64 v[12:13], v234 offset:25600
    ds_read_b64 v[14:15], v234 offset:26112
    ds_read_b64 v[16:17], v234 offset:28160
    ds_read_b64 v[18:19], v234 offset:28672
    ds_read_b64 v[20:21], v234 offset:30720
    ds_read_b64 v[22:23], v234 offset:31232
    ds_read_b64 v[24:25], v234 offset:33280
    ds_read_b64 v[26:27], v234 offset:33792
    s_waitcnt lgkmcnt(6)
    v_mfma_f32_16x16x32_bf16 v[88:91], v[8:11], v[72:75], 0
    v_mfma_f32_16x16x32_bf16 v[92:95], v[12:15], v[72:75], 0
    s_waitcnt lgkmcnt(4)
    v_mfma_f32_16x16x32_bf16 v[96:99], v[12:15], v[76:79], 0
    v_mfma_f32_16x16x32_bf16 v[100:103], v[16:19], v[76:79], 0
    s_waitcnt lgkmcnt(2)
    v_mfma_f32_16x16x32_bf16 v[104:107], v[16:19], v[80:83], 0
    v_mfma_f32_16x16x32_bf16 v[108:111], v[20:23], v[80:83], 0
    s_waitcnt lgkmcnt(0)
    v_mfma_f32_16x16x32_bf16 v[40:43], v[20:23], v[84:87], 0
    v_mfma_f32_16x16x32_bf16 v[44:47], v[24:27], v[84:87], 0
    s_nop 3
    v_cvt_pk_bf16_f32 v88, v88, v89
    v_cvt_pk_bf16_f32 v89, v90, v91
    v_cvt_pk_bf16_f32 v92, v92, v93
    v_cvt_pk_bf16_f32 v93, v94, v95
    buffer_store_dwordx2 v[88:89], v67, s[12:15], s83 offen sc1
    s_add_u32 s83, s83, 2048
    v_cvt_pk_bf16_f32 v96, v96, v97
    v_cvt_pk_bf16_f32 v97, v98, v99
    v_cvt_pk_bf16_f32 v100, v100, v101
    v_cvt_pk_bf16_f32 v101, v102, v103
    v_cndmask_b32 v96, v92, v96, s[60:61]
    buffer_store_dwordx2 v[96:97], v67, s[12:15], s83 offen sc1
    s_add_u32 s83, s83, 2048
    v_cvt_pk_bf16_f32 v104, v104, v105
    v_cvt_pk_bf16_f32 v105, v106, v107
    v_cvt_pk_bf16_f32 v108, v108, v109
    v_cvt_pk_bf16_f32 v109, v110, v111
    v_cndmask_b32 v104, v100, v104, s[60:61]
    v_cndmask_b32 v105, v101, v105, s[60:61]
    buffer_store_dwordx2 v[104:105], v67, s[12:15], s83 offen sc1
    s_add_u32 s83, s83, 2048
    v_cvt_pk_bf16_f32 v40, v40, v41
    v_cvt_pk_bf16_f32 v41, v42, v43
    v_cvt_pk_bf16_f32 v44, v44, v45
    v_cvt_pk_bf16_f32 v45, v46, v47
    v_cndmask_b32 v40, v108, v40, s[62:63]
    v_cndmask_b32 v41, v109, v41, s[60:61]
    buffer_store_dwordx2 v[40:41], v67, s[12:15], s83 offen sc1
    s_add_u32 s83, s83, 2048
    s_mov_b64 exec, 0xffffffff
    buffer_store_dwordx2 v[44:45], v67, s[12:15], s83 offen sc1
    s_mov_b64 exec, -1
    s_setprio 0
M_mid:
    s_mul_i32 s88, s3, 2621440
    s_add_u32 s88, s88, 10485760
    s_add_u32 s88, s88, s24
    s_lshl_b32 s90, s3, 13
    s_lshl_b32 s5, s21, 7
    s_add_u32 s90, s90, s5
    s_add_u32 s90, s90, 28442624
    s_and_b32 s5, s4, 1
    s_lshl_b32 s6, s5, 12
    s_and_b32 s7, s4, 2
    s_lshl_b32 s7, s7, 8
    s_add_u32 s6, s6, s7
    v_add_u32 v108, s6, v1
    v_add_u32 v109, 32768, v108
    s_mul_i32 s5, s5, 4608
    s_lshr_b32 s6, s4, 2
    s_mul_i32 s6, s6, 3072
    s_add_u32 s6, s6, s5
    s_add_u32 s6, s6, 80896
    v_add_u32 v7, s6, v70
    v_add_u32 v110, 36864, v7
    v_lshrrev_b32 v71, 4, v0
    v_and_b32 v69, 7, v0
    v_lshl_add_u32 v69, v71, 3, v69
    v_lshlrev_b32 v69, 4, v69
    s_add_u32 s5, s5, 84992
    v_add_u32 v69, s5, v69
    v_add_u32 v111, 36864, v69
    s_lshl_b32 s5, s4, 10
    s_add_u32 s88, s88, s5
    s_mul_i32 s5, s4, 3072
    s_add_u32 s5, s5, 3072
    v_add_u32 v56, s5, v70
    s_xor_b32 s6, s4, 1
    s_mul_i32 s6, s6, 3072
    s_add_u32 s6, s6, 3072
    v_add_u32 v71, s6, v70
    s_mov_b32 s91, s90
    s_waitcnt vmcnt(0)
    s_barrier
    s_cmp_lg_u32 s4, 7
    s_cbranch_scc1 M_sigA_ns
    s_lshl_b32 s5, s20, 2
    s_mov_b64 exec, 1
    v_mov_b32 v2, s5
    v_mov_b32 v3, s101
    buffer_store_dword v3, v2, s[12:15], s91 offen sc1
    s_mov_b64 exec, -1
M_sigA_ns:
    s_cmp_eq_u32 s4, 7
    s_cbranch_scc1 M_nolate
    s_mov_b32 s82, s87
    s_lshl_b32 s87, s4, 10
    s_add_u32 s6, s87, 41984
    s_cmp_lt_u32 s87, 5120
    s_cselect_b32 s6, s87, s6
    s_min_u32 s6, s6, 81920
    s_add_u32 m0, s6, 80896
    s_add_u32 s7, s6, s89
    buffer_load_dwordx4 v70, s[12:15], s7 offen lds
    s_add_u32 s87, s87, 7168
    s_add_u32 s6, s87, 41984
    s_cmp_lt_u32 s87, 5120
    s_cselect_b32 s6, s87, s6
    s_min_u32 s6, s6, 81920
    s_add_u32 m0, s6, 80896
    s_add_u32 s7, s6, s89
    buffer_load_dwordx4 v70, s[12:15], s7 offen lds
    s_add_u32 s87, s87, 7168
    s_add_u32 s6, s87, 41984
    s_cmp_lt_u32 s87, 5120
    s_cselect_b32 s6, s87, s6
    s_min_u32 s6, s6, 81920
    s_add_u32 m0, s6, 80896
    s_add_u32 s7, s6, s89
    buffer_load_dwordx4 v70, s[12:15], s7 offen lds
    s_add_u32 s87, s87, 7168
    s_add_u32 s6, s87, 41984
    s_cmp_lt_u32 s87, 5120
    s_cselect_b32 s6, s87, s6
    s_min_u32 s6, s6, 81920
    s_add_u32 m0, s6, 80896
    s_add_u32 s7, s6, s89
    buffer_load_dwordx4 v70, s[12:15], s7 offen lds
    s_add_u32 s87, s87, 7168
    s_add_u32 s6, s87, 41984
    s_cmp_lt_u32 s87, 5120
    s_cselect_b32 s6, s87, s6
    s_min_u32 s6, s6, 81920
    s_add_u32 m0, s6, 80896
    s_add_u32 s7, s6, s89
    buffer_load_dwordx4 v70, s[12:15], s7 offen lds
    s_add_u32 s87, s87, 7168
    s_add_u32 s6, s87, 41984
    s_cmp_lt_u32 s87, 5120
    s_cselect_b32 s6, s87, s6
    s_min_u32 s6, s6, 81920
    s_add_u32 m0, s6, 80896
    s_add_u32 s7, s6, s89
    buffer_load_dwordx4 v70, s[12:15], s7 offen lds
    s_add_u32 s87, s87, 7168
M_nolate:
    v_mov_b32 v72, 0
    v_mov_b32 v73, 0
    v_mov_b32 v74, 0
    v_mov_b32 v75, 0
    v_mov_b32 v76, 0
    v_mov_b32 v77, 0
    v_mov_b32 v78, 0
    v_mov_b32 v79, 0
    v_mov_b32 v80, 0
    v_mov_b32 v81, 0
    v_mov_b32 v82, 0
    v_mov_b32 v83, 0
    v_mov_b32 v84, 0
    v_mov_b32 v85, 0
    v_mov_b32 v86, 0
    v_mov_b32 v87, 0
    v_mov_b32 v88, 0
    v_mov_b32 v89, 0
    v_mov_b32 v90, 0
    v_mov_b32 v91, 0
    v_mov_b32 v92, 0
    v_mov_b32 v93, 0
    v_mov_b32 v94, 0
    v_mov_b32 v95, 0
    s_cmp_lg_u32 s4, 7
    s_cbranch_scc1 M_pollA_done
    v_and_b32 v2, 7, v0
    v_lshlrev_b32 v2, 2, v2
    s_mov_b64 exec, 0xff
    s_mov_b32 s5, 0x20000
    buffer_load_dword v8, v2, s[12:15], s91 offen sc1
    s_sleep 2
    buffer_load_dword v9, v2, s[12:15], s91 offen sc1
    s_sleep 2
M_pollA_loop:
    buffer_load_dword v10, v2, s[12:15], s91 offen sc1
    s_waitcnt vmcnt(2)
    v_cmp_eq_u32 vcc, s101, v8
    s_nop 1
    s_cmp_eq_u64 vcc, exec
    s_cbranch_scc1 M_pollA_ok
    buffer_load_dword v8, v2, s[12:15], s91 offen sc1
    s_waitcnt vmcnt(2)
    v_cmp_eq_u32 vcc, s101, v9
    s_nop 1
    s_cmp_eq_u64 vcc, exec
    s_cbranch_scc1 M_pollA_ok
    buffer_load_dword v9, v2, s[12:15], s91 offen sc1
    s_waitcnt vmcnt(2)
    v_cmp_eq_u32 vcc, s101, v10
    s_nop 1
    s_cmp_eq_u64 vcc, exec
    s_cbranch_scc1 M_pollA_ok
    s_sub_u32 s5, s5, 1
    s_cmp_lg_u32 s5, 0
    s_cbranch_scc1 M_pollA_loop
M_pollA_ok:
    s_mov_b64 exec, -1
M_pollA_done:
    s_barrier
    s_setprio 3
    s_add_u32 m0, s26, 0
    s_nop 0
    buffer_load_dwordx4 v70, s[12:15], s88 offen sc1 lds
    s_add_u32 s88, s88, 8192
    s_setprio 2
    s_add_u32 m0, s26, 8192
    s_nop 0
    buffer_load_dwordx4 v70, s[12:15], s88 offen sc1 lds
    s_add_u32 s88, s88, 8192
    s_setprio 1
    s_add_u32 m0, s26, 16384
    s_nop 0
    buffer_load_dwordx4 v70, s[12:15], s88 offen sc1 lds
    s_add_u32 s88, s88, 8192
    s_setprio 0
    s_add_u32 m0, s26, 24576
    s_nop 0
    buffer_load_dwordx4 v70, s[12:15], s88 offen sc1 lds
    s_add_u32 s88, s88, 8192
    s_setprio 0
    s_add_u32 m0, s26, 32768
    s_nop 0
    buffer_load_dwordx4 v70, s[12:15], s88 offen sc1 lds
    s_add_u32 s88, s88, 8192
    s_cmp_ge_u32 s4, 4
    s_cbranch_scc1 M_Bh1
M_Bh0:
    s_waitcnt vmcnt(4)
    s_barrier
    ds_read_b128 v[8:11], v108 offset:0
    ds_read_b128 v[12:15], v108 offset:256
    ds_read_b128 v[16:19], v7 offset:0
    ds_read_b128 v[20:23], v7 offset:1024
    ds_read_b128 v[24:27], v7 offset:2048
    s_add_u32 m0, s26, 40960
    s_nop 0
    buffer_load_dwordx4 v70, s[12:15], s88 offen sc1 lds
    s_add_u32 s88, s88, 8192
    s_add_u32 m0, s26, 49152
    s_nop 0
    buffer_load_dwordx4 v70, s[12:15], s88 offen sc1 lds
    s_add_u32 s88, s88, 8192
    s_waitcnt lgkmcnt(0)
    v_mfma_f32_16x16x32_bf16 v[72:75], v[16:19], v[8:11], v[72:75]
    v_mfma_f32_16x16x32_bf16 v[84:87], v[16:19], v[12:15], v[84:87]
    v_mfma_f32_16x16x32_bf16 v[76:79], v[20:23], v[8:11], v[76:79]
    v_mfma_f32_16x16x32_bf16 v[88:91], v[20:23], v[12:15], v[88:91]
    v_mfma_f32_16x16x32_bf16 v[80:83], v[24:27], v[8:11], v[80:83]
    v_mfma_f32_16x16x32_bf16 v[92:95], v[24:27], v[12:15], v[92:95]
    s_waitcnt vmcnt(5)
    s_barrier
    ds_read_b128 v[28:31], v108 offset:8192
    ds_read_b128 v[32:35], v108 offset:8448
    ds_read_b128 v[36:39], v7 offset:9216
    ds_read_b128 v[40:43], v7 offset:10240
    ds_read_b128 v[44:47], v7 offset:11264
    s_add_u32 m0, s26, 57344
    s_nop 0
    buffer_load_dwordx4 v70, s[12:15], s88 offen sc1 lds
    s_add_u32 s88, s88, 8192
    s_add_u32 m0, s26, 65536
    s_nop 0
    buffer_load_dwordx4 v70, s[12:15], s88 offen sc1 lds
    s_add_u32 s88, s88, 8192
    s_waitcnt lgkmcnt(0)
    v_mfma_f32_16x16x32_bf16 v[72:75], v[36:39], v[28:31], v[72:75]
    v_mfma_f32_16x16x32_bf16 v[84:87], v[36:39], v[32:35], v[84:87]
    v_mfma_f32_16x16x32_bf16 v[76:79], v[40:43], v[28:31], v[76:79]
    v_mfma_f32_16x16x32_bf16 v[88:91], v[40:43], v[32:35], v[88:91]
    v_mfma_f32_16x16x32_bf16 v[80:83], v[44:47], v[28:31], v[80:83]
    v_mfma_f32_16x16x32_bf16 v[92:95], v[44:47], v[32:35], v[92:95]
    s_waitcnt vmcnt(5)
    s_barrier
    ds_read_b128 v[8:11], v108 offset:16384
    ds_read_b128 v[12:15], v108 offset:16640
    ds_read_b128 v[16:19], v7 offset:18432
    ds_read_b128 v[20:23], v7 offset:19456
    ds_read_b128 v[24:27], v7 offset:20480
    ds_read_b128 v[28:31], v108 offset:24576
    ds_read_b128 v[32:35], v108 offset:24832
    ds_read_b128 v[36:39], v7 offset:27648
    ds_read_b128 v[40:43], v7 offset:28672
    ds_read_b128 v[44:47], v7 offset:29696
    s_waitcnt lgkmcnt(5)
    v_mfma_f32_16x16x32_bf16 v[72:75], v[16:19], v[8:11], v[72:75]
    v_mfma_f32_16x16x32_bf16 v[84:87], v[16:19], v[12:15], v[84:87]
    v_mfma_f32_16x16x32_bf16 v[76:79], v[20:23], v[8:11], v[76:79]
    v_mfma_f32_16x16x32_bf16 v[88:91], v[20:23], v[12:15], v[88:91]
    v_mfma_f32_16x16x32_bf16 v[80:83], v[24:27], v[8:11], v[80:83]
    v_mfma_f32_16x16x32_bf16 v[92:95], v[24:27], v[12:15], v[92:95]
    s_waitcnt lgkmcnt(0)
    v_mfma_f32_16x16x32_bf16 v[72:75], v[36:39], v[28:31], v[72:75]
    v_mfma_f32_16x16x32_bf16 v[84:87], v[36:39], v[32:35], v[84:87]
    v_mfma_f32_16x16x32_bf16 v[76:79], v[40:43], v[28:31], v[76:79]
    v_mfma_f32_16x16x32_bf16 v[88:91], v[40:43], v[32:35], v[88:91]
    v_mfma_f32_16x16x32_bf16 v[80:83], v[44:47], v[28:31], v[80:83]
    v_mfma_f32_16x16x32_bf16 v[92:95], v[44:47], v[32:35], v[92:95]
    s_waitcnt vmcnt(3)
    s_barrier
    ds_read_b128 v[8:11], v109 offset:0
    ds_read_b128 v[12:15], v109 offset:256
    ds_read_b128 v[16:19], v110 offset:0
    ds_read_b128 v[20:23], v110 offset:1024
    ds_read_b128 v[24:27], v110 offset:2048
    s_cmp_lg_u32 s3, 0
    s_cbranch_scc1 M_g20_3
    s_add_u32 s84, s28, 0
    buffer_load_dwordx4 v[112:115], v58, s[16:19], s84 offen
    s_add_u32 s84, s28, 13824
    buffer_load_dwordx4 v[120:123], v58, s[16:19], s84 offen
M_g20_3:
    ds_read_b128 v[28:31], v109 offset:8192
    ds_read_b128 v[32:35], v109 offset:8448
    ds_read_b128 v[36:39], v110 offset:9216
    ds_read_b128 v[40:43], v110 offset:10240
    ds_read_b128 v[44:47], v110 offset:11264
    s_waitcnt lgkmcnt(5)
    v_mfma_f32_16x16x32_bf16 v[72:75], v[16:19], v[8:11], v[72:75]
    v_mfma_f32_16x16x32_bf16 v[84:87], v[16:19], v[12:15], v[84:87]
    v_mfma_f32_16x16x32_bf16 v[76:79], v[20:23], v[8:11], v[76:79]
    v_mfma_f32_16x16x32_bf16 v[88:91], v[20:23], v[12:15], v[88:91]
    v_mfma_f32_16x16x32_bf16 v[80:83], v[24:27], v[8:11], v[80:83]
    v_mfma_f32_16x16x32_bf16 v[92:95], v[24:27], v[12:15], v[92:95]
    s_cmp_lg_u32 s3, 0
    s_cbranch_scc1 M_g20_4
    s_add_u32 s84, s28, 27648
    buffer_load_dwordx4 v[128:131], v58, s[16:19], s84 offen
    s_add_u32 s84, s28, 41472
    buffer_load_dwordx4 v[136:139], v58, s[16:19], s84 offen
M_g20_4:
    s_add_u32 s84, s28, 235008
    buffer_load_dwordx4 v[252:255], v59, s[16:19], s84 offen
    s_waitcnt lgkmcnt(0)
    v_mfma_f32_16x16x32_bf16 v[72:75], v[36:39], v[28:31], v[72:75]
    v_mfma_f32_16x16x32_bf16 v[84:87], v[36:39], v[32:35], v[84:87]
    v_mfma_f32_16x16x32_bf16 v[76:79], v[40:43], v[28:31], v[76:79]
    v_mfma_f32_16x16x32_bf16 v[88:91], v[40:43], v[32:35], v[88:91]
    v_mfma_f32_16x16x32_bf16 v[80:83], v[44:47], v[28:31], v[80:83]
    v_mfma_f32_16x16x32_bf16 v[92:95], v[44:47], v[32:35], v[92:95]
    s_waitcnt vmcnt(1)
    s_barrier
    ds_read_b128 v[8:11], v109 offset:16384
    ds_read_b128 v[12:15], v109 offset:16640
    ds_read_b128 v[16:19], v110 offset:18432
    ds_read_b128 v[20:23], v110 offset:19456
    ds_read_b128 v[24:27], v110 offset:20480
    s_cmp_lg_u32 s3, 0
    s_cbranch_scc1 M_g20_5
    s_add_u32 s84, s28, 55296
    buffer_load_dwordx4 v[144:147], v58, s[16:19], s84 offen
    s_add_u32 s84, s28, 69120
    buffer_load_dwordx4 v[152:155], v58, s[16:19], s84 offen
M_g20_5:
    s_add_u32 s84, s28, 193536
    buffer_load_dwordx4 v[224:227], v58, s[16:19], s84 offen
    ds_read_b128 v[28:31], v109 offset:24576
    ds_read_b128 v[32:35], v109 offset:24832
    ds_read_b128 v[36:39], v110 offset:27648
    ds_read_b128 v[40:43], v110 offset:28672
    ds_read_b128 v[44:47], v110 offset:29696
    s_waitcnt lgkmcnt(5)
    v_mfma_f32_16x16x32_bf16 v[72:75], v[16:19], v[8:11], v[72:75]
    v_mfma_f32_16x16x32_bf16 v[84:87], v[16:19], v[12:15], v[84:87]
    v_mfma_f32_16x16x32_bf16 v[76:79], v[20:23], v[8:11], v[76:79]
    v_mfma_f32_16x16x32_bf16 v[88:91], v[20:23], v[12:15], v[88:91]
    v_mfma_f32_16x16x32_bf16 v[80:83], v[24:27], v[8:11], v[80:83]
    v_mfma_f32_16x16x32_bf16 v[92:95], v[24:27], v[12:15], v[92:95]
    s_cmp_lg_u32 s3, 0
    s_cbranch_scc1 M_g20_6
    s_add_u32 s84, s28, 82944
    buffer_load_dwordx4 v[160:163], v58, s[16:19], s84 offen
    s_add_u32 s84, s28, 96768
    buffer_load_dwordx4 v[168:171], v58, s[16:19], s84 offen
M_g20_6:
    s_add_u32 s84, s28, 207360
    buffer_load_dwordx4 v[232:235], v58, s[16:19], s84 offen
    ds_read_b128 v[8:11], v109 offset:32768
    ds_read_b128 v[12:15], v109 offset:33024
    ds_read_b128 v[16:19], v110 offset:36864
    ds_read_b128 v[20:23], v110 offset:37888
    ds_read_b128 v[24:27], v110 offset:38912
    s_waitcnt lgkmcnt(5)
    v_mfma_f32_16x16x32_bf16 v[72:75], v[36:39], v[28:31], v[72:75]
    v_mfma_f32_16x16x32_bf16 v[84:87], v[36:39], v[32:35], v[84:87]
    v_mfma_f32_16x16x32_bf16 v[76:79], v[40:43], v[28:31], v[76:79]
    v_mfma_f32_16x16x32_bf16 v[88:91], v[40:43], v[32:35], v[88:91]
    v_mfma_f32_16x16x32_bf16 v[80:83], v[44:47], v[28:31], v[80:83]
    v_mfma_f32_16x16x32_bf16 v[92:95], v[44:47], v[32:35], v[92:95]
    s_cmp_lg_u32 s3, 0
    s_cbranch_scc1 M_g20_7
    s_add_u32 s84, s28, 110592
    buffer_load_dwordx4 v[176:179], v58, s[16:19], s84 offen
    s_add_u32 s84, s28, 124416
    buffer_load_dwordx4 v[184:187], v58, s[16:19], s84 offen
M_g20_7:
    s_waitcnt lgkmcnt(0)
    v_mfma_f32_16x16x32_bf16 v[72:75], v[16:19], v[8:11], v[72:75]
    v_mfma_f32_16x16x32_bf16 v[84:87], v[16:19], v[12:15], v[84:87]
    v_mfma_f32_16x16x32_bf16 v[76:79], v[20:23], v[8:11], v[76:79]
    v_mfma_f32_16x16x32_bf16 v[88:91], v[20:23], v[12:15], v[88:91]
    v_mfma_f32_16x16x32_bf16 v[80:83], v[24:27], v[8:11], v[80:83]
    v_mfma_f32_16x16x32_bf16 v[92:95], v[24:27], v[12:15], v[92:95]
    s_cmp_lg_u32 s3, 0
    s_cbranch_scc1 M_g20_8
M_g20_8:
    s_and_b32 s7, s4, 1
    s_cmp_eq_u32 s7, 0
    s_nop 6
    s_cbranch_scc1 M_Bx0_k0
    ds_write_b128 v56, v[72:75] offset:0
    ds_write_b128 v56, v[76:79] offset:1024
    ds_write_b128 v56, v[80:83] offset:2048
    s_waitcnt lgkmcnt(0)
    s_barrier
    ds_read_b128 v[8:11], v71 offset:0
    ds_read_b128 v[12:15], v71 offset:1024
    ds_read_b128 v[16:19], v71 offset:2048
    s_waitcnt lgkmcnt(2)
    v_pk_add_f32 v[96:97], v[84:85], v[8:9]
    v_pk_add_f32 v[98:99], v[86:87], v[10:11]
    s_waitcnt lgkmcnt(1)
    v_pk_add_f32 v[100:101], v[88:89], v[12:13]
    v_pk_add_f32 v[102:103], v[90:91], v[14:15]
    s_waitcnt lgkmcnt(0)
    v_pk_add_f32 v[104:105], v[92:93], v[16:17]
    v_pk_add_f32 v[106:107], v[94:95], v[18:19]
    s_branch M_Bx0_j
M_Bx0_k0:
    ds_write_b128 v56, v[84:87] offset:0
    ds_write_b128 v56, v[88:91] offset:1024
    ds_write_b128 v56, v[92:95] offset:2048
    s_waitcnt lgkmcnt(0)
    s_barrier
    ds_read_b128 v[8:11], v71 offset:0
    ds_read_b128 v[12:15], v71 offset:1024
    ds_read_b128 v[16:19], v71 offset:2048
    s_waitcnt lgkmcnt(2)
    v_pk_add_f32 v[96:97], v[72:73], v[8:9]
    v_pk_add_f32 v[98:99], v[74:75], v[10:11]
    s_waitcnt lgkmcnt(1)
    v_pk_add_f32 v[100:101], v[76:77], v[12:13]
    v_pk_add_f32 v[102:103], v[78:79], v[14:15]
    s_waitcnt lgkmcnt(0)
    v_pk_add_f32 v[104:105], v[80:81], v[16:17]
    v_pk_add_f32 v[106:107], v[82:83], v[18:19]
M_Bx0_j:
    s_mul_i32 s5, s3, 2621440
    s_add_u32 s5, s5, s24
    s_mul_i32 s6, s20, 9216
    s_add_u32 s5, s5, s6
    s_add_u32 s5, s5, 2621440
    v_cvt_pk_bf16_f32 v16, v96, v97
    v_cvt_pk_bf16_f32 v26, v100, v101
    v_cvt_pk_bf16_f32 v36, v104, v105
    v_cvt_pk_bf16_f32 v17, v98, v99
    v_cvt_pk_bf16_f32 v27, v102, v103
    v_cvt_pk_bf16_f32 v37, v106, v107
    v_lshlrev_b32 v12, 16, v60
    v_lshlrev_b32 v22, 16, v62
    v_lshlrev_b32 v32, 16, v64
    v_and_b32 v13, 0xffff0000, v60
    v_and_b32 v23, 0xffff0000, v62
    v_and_b32 v33, 0xffff0000, v64
    v_lshlrev_b32 v14, 16, v61
    v_lshlrev_b32 v24, 16, v63
    v_lshlrev_b32 v34, 16, v65
    v_and_b32 v15, 0xffff0000, v61
    v_and_b32 v25, 0xffff0000, v63
    v_and_b32 v35, 0xffff0000, v65
    v_lshlrev_b32 v8, 16, v16
    v_lshlrev_b32 v18, 16, v26
    v_lshlrev_b32 v28, 16, v36
    v_and_b32 v9, 0xffff0000, v16
    v_and_b32 v19, 0xffff0000, v26
    v_and_b32 v29, 0xffff0000, v36
    v_lshlrev_b32 v10, 16, v17
    v_lshlrev_b32 v20, 16, v27
    v_lshlrev_b32 v30, 16, v37
    v_and_b32 v11, 0xffff0000, v17
    v_and_b32 v21, 0xffff0000, v27
    v_and_b32 v31, 0xffff0000, v37
    v_pk_add_f32 v[8:9], v[8:9], v[12:13]
    v_pk_add_f32 v[18:19], v[18:19], v[22:23]
    v_pk_add_f32 v[28:29], v[28:29], v[32:33]
    v_pk_add_f32 v[10:11], v[10:11], v[14:15]
    v_pk_add_f32 v[20:21], v[20:21], v[24:25]
    v_pk_add_f32 v[30:31], v[30:31], v[34:35]
    v_cvt_pk_bf16_f32 v60, v8, v9
    v_cvt_pk_bf16_f32 v62, v18, v19
    v_cvt_pk_bf16_f32 v64, v28, v29
    v_cvt_pk_bf16_f32 v61, v10, v11
    v_cvt_pk_bf16_f32 v63, v20, v21
    v_cvt_pk_bf16_f32 v65, v30, v31
    s_cmp_eq_u32 s3, 3
    s_cbranch_scc1 M_Bf0
    buffer_store_dwordx2 v[60:61], v67, s[12:15], s5 offen sc1
    s_add_u32 s5, s5, 2048
    buffer_store_dwordx2 v[62:63], v67, s[12:15], s5 offen sc1
    s_add_u32 s5, s5, 2048
    buffer_store_dwordx2 v[64:65], v67, s[12:15], s5 offen sc1
    s_add_u32 s5, s5, 2048
    s_mov_b64 exec, -1
    v_mov_b32 v8, 0x3f803f80
    v_dot2_f32_bf16 v28, v60, v8, 0
    v_dot2_f32_bf16 v29, v60, v60, 0
    v_dot2_f32_bf16 v28, v61, v8, v28
    v_dot2_f32_bf16 v29, v61, v61, v29
    v_dot2_f32_bf16 v28, v62, v8, v28
    v_dot2_f32_bf16 v29, v62, v62, v29
    v_dot2_f32_bf16 v28, v63, v8, v28
    v_dot2_f32_bf16 v29, v63, v63, v29
    v_dot2_f32_bf16 v28, v64, v8, v28
    v_dot2_f32_bf16 v29, v64, v64, v29
    v_dot2_f32_bf16 v28, v65, v8, v28
    v_dot2_f32_bf16 v29, v65, v65, v29
    s_nop 2
    v_mov_b32 v30, v28
    v_mov_b32 v31, v29
    s_lshl_b32 s5, s3, 18
    s_lshl_b32 s6, s21, 13
    v_permlane32_swap_b32 v28, v30
    v_permlane32_swap_b32 v29, v31
    v_pk_add_f32 v[28:29], v[28:29], v[30:31]
    v_mov_b32 v30, v28
    v_mov_b32 v31, v29
    s_add_u32 s5, s5, s6
    s_lshl_b32 s6, s20, 10
    v_permlane16_swap_b32 v28, v30
    v_permlane16_swap_b32 v29, v31
    v_pk_add_f32 v[28:29], v[28:29], v[30:31]
    s_add_u32 s5, s5, s6
    s_and_b32 s6, s4, 3
    s_lshl_b32 s6, s6, 7
    s_add_u32 s5, s5, s6
    s_add_u32 s5, s5, 29622272
    v_lshlrev_b32 v30, 3, v0
    s_mov_b64 exec, 0xffff
    buffer_store_dwordx2 v[28:29], v30, s[12:15], s5 offen sc1
    s_mov_b64 exec, -1
    s_branch M_Bdone
M_Bf0:
    buffer_store_dwordx2 v[60:61], v66, s[92:95], 0 offen offset:0
    buffer_store_dwordx2 v[62:63], v66, s[92:95], 0 offen offset:32
    buffer_store_dwordx2 v[64:65], v66, s[92:95], 0 offen offset:64
    s_mov_b64 exec, -1
    s_branch M_fin
M_Bh1:
    s_waitcnt vmcnt(4)
    s_barrier
    ds_read_b128 v[8:11], v108 offset:0
    ds_read_b128 v[12:15], v108 offset:256
    ds_read_b128 v[16:19], v7 offset:0
    ds_read_b128 v[20:23], v69 offset:0
    s_add_u32 m0, s26, 40960
    s_nop 0
    buffer_load_dwordx4 v70, s[12:15], s88 offen sc1 lds
    s_add_u32 s88, s88, 8192
    s_add_u32 m0, s26, 49152
    s_nop 0
    buffer_load_dwordx4 v70, s[12:15], s88 offen sc1 lds
    s_add_u32 s88, s88, 8192
    s_waitcnt lgkmcnt(0)
    v_mfma_f32_16x16x32_bf16 v[72:75], v[16:19], v[8:11], v[72:75]
    v_mfma_f32_16x16x32_bf16 v[84:87], v[16:19], v[12:15], v[84:87]
    v_mfma_f32_16x16x32_bf16 v[76:79], v[20:23], v[8:11], v[76:79]
    v_mfma_f32_16x16x32_bf16 v[88:91], v[20:23], v[12:15], v[88:91]
    s_waitcnt vmcnt(5)
    s_barrier
    ds_read_b128 v[28:31], v108 offset:8192
    ds_read_b128 v[32:35], v108 offset:8448
    ds_read_b128 v[36:39], v7 offset:9216
    ds_read_b128 v[40:43], v69 offset:9216
    s_add_u32 m0, s26, 57344
    s_nop 0
    buffer_load_dwordx4 v70, s[12:15], s88 offen sc1 lds
    s_add_u32 s88, s88, 8192
    s_add_u32 m0, s26, 65536
    s_nop 0
    buffer_load_dwordx4 v70, s[12:15], s88 offen sc1 lds
    s_add_u32 s88, s88, 8192
    s_waitcnt lgkmcnt(0)
    v_mfma_f32_16x16x32_bf16 v[72:75], v[36:39], v[28:31], v[72:75]
    v_mfma_f32_16x16x32_bf16 v[84:87], v[36:39], v[32:35], v[84:87]
    v_mfma_f32_16x16x32_bf16 v[76:79], v[40:43], v[28:31], v[76:79]
    v_mfma_f32_16x16x32_bf16 v[88:91], v[40:43], v[32:35], v[88:91]
    s_waitcnt vmcnt(5)
    s_barrier
    ds_read_b128 v[8:11], v108 offset:16384
    ds_read_b128 v[12:15], v108 offset:16640
    ds_read_b128 v[16:19], v7 offset:18432
    ds_read_b128 v[20:23], v69 offset:18432
    ds_read_b128 v[28:31], v108 offset:24576
    ds_read_b128 v[32:35], v108 offset:24832
    ds_read_b128 v[36:39], v7 offset:27648
    ds_read_b128 v[40:43], v69 offset:27648
    s_waitcnt lgkmcnt(4)
    v_mfma_f32_16x16x32_bf16 v[72:75], v[16:19], v[8:11], v[72:75]
    v_mfma_f32_16x16x32_bf16 v[84:87], v[16:19], v[12:15], v[84:87]
    v_mfma_f32_16x16x32_bf16 v[76:79], v[20:23], v[8:11], v[76:79]
    v_mfma_f32_16x16x32_bf16 v[88:91], v[20:23], v[12:15], v[88:91]
    s_waitcnt lgkmcnt(0)
    v_mfma_f32_16x16x32_bf16 v[72:75], v[36:39], v[28:31], v[72:75]
    v_mfma_f32_16x16x32_bf16 v[84:87], v[36:39], v[32:35], v[84:87]
    v_mfma_f32_16x16x32_bf16 v[76:79], v[40:43], v[28:31], v[76:79]
    v_mfma_f32_16x16x32_bf16 v[88:91], v[40:43], v[32:35], v[88:91]
    s_waitcnt vmcnt(3)
    s_barrier
    ds_read_b128 v[8:11], v109 offset:0
    ds_read_b128 v[12:15], v109 offset:256
    ds_read_b128 v[16:19], v110 offset:0
    ds_read_b128 v[20:23], v111 offset:0
    s_cmp_lg_u32 s3, 0
    s_cbranch_scc1 M_g21_3
    s_add_u32 s84, s28, 0
    buffer_load_dwordx4 v[112:115], v58, s[16:19], s84 offen
    s_add_u32 s84, s28, 0
    buffer_load_dwordx4 v[116:119], v59, s[16:19], s84 offen
M_g21_3:
    ds_read_b128 v[28:31], v109 offset:8192
    ds_read_b128 v[32:35], v109 offset:8448
    ds_read_b128 v[36:39], v110 offset:9216
    ds_read_b128 v[40:43], v111 offset:9216
    s_waitcnt lgkmcnt(4)
    v_mfma_f32_16x16x32_bf16 v[72:75], v[16:19], v[8:11], v[72:75]
    v_mfma_f32_16x16x32_bf16 v[84:87], v[16:19], v[12:15], v[84:87]
    v_mfma_f32_16x16x32_bf16 v[76:79], v[20:23], v[8:11], v[76:79]
    v_mfma_f32_16x16x32_bf16 v[88:91], v[20:23], v[12:15], v[88:91]
    s_cmp_lg_u32 s3, 0
    s_cbranch_scc1 M_g21_4
    s_add_u32 s84, s28, 13824
    buffer_load_dwordx4 v[120:123], v58, s[16:19], s84 offen
    s_add_u32 s84, s28, 13824
    buffer_load_dwordx4 v[124:127], v59, s[16:19], s84 offen
M_g21_4:
    s_add_u32 s84, s28, 193536
    buffer_load_dwordx4 v[224:227], v58, s[16:19], s84 offen
    s_add_u32 s84, s28, 193536
    buffer_load_dwordx4 v[228:231], v59, s[16:19], s84 offen
    s_waitcnt lgkmcnt(0)
    v_mfma_f32_16x16x32_bf16 v[72:75], v[36:39], v[28:31], v[72:75]
    v_mfma_f32_16x16x32_bf16 v[84:87], v[36:39], v[32:35], v[84:87]
    v_mfma_f32_16x16x32_bf16 v[76:79], v[40:43], v[28:31], v[76:79]
    v_mfma_f32_16x16x32_bf16 v[88:91], v[40:43], v[32:35], v[88:91]
    s_waitcnt vmcnt(2)
    s_barrier
    ds_read_b128 v[8:11], v109 offset:16384
    ds_read_b128 v[12:15], v109 offset:16640
    ds_read_b128 v[16:19], v110 offset:18432
    ds_read_b128 v[20:23], v111 offset:18432
    s_cmp_lg_u32 s3, 0
    s_cbranch_scc1 M_g21_5
    s_add_u32 s84, s28, 27648
    buffer_load_dwordx4 v[128:131], v58, s[16:19], s84 offen
    s_add_u32 s84, s28, 27648
    buffer_load_dwordx4 v[132:135], v59, s[16:19], s84 offen
M_g21_5:
    s_add_u32 s84, s28, 207360
    buffer_load_dwordx4 v[232:235], v58, s[16:19], s84 offen
    s_add_u32 s84, s28, 207360
    buffer_load_dwordx4 v[236:239], v59, s[16:19], s84 offen
    ds_read_b128 v[28:31], v109 offset:24576
    ds_read_b128 v[32:35], v109 offset:24832
    ds_read_b128 v[36:39], v110 offset:27648
    ds_read_b128 v[40:43], v111 offset:27648
    s_waitcnt lgkmcnt(4)
    v_mfma_f32_16x16x32_bf16 v[72:75], v[16:19], v[8:11], v[72:75]
    v_mfma_f32_16x16x32_bf16 v[84:87], v[16:19], v[12:15], v[84:87]
    v_mfma_f32_16x16x32_bf16 v[76:79], v[20:23], v[8:11], v[76:79]
    v_mfma_f32_16x16x32_bf16 v[88:91], v[20:23], v[12:15], v[88:91]
    s_cmp_lg_u32 s3, 0
    s_cbranch_scc1 M_g21_6
    s_add_u32 s84, s28, 41472
    buffer_load_dwordx4 v[136:139], v58, s[16:19], s84 offen
    s_add_u32 s84, s28, 41472
    buffer_load_dwordx4 v[140:143], v59, s[16:19], s84 offen
M_g21_6:
    s_add_u32 s84, s28, 221184
    buffer_load_dwordx4 v[240:243], v58, s[16:19], s84 offen
    s_add_u32 s84, s28, 221184
    buffer_load_dwordx4 v[244:247], v59, s[16:19], s84 offen
    ds_read_b128 v[8:11], v109 offset:32768
    ds_read_b128 v[12:15], v109 offset:33024
    ds_read_b128 v[16:19], v110 offset:36864
    ds_read_b128 v[20:23], v111 offset:36864
    s_waitcnt lgkmcnt(4)
    v_mfma_f32_16x16x32_bf16 v[72:75], v[36:39], v[28:31], v[72:75]
    v_mfma_f32_16x16x32_bf16 v[84:87], v[36:39], v[32:35], v[84:87]
    v_mfma_f32_16x16x32_bf16 v[76:79], v[40:43], v[28:31], v[76:79]
    v_mfma_f32_16x16x32_bf16 v[88:91], v[40:43], v[32:35], v[88:91]
    s_cmp_lg_u32 s3, 0
    s_cbranch_scc1 M_g21_7
    s_add_u32 s84, s28, 55296
    buffer_load_dwordx4 v[144:147], v58, s[16:19], s84 offen
    s_add_u32 s84, s28, 55296
    buffer_load_dwordx4 v[148:151], v59, s[16:19], s84 offen
M_g21_7:
    s_add_u32 s84, s28, 235008
    buffer_load_dwordx4 v[248:251], v58, s[16:19], s84 offen
    s_add_u32 s84, s28, 235008
    buffer_load_dwordx4 v[252:255], v59, s[16:19], s84 offen
    s_waitcnt lgkmcnt(0)
    v_mfma_f32_16x16x32_bf16 v[72:75], v[16:19], v[8:11], v[72:75]
    v_mfma_f32_16x16x32_bf16 v[84:87], v[16:19], v[12:15], v[84:87]
    v_mfma_f32_16x16x32_bf16 v[76:79], v[20:23], v[8:11], v[76:79]
    v_mfma_f32_16x16x32_bf16 v[88:91], v[20:23], v[12:15], v[88:91]
    s_cmp_lg_u32 s3, 0
    s_cbranch_scc1 M_g21_8
    s_add_u32 s84, s28, 69120
    buffer_load_dwordx4 v[152:155], v58, s[16:19], s84 offen
    s_add_u32 s84, s28, 69120
    buffer_load_dwordx4 v[156:159], v59, s[16:19], s84 offen
M_g21_8:
    s_and_b32 s7, s4, 1
    s_cmp_eq_u32 s7, 0
    s_nop 6
    s_cbranch_scc1 M_Bx1_k0
    ds_write_b128 v56, v[72:75] offset:0
    ds_write_b128 v56, v[76:79] offset:1024
    s_waitcnt lgkmcnt(0)
    s_barrier
    ds_read_b128 v[8:11], v71 offset:0
    ds_read_b128 v[12:15], v71 offset:1024
    s_waitcnt lgkmcnt(1)
    v_pk_add_f32 v[96:97], v[84:85], v[8:9]
    v_pk_add_f32 v[98:99], v[86:87], v[10:11]
    s_waitcnt lgkmcnt(0)
    v_pk_add_f32 v[100:101], v[88:89], v[12:13]
    v_pk_add_f32 v[102:103], v[90:91], v[14:15]
    s_branch M_Bx1_j
M_Bx1_k0:
    ds_write_b128 v56, v[84:87] offset:0
    ds_write_b128 v56, v[88:91] offset:1024
    s_waitcnt lgkmcnt(0)
    s_barrier
    ds_read_b128 v[8:11], v71 offset:0
    ds_read_b128 v[12:15], v71 offset:1024
    s_waitcnt lgkmcnt(1)
    v_pk_add_f32 v[96:97], v[72:73], v[8:9]
    v_pk_add_f32 v[98:99], v[74:75], v[10:11]
    s_waitcnt lgkmcnt(0)
    v_pk_add_f32 v[100:101], v[76:77], v[12:13]
    v_pk_add_f32 v[102:103], v[78:79], v[14:15]
M_Bx1_j:
    s_mul_i32 s5, s3, 2621440
    s_add_u32 s5, s5, s24
    s_mul_i32 s6, s20, 9216
    s_add_u32 s5, s5, s6
    s_add_u32 s5, s5, 2621440
    v_cvt_pk_bf16_f32 v16, v96, v97
    v_cvt_pk_bf16_f32 v26, v100, v101
    v_cvt_pk_bf16_f32 v17, v98, v99
    v_cvt_pk_bf16_f32 v27, v102, v103
    v_lshlrev_b32 v12, 16, v60
    v_lshlrev_b32 v22, 16, v62
    v_and_b32 v13, 0xffff0000, v60
    v_and_b32 v23, 0xffff0000, v62
    v_lshlrev_b32 v14, 16, v61
    v_lshlrev_b32 v24, 16, v63
    v_and_b32 v15, 0xffff0000, v61
    v_and_b32 v25, 0xffff0000, v63
    v_lshlrev_b32 v8, 16, v16
    v_lshlrev_b32 v18, 16, v26
    v_and_b32 v9, 0xffff0000, v16
    v_and_b32 v19, 0xffff0000, v26
    v_lshlrev_b32 v10, 16, v17
    v_lshlrev_b32 v20, 16, v27
    v_and_b32 v11, 0xffff0000, v17
    v_and_b32 v21, 0xffff0000, v27
    v_pk_add_f32 v[8:9], v[8:9], v[12:13]
    v_pk_add_f32 v[18:19], v[18:19], v[22:23]
    v_pk_add_f32 v[10:11], v[10:11], v[14:15]
    v_pk_add_f32 v[20:21], v[20:21], v[24:25]
    v_cvt_pk_bf16_f32 v60, v8, v9
    v_cvt_pk_bf16_f32 v62, v18, v19
    v_cvt_pk_bf16_f32 v61, v10, v11
    v_cvt_pk_bf16_f32 v63, v20, v21
    s_cmp_eq_u32 s3, 3
    s_cbranch_scc1 M_Bf1
    buffer_store_dwordx2 v[60:61], v67, s[12:15], s5 offen sc1
    s_add_u32 s5, s5, 2048
    s_mov_b64 exec, 0xffffffff
    buffer_store_dwordx2 v[62:63], v67, s[12:15], s5 offen sc1
    s_add_u32 s5, s5, 2048
    s_mov_b64 exec, -1
    s_mov_b32 s6, 0
    s_mov_b32 s7, -1
    v_cndmask_b32 v40, v62, 0, s[6:7]
    v_cndmask_b32 v41, v63, 0, s[6:7]
    v_mov_b32 v8, 0x3f803f80
    v_dot2_f32_bf16 v28, v60, v8, 0
    v_dot2_f32_bf16 v29, v60, v60, 0
    v_dot2_f32_bf16 v28, v61, v8, v28
    v_dot2_f32_bf16 v29, v61, v61, v29
    v_dot2_f32_bf16 v28, v40, v8, v28
    v_dot2_f32_bf16 v29, v40, v40, v29
    v_dot2_f32_bf16 v28, v41, v8, v28
    v_dot2_f32_bf16 v29, v41, v41, v29
    s_nop 2
    v_mov_b32 v30, v28
    v_mov_b32 v31, v29
    s_lshl_b32 s5, s3, 18
    s_lshl_b32 s6, s21, 13
    v_permlane32_swap_b32 v28, v30
    v_permlane32_swap_b32 v29, v31
    v_pk_add_f32 v[28:29], v[28:29], v[30:31]
    v_mov_b32 v30, v28
    v_mov_b32 v31, v29
    s_add_u32 s5, s5, s6
    s_lshl_b32 s6, s20, 10
    v_permlane16_swap_b32 v28, v30
    v_permlane16_swap_b32 v29, v31
    v_pk_add_f32 v[28:29], v[28:29], v[30:31]
    s_add_u32 s5, s5, s6
    s_and_b32 s6, s4, 3
    s_lshl_b32 s6, s6, 7
    s_add_u32 s5, s5, s6
    s_add_u32 s5, s5, 29622784
    v_lshlrev_b32 v30, 3, v0
    s_mov_b64 exec, 0xffff
    buffer_store_dwordx2 v[28:29], v30, s[12:15], s5 offen sc1
    s_mov_b64 exec, -1
    s_branch M_Bdone
M_Bf1:
    buffer_store_dwordx2 v[60:61], v66, s[92:95], 0 offen offset:0
    s_mov_b64 exec, 0xffffffff
    buffer_store_dwordx2 v[62:63], v66, s[92:95], 0 offen offset:32
    s_mov_b64 exec, -1
    s_branch M_fin
M_Bdone:
    s_add_u32 s91, s90, 4096
    s_waitcnt vmcnt(0)
    s_barrier
    s_cmp_lg_u32 s4, 7
    s_cbranch_scc1 M_sigB_ns
    s_lshl_b32 s5, s20, 2
    s_mov_b64 exec, 1
    v_mov_b32 v2, s5
    v_mov_b32 v3, s101
    buffer_store_dword v3, v2, s[12:15], s91 offen sc1
    s_mov_b64 exec, -1
M_sigB_ns:
    s_cmp_lt_u32 s4, 4
    s_cbranch_scc1 M_g3
    s_cmp_lg_u32 s3, 0
    s_cbranch_scc1 M_g3
    s_add_u32 s84, s28, 82944
    buffer_load_dwordx4 v[160:163], v58, s[16:19], s84 offen
    s_add_u32 s84, s28, 82944
    buffer_load_dwordx4 v[164:167], v59, s[16:19], s84 offen
    s_add_u32 s84, s28, 96768
    buffer_load_dwordx4 v[168:171], v58, s[16:19], s84 offen
    s_add_u32 s84, s28, 96768
    buffer_load_dwordx4 v[172:175], v59, s[16:19], s84 offen
    s_add_u32 s84, s28, 110592
    buffer_load_dwordx4 v[176:179], v58, s[16:19], s84 offen
    s_add_u32 s84, s28, 110592
    buffer_load_dwordx4 v[180:183], v59, s[16:19], s84 offen
    s_add_u32 s84, s28, 124416
    buffer_load_dwordx4 v[184:187], v58, s[16:19], s84 offen
    s_add_u32 s84, s28, 124416
    buffer_load_dwordx4 v[188:191], v59, s[16:19], s84 offen
    s_add_u32 s84, s28, 138240
    buffer_load_dwordx4 v[192:195], v58, s[16:19], s84 offen
    s_add_u32 s84, s28, 138240
    buffer_load_dwordx4 v[196:199], v59, s[16:19], s84 offen
    s_add_u32 s84, s28, 152064
    buffer_load_dwordx4 v[200:203], v58, s[16:19], s84 offen
    s_add_u32 s84, s28, 152064
    buffer_load_dwordx4 v[204:207], v59, s[16:19], s84 offen
M_g3:
    s_add_u32 s3, s3, 1
    s_and_b32 s5, s3, 1
    s_cmp_eq_u32 s5, 0
    s_mov_b32 s28, 20971520
    s_cselect_b32 s28, 23068672, s28
    s_add_u32 s28, s28, s96
    s_cmp_eq_u32 s3, 3
    s_cselect_b32 s18, 0, s18
    s_mul_i32 s27, s3, 2621440
    s_add_u32 s27, s27, s24
    s_sub_u32 s85, s27, 73728
    s_lshl_b32 s5, s4, 10
    s_add_u32 s27, s27, s5
    s_and_b32 s5, s3, 1
    s_cmp_eq_u32 s5, 0
    s_mov_b32 s89, 27262976
    s_cselect_b32 s89, 25165824, s89
    s_mul_i32 s5, s20, 82944
    s_add_u32 s89, s89, s5
    s_lshl_b32 s87, s4, 10
    s_add_u32 s87, s87, 5120
    s_cmp_eq_u32 s4, 7
    s_cbranch_scc1 M_nowo
    s_min_u32 s6, s87, 46080
    s_add_u32 m0, s6, 80896
    s_add_u32 s7, s6, s89
    buffer_load_dwordx4 v70, s[12:15], s7 offen lds
    s_add_u32 s87, s87, 7168
    s_min_u32 s6, s87, 46080
    s_add_u32 m0, s6, 80896
    s_add_u32 s7, s6, s89
    buffer_load_dwordx4 v70, s[12:15], s7 offen lds
    s_add_u32 s87, s87, 7168
    s_min_u32 s6, s87, 46080
    s_add_u32 m0, s6, 80896
    s_add_u32 s7, s6, s89
    buffer_load_dwordx4 v70, s[12:15], s7 offen lds
    s_add_u32 s87, s87, 7168
    s_min_u32 s6, s87, 46080
    s_add_u32 m0, s6, 80896
    s_add_u32 s7, s6, s89
    buffer_load_dwordx4 v70, s[12:15], s7 offen lds
    s_add_u32 s87, s87, 7168
    s_min_u32 s6, s87, 46080
    s_add_u32 m0, s6, 80896
    s_add_u32 s7, s6, s89
    buffer_load_dwordx4 v70, s[12:15], s7 offen lds
    s_add_u32 s87, s87, 7168
    s_min_u32 s6, s87, 46080
    s_add_u32 m0, s6, 80896
    s_add_u32 s7, s6, s89
    buffer_load_dwordx4 v70, s[12:15], s7 offen lds
    s_add_u32 s87, s87, 7168
M_nowo:
    s_cmp_lg_u32 s4, 7
    s_cbranch_scc1 M_pollB_done
    v_and_b32 v2, 7, v0
    v_lshlrev_b32 v2, 2, v2
    s_cmp_eq_u32 s23, 0
    s_cselect_b32 s5, 128, 0
    v_and_b32 v3, 8, v0
    v_lshlrev_b32 v3, 4, v3
    v_max_u32 v3, s5, v3
    v_add_u32 v2, v2, v3
    s_sub_u32 s91, s91, 128
    s_mov_b64 exec, 0xffff
    s_mov_b32 s5, 0x20000
    buffer_load_dword v8, v2, s[12:15], s91 offen sc1
    s_sleep 2
    buffer_load_dword v9, v2, s[12:15], s91 offen sc1
    s_sleep 2
M_pollB_loop:
    buffer_load_dword v10, v2, s[12:15], s91 offen sc1
    s_waitcnt vmcnt(2)
    v_cmp_eq_u32 vcc, s101, v8
    s_nop 1
    s_cmp_eq_u64 vcc, exec
    s_cbranch_scc1 M_pollB_ok
    buffer_load_dword v8, v2, s[12:15], s91 offen sc1
    s_waitcnt vmcnt(2)
    v_cmp_eq_u32 vcc, s101, v9
    s_nop 1
    s_cmp_eq_u64 vcc, exec
    s_cbranch_scc1 M_pollB_ok
    buffer_load_dword v9, v2, s[12:15], s91 offen sc1
    s_waitcnt vmcnt(2)
    v_cmp_eq_u32 vcc, s101, v10
    s_nop 1
    s_cmp_eq_u64 vcc, exec
    s_cbranch_scc1 M_pollB_ok
    s_sub_u32 s5, s5, 1
    s_cmp_lg_u32 s5, 0
    s_cbranch_scc1 M_pollB_loop
M_pollB_ok:
    s_mov_b64 exec, -1
M_pollB_done:
    s_barrier
    s_cmp_lt_u32 s4, 4
    s_cbranch_scc1 M_PV_loop
    s_cmp_eq_u32 s4, 4
    s_cbranch_scc1 M_S4_loop
    s_cmp_eq_u32 s4, 5
    s_cbranch_scc1 M_S5_loop
    s_cmp_eq_u32 s4, 6
    s_cbranch_scc1 M_S6_loop
    s_branch M_S7_loop
M_fin:
M_exit:
    s_endpgm
.section .rodata,"a"
.p2align 6
.amdhsa_kernel p_kernel
  .amdhsa_next_free_vgpr 96
  .amdhsa_next_free_sgpr 102
  .amdhsa_accum_offset 96
  .amdhsa_group_segment_fixed_size 0
  .amdhsa_kernarg_size 72
  .amdhsa_user_sgpr_count 2
  .amdhsa_user_sgpr_kernarg_segment_ptr 1
  .amdhsa_system_sgpr_workgroup_id_x 1
.end_amdhsa_kernel

.p2align 6
.amdhsa_kernel m_kernel
  .amdhsa_next_free_vgpr 256
  .amdhsa_next_free_sgpr 102
  .amdhsa_accum_offset 256
  .amdhsa_group_segment_fixed_size 0
  .amdhsa_kernarg_size 72
  .amdhsa_user_sgpr_count 2
  .amdhsa_user_sgpr_kernarg_segment_ptr 1
  .amdhsa_system_sgpr_workgroup_id_x 1
.end_amdhsa_kernel
```
